```python
import torch

def _softmax(x, axis=-1):
    return torch.softmax(x, dim=axis)

def _gelu(x):
    return torch.nn.functional.gelu(x, approximate='tanh')

def _silu(x):
    return torch.nn.functional.silu(x)

def _sigmoid(x):
    return torch.sigmoid(x)

def _layernorm(x, axis=-1, eps=1e-05):
    m = x.mean(dim=axis, keepdim=True)
    v = x.var(dim=axis, keepdim=True, unbiased=False)
    return (x - m) / torch.sqrt(v + eps)

def _scatter_add(tgt, idx, src, axis=0):
    return tgt.clone().index_add_(axis, idx, src)

def _segment_sum(src, seg, n):
    out = torch.zeros((n,) + src.shape[1:], dtype=src.dtype)
    return out.index_add_(0, seg, src)

def _pad(x, pw):
    flat = tuple((v for pair in reversed(pw) for v in pair))
    return torch.nn.functional.pad(x, flat)
kernel_name = 'gated_mix__memory_aug_recurrent_mem_tr__glu_gated_bilinear__prompt'

def setup_inputs():

    _w = lambda a: (lambda t: t.to(torch.bfloat16) if t.is_floating_point() else t)(torch.as_tensor(a))

    def _A_setup():
        B, S, Dm = (1, 2048, 640)
        H, Dh = (32, 128)
        M, seg = (8, 32)
        seg = min(seg, S)
        S = S // seg * seg
        return {'x': _w((lambda *s: torch.randn(*s, dtype=torch.bfloat16) * 0.05)(B, S, Dm)), 'mem0': _w((lambda *s: torch.randn(*s, dtype=torch.bfloat16) * 0.4)(B, M, Dm)), 'Wq': _w((lambda *s: torch.randn(*s, dtype=torch.bfloat16) * 6.4)(Dm, H, Dh) * Dm ** (-0.5)), 'Wk': _w((lambda *s: torch.randn(*s, dtype=torch.bfloat16) * 6.4)(Dm, H, Dh) * Dm ** (-0.5)), 'Wv': _w((lambda *s: torch.randn(*s, dtype=torch.bfloat16) * 0.4)(Dm, H, Dh) * Dm ** (-0.5)), 'Wo': _w((lambda *s: torch.randn(*s, dtype=torch.bfloat16) * 0.4)(H, Dh, Dm) * (H * Dh) ** (-0.5)), 'seg_len': seg}
    _A_in = _A_setup()

    def _B_setup():
        B, S, D, F = (1, 2048, 640, 1728)
        return {'x': _w((lambda *s: torch.randn(*s, dtype=torch.bfloat16) * 0.05)(B, S, D)), 'w_gate': _w((lambda *s: torch.randn(*s, dtype=torch.bfloat16) * 1.6)(D, F) * D ** (-0.5)), 'w_up': _w((lambda *s: torch.randn(*s, dtype=torch.bfloat16) * 1.6)(D, F) * D ** (-0.5)), 'w_down': _w((lambda *s: torch.randn(*s, dtype=torch.bfloat16) * 1.6)(F, D) * F ** (-0.5))}
    _B_in = _B_setup()
    return {'A_x': _A_in['x'], 'A_mem0': _A_in['mem0'], 'A_Wq': _A_in['Wq'], 'A_Wk': _A_in['Wk'], 'A_Wv': _A_in['Wv'], 'A_Wo': _A_in['Wo'], 'A_seg_len': _A_in['seg_len'], 'B_x': _B_in['x'], 'B_w_gate': _B_in['w_gate'], 'B_w_up': _B_in['w_up'], 'B_w_down': _B_in['w_down'], 'gate_w': _w((lambda *s: torch.randn(*s, dtype=torch.bfloat16) * 0.05)(640) * 16.0)}

def reference(A_x, A_mem0, A_Wq, A_Wk, A_Wv, A_Wo, A_seg_len, B_x, B_w_gate, B_w_up, B_w_down, gate_w):

    def _A_ref(x, mem0, Wq, Wk, Wv, Wo, seg_len):
        B, S, Dm = x.shape
        H, Dh = (Wq.shape[1], Wq.shape[2])
        M = mem0.shape[1]
        scale = Dh ** (-0.5)
        n_seg = S // seg_len
        L = M + seg_len
        idx = torch.arange(L)
        mask = (idx[:, None] < M) | (idx[:, None] >= idx[None, :])
        mem = mem0
        outs = []
        for s in range(n_seg):
            xs = x[:, s * seg_len:(s + 1) * seg_len, :].clone()
            h = torch.concatenate([mem, xs], axis=1)
            q = torch.einsum('btd,dhe->bhte', h, Wq)
            k = torch.einsum('btd,dhe->bhte', h, Wk)
            v = torch.einsum('btd,dhe->bhte', h, Wv)
            scores = torch.einsum('bhqe,bhke->bhqk', q, k) * scale
            scores = torch.where(mask[None, None], scores, -1000000000.0)
            p = _softmax(scores, axis=-1)
            o = torch.einsum('bhqk,bhke->bhqe', p, v)
            o = torch.einsum('bhte,hed->btd', o, Wo)
            mem = o[:, :M, :].clone()
            outs.append(o[:, M:, :])
        return torch.concatenate(outs, axis=1)

    def _B_ref(x, w_gate, w_up, w_down):
        g = torch.einsum('bsd,df->bsf', x, w_gate)
        u = torch.einsum('bsd,df->bsf', x, w_up)
        h = g * u
        return torch.einsum('bsf,fd->bsd', h, w_down)
    x = A_x
    g = _sigmoid((x * gate_w).sum(-1, keepdims=True))
    a = _A_ref(x, A_mem0, A_Wq, A_Wk, A_Wv, A_Wo, A_seg_len)
    b = _B_ref(x, B_w_gate, B_w_up, B_w_down)
    return g * a + (1 - g) * b
```

```asm
; @launch grid=(256,1,1) block=(512,1,1) lds=163840
.amdgcn_target "amdgcn-amd-amdhsa--gfx950"
.text
.globl gated_mix__memory_aug_recurrent_mem_tr__glu_gated_bilinear__prompt_kernel
.p2align 8
.type gated_mix__memory_aug_recurrent_mem_tr__glu_gated_bilinear__prompt_kernel,@function
gated_mix__memory_aug_recurrent_mem_tr__glu_gated_bilinear__prompt_kernel:
    s_cmp_ge_u32 s2, 256
    s_cbranch_scc1 L_end
    s_load_dwordx16 s[16:31], s[0:1], 0
    s_load_dwordx8 s[32:39], s[0:1], 64
    s_load_dwordx4 s[40:43], s[0:1], 96
    s_load_dwordx2 s[44:45], s[0:1], 112
    v_lshrrev_b32 v1, 6, v0
    v_and_b32 v0, 63, v0
    v_readfirstlane_b32 s52, v1
    s_getreg_b32 s53, hwreg(HW_REG_XCC_ID)
    s_and_b32 s53, s53, 7
    s_mov_b32 s59, 0x80000
    s_waitcnt lgkmcnt(0)
    s_mov_b32 s4, s44
    s_and_b32 s5, s45, 0xffff
    s_mov_b32 s6, 268435456
    s_mov_b32 s7, 0x00020000
    s_mov_b32 s8, s42
    s_and_b32 s9, s43, 0xffff
    s_mov_b32 s10, 256
    s_mov_b32 s11, 0x00020000
    s_mov_b32 s12, s44
    s_and_b32 s13, s45, 0xffff
    s_mov_b32 s14, 268435456
    s_mov_b32 s15, 0x00020000
    s_mov_b32 s48, s44
    s_and_b32 s49, s45, 0xffff
    s_mov_b32 s50, 268435456
    s_mov_b32 s51, 0x00020000
    s_lshr_b32 s54, s2, 3
    s_mov_b32 s30, 0
    s_cmp_lg_u32 s53, 0
    s_cbranch_scc1 L_nocal
    s_cmp_lt_u32 s54, 26
    s_cbranch_scc1 L_nocal
    s_cmp_lg_u32 s52, 7
    s_cbranch_scc1 L_caldone
    s_lshr_b32 s62, s2, 6
    s_lshl_b32 s62, s62, 14
    s_and_b32 s63, s2, 63
    s_lshl_b32 s63, s63, 7
    s_add_u32 s62, s62, s63
    s_add_u32 s62, s62, 260046848
    v_mov_b32 v2, s62
    v_add_u32 v3, 0x2000, v2
    v_mov_b32 v4, 0
    s_mov_b64 exec, 1
    s_mov_b32 s64, -1
    s_mov_b32 s65, -1
    buffer_store_dword v4, v2, s[4:7], 0 offen sc1
    buffer_store_dword v4, v3, s[4:7], 0 offen sc1
    s_waitcnt vmcnt(0)
    s_memtime s[84:85]
    s_waitcnt lgkmcnt(0)
    buffer_load_dword v5, v2, s[4:7], 0 offen sc1
    s_waitcnt vmcnt(0)
    s_memtime s[86:87]
    s_waitcnt lgkmcnt(0)
    s_sub_u32 s62, s86, s84
    s_min_u32 s64, s64, s62
    s_memtime s[84:85]
    s_waitcnt lgkmcnt(0)
    buffer_load_dword v5, v3, s[4:7], 0 offen sc1
    s_waitcnt vmcnt(0)
    s_memtime s[86:87]
    s_waitcnt lgkmcnt(0)
    s_sub_u32 s62, s86, s84
    s_min_u32 s65, s65, s62
    buffer_store_dword v4, v2, s[4:7], 0 offen sc1
    buffer_store_dword v4, v3, s[4:7], 0 offen sc1
    s_waitcnt vmcnt(0)
    s_memtime s[84:85]
    s_waitcnt lgkmcnt(0)
    buffer_load_dword v5, v2, s[4:7], 0 offen sc1
    s_waitcnt vmcnt(0)
    s_memtime s[86:87]
    s_waitcnt lgkmcnt(0)
    s_sub_u32 s62, s86, s84
    s_min_u32 s64, s64, s62
    s_memtime s[84:85]
    s_waitcnt lgkmcnt(0)
    buffer_load_dword v5, v3, s[4:7], 0 offen sc1
    s_waitcnt vmcnt(0)
    s_memtime s[86:87]
    s_waitcnt lgkmcnt(0)
    s_sub_u32 s62, s86, s84
    s_min_u32 s65, s65, s62
    s_cmp_lt_u32 s64, s65
    s_cselect_b32 s62, 36, 68
    v_mov_b32 v2, s62
    v_mov_b32 v4, 1
    buffer_atomic_add v4, v2, s[8:11], 0 offen
    s_waitcnt vmcnt(0)
    s_mov_b64 exec, -1
L_caldone:
    s_barrier
L_nocal:
    v_lshlrev_b32 v1, 4, v0
    v_mov_b32 v4, -1
    v_mov_b32 v5, -1
    v_mov_b32 v6, -1
    v_mov_b32 v7, -1
    s_cmp_ge_u32 s52, 6
    s_cbranch_scc1 L_ini67
    s_lshr_b32 s62, s52, 1
    s_mul_i32 s62, s62, 4194304
    s_and_b32 s63, s52, 1
    s_lshl_b32 s63, s63, 10
    s_add_u32 s62, s62, s63
    s_lshl_b32 s63, s2, 11
    s_add_u32 s62, s62, s63
    buffer_store_dwordx4 v[4:7], v1, s[4:7], s62 offen sc1
    s_branch L_dispatch
L_ini67:
    s_sub_u32 s64, s52, 6
    s_lshl_b32 s64, s64, 8
    s_add_u32 s64, s64, s2
    s_lshl_b32 s62, s64, 10
    s_add_u32 s62, s62, 37748736
    buffer_store_dwordx4 v[4:7], v1, s[4:7], s62 offen sc1
    s_cmp_eq_u32 s52, 6
    s_cbranch_scc1 L_ini6
    s_cmp_lt_u32 s2, 128
    s_cbranch_scc1 L_ini7
    s_add_u32 s64, s2, 384
    s_lshl_b32 s62, s64, 10
    s_add_u32 s62, s62, 37748736
    buffer_store_dwordx4 v[4:7], v1, s[4:7], s62 offen sc1
    s_branch L_dispatch
L_ini7:
    s_cmp_ge_u32 s2, 80
    s_cbranch_scc1 L_dispatch
    s_mov_b32 s63, 35586048
    s_cmp_ge_u32 s2, 64
    s_cselect_b32 s63, 7258112, s63
    s_lshl_b32 s62, s2, 10
    s_add_u32 s62, s62, s63
    buffer_store_dwordx4 v[4:7], v1, s[4:7], s62 offen sc1
    s_branch L_dispatch
L_ini6:
    v_mov_b32 v8, 0
    v_mov_b32 v9, 0
    s_lshl_b32 s62, s2, 7
    s_add_u32 s62, s62, 2359296
    s_mov_b64 exec, 1
    buffer_store_dwordx2 v[8:9], v8, s[4:7], s62 offen sc1
    s_mov_b64 exec, -1
    s_branch L_dispatch
L_reclaim:
    s_waitcnt vmcnt(0) lgkmcnt(0)
    s_barrier
    s_mov_b32 s30, 1
    s_cmp_lg_u32 s52, 0
    s_cbranch_scc1 L_pro_join
    s_mov_b64 exec, 1
L_claim_loop:
    s_lshl_b32 s62, 1, s54
    s_lshl_b32 s63, s53, 5
    v_mov_b32 v2, s62
    v_mov_b32 v3, s63
    buffer_atomic_or v2, v3, s[8:11], 0 offen sc0
    s_waitcnt vmcnt(0)
    v_readfirstlane_b32 s63, v2
    s_nop 0
    s_and_b32 s64, s63, s62
    s_cbranch_scc0 L_claim_ok
    s_cmp_eq_u32 s63, -1
    s_cbranch_scc1 L_claim_next
    s_ff0_i32_b32 s54, s63
    s_branch L_claim_loop
L_claim_next:
    v_mov_b32 v2, 1
    v_mov_b32 v3, 100
    buffer_atomic_or v2, v3, s[8:11], 0 offen
    s_waitcnt vmcnt(0)
    s_add_u32 s53, s53, 1
    s_and_b32 s53, s53, 7
    s_mov_b32 s54, 0
    s_branch L_claim_loop
L_claim_ok:
    s_lshl_b32 s62, s53, 5
    s_or_b32 s62, s62, s54
    v_mov_b32 v2, s62
    v_mov_b32 v3, 163836
    ds_write_b32 v3, v2
    s_waitcnt lgkmcnt(0)
    s_mov_b64 exec, -1
L_pro_join:
    s_barrier
    v_mov_b32 v3, 163836
    ds_read_b32 v2, v3
    s_waitcnt lgkmcnt(0)
    v_readfirstlane_b32 s62, v2
    s_nop 0
    s_lshr_b32 s53, s62, 5
    s_and_b32 s53, s53, 7
    s_and_b32 s54, s62, 31
L_dispatch:
    s_mov_b32 s56, 0
    s_cmp_eq_u32 s53, 0
    s_cbranch_scc1 L_R
    s_mov_b32 s56, 1
    s_cmp_eq_u32 s53, 2
    s_cbranch_scc1 L_R
    s_mov_b32 s56, 2
    s_cmp_eq_u32 s53, 1
    s_cbranch_scc1 L_RVO
    s_mov_b32 s62, 0
    s_cmp_eq_u32 s53, 4
    s_cbranch_scc1 L_Atype
    s_mov_b32 s62, 1
    s_cmp_eq_u32 s53, 5
    s_cbranch_scc1 L_Atype
    s_mov_b32 s62, 2
    s_cmp_eq_u32 s53, 6
    s_cbranch_scc1 L_Atype
    s_mov_b32 s62, 3
    s_cmp_eq_u32 s53, 7
    s_cbranch_scc1 L_Atype
    s_cmp_lg_u32 s53, 3
    s_cbranch_scc1 L_idle
    s_lshr_b32 s55, s54, 1
    s_and_b32 s56, s54, 1
    s_cmp_lt_u32 s54, 28
    s_cbranch_scc1 L_FF1
L_idle:
    s_waitcnt vmcnt(0)
    s_barrier
    s_or_b32 s62, s52, s30
    s_cbranch_scc1 Lci_1
    s_lshl_b32 s62, 1, s54
    s_lshl_b32 s63, s53, 5
    v_mov_b32 v20, s62
    v_mov_b32 v2, s63
    s_mov_b64 exec, 1
    buffer_atomic_or v20, v2, s[8:11], 0 offen sc0
    s_mov_b64 exec, -1
Lci_1:
    v_min_u32 v3, 7, v0
    v_lshlrev_b32 v3, 5, v3
    s_cmp_lg_u32 s52, 0
    s_cbranch_scc1 Lwid_3
    s_mov_b32 s64, 0
    s_cmp_lg_u32 s30, 0
    s_cbranch_scc1 Lwok_4
    s_waitcnt vmcnt(0)
    v_readfirstlane_b32 s62, v20
    s_nop 0
    s_lshr_b32 s62, s62, s54
    s_and_b32 s64, s62, 1
Lwok_4:
    v_mov_b32 v2, 163832
    v_mov_b32 v20, s64
    ds_write_b32 v2, v20
    s_waitcnt lgkmcnt(0)
Lwid_3:
    s_barrier
    v_mov_b32 v3, 163832
    ds_read_b32 v3, v3
    s_waitcnt vmcnt(0) lgkmcnt(0)
    v_readfirstlane_b32 s62, v3
    s_nop 0
    s_cmp_lg_u32 s62, 0
    s_cbranch_scc1 L_reclaim
    s_branch L_end
L_Atype:
    s_and_b32 s55, s54, 7
    s_mov_b32 s56, s62
    s_cmp_ge_u32 s54, 24
    s_cbranch_scc1 L_FIN
    s_lshl_b32 s62, s62, 3
    s_add_u32 s55, s55, s62
    s_mov_b32 s56, 0
    s_cmp_ge_u32 s54, 16
    s_cbranch_scc1 L_VOX
    s_lshr_b32 s56, s54, 3
    s_branch L_QKX
L_R:
    s_cmp_lt_u32 s54, 16
    s_cbranch_scc1 L_RQK
    s_sub_u32 s57, s54, 16
    s_cmp_eq_u32 s57, 15
    s_cbranch_scc1 L_idle
    s_waitcnt vmcnt(0)
    s_barrier
    s_or_b32 s62, s52, s30
    s_cbranch_scc1 Lci_5
    s_lshl_b32 s62, 1, s54
    s_lshl_b32 s63, s53, 5
    v_mov_b32 v20, s62
    v_mov_b32 v14, s63
    s_mov_b64 exec, 1
    buffer_atomic_or v20, v14, s[8:11], 0 offen sc0
    s_mov_b64 exec, -1
Lci_5:
    v_min_u32 v15, 7, v0
    v_lshlrev_b32 v15, 5, v15
    s_cmp_lg_u32 s52, 0
    s_cbranch_scc1 Lwid_7
    s_mov_b32 s64, 0
    s_cmp_lg_u32 s30, 0
    s_cbranch_scc1 Lwok_8
    s_waitcnt vmcnt(0)
    v_readfirstlane_b32 s62, v20
    s_nop 0
    s_lshr_b32 s62, s62, s54
    s_and_b32 s64, s62, 1
Lwok_8:
    v_mov_b32 v14, 163832
    v_mov_b32 v20, s64
    ds_write_b32 v14, v20
    s_waitcnt lgkmcnt(0)
    s_cmp_lg_u32 s64, 0
    s_cbranch_scc1 Lwid_7
    s_mov_b32 s89, s59
Lwi_6:
    s_sleep 64
    buffer_load_dword v14, v15, s[8:11], 0 offen sc1
    s_waitcnt vmcnt(0)
    v_cmp_ne_u32 vcc, -1, v14
    s_cbranch_vccz Lwid_7
    s_sub_u32 s89, s89, 8
    s_cbranch_scc0 Lwi_6
    s_mov_b32 s59, 0
Lwid_7:
    s_barrier
    buffer_load_dword v14, v15, s[8:11], 0 offen offset:4 sc1
    v_mov_b32 v15, 163832
    ds_read_b32 v15, v15
    s_waitcnt vmcnt(0) lgkmcnt(0)
    v_readfirstlane_b32 s62, v15
    s_nop 0
    s_cmp_lg_u32 s62, 0
    s_cbranch_scc1 L_reclaim
    v_readlane_b32 s62, v14, 1
    v_readlane_b32 s63, v14, 2
    v_readlane_b32 s61, v14, 3
    s_cmp_gt_u32 s63, s62
    s_cselect_b32 s46, 0x2000, 0
    s_mul_i32 s65, s56, 4194304
    s_add_u32 s69, s65, s46
    s_xor_b32 s68, s69, 0x2000
    s_sub_u32 s65, 4194304, s65
    s_add_u32 s70, s65, s46
    s_mov_b32 s60, 0
    s_mov_b32 s71, s68
    s_mov_b32 s72, s69
    s_mov_b32 s73, s70
    v_lshlrev_b32 v1, 4, v0
    s_cmp_eq_u32 s57, 14
    s_cbranch_scc1 L_PF
    s_cmp_ge_u32 s57, 10
    s_cbranch_scc1 L_PZ
L_S2:
    s_cmp_ge_u32 s52, 4
    s_cbranch_scc1 L_S2_red
    s_mul_i32 s62, s52, 2560
    s_add_u32 s62, s62, 16384
    s_cmp_eq_u32 s52, 3
    s_cselect_b32 s62, 5120, s62
    v_and_b32 v8, 7, v0
    v_lshlrev_b32 v8, 4, v8
    v_add_u32 v8, s62, v8
    v_lshrrev_b32 v9, 4, v0
    v_lshl_add_u32 v10, v9, 7, v8
    v_mul_u32_u24 v9, 640, v9
    v_add_u32 v11, v8, v9
    v_add_u32 v11, 512, v11
    v_bfe_u32 v9, v0, 3, 1
    v_mul_u32_u24 v9, 640, v9
    v_add_u32 v10, v10, v9
    v_and_b32 v8, 8, v0
    v_lshlrev_b32 v8, 10, v8
    v_xor_b32 v8, s46, v8
    v_xor_b32 v8, 0x2000, v8
    v_add_u32 v11, v11, v8
    v_and_b32 v14, 15, v0
    v_lshlrev_b32 v14, 5, v14
    v_lshrrev_b32 v8, 4, v0
    v_lshl_add_u32 v14, v8, 3, v14
    s_lshl_b32 s63, s52, 11
    s_add_u32 s63, s63, 32768
    v_add_u32 v14, s63, v14
    s_mul_i32 s64, s56, 10
    s_add_u32 s64, s64, s57
    s_lshl_b32 s62, s64, 15
    s_lshl_b32 s63, s52, 10
    s_add_u32 s62, s62, s63
    s_lshl_b32 s63, s56, 12
    s_add_u32 s62, s62, s63
    v_add_u32 v12, s62, v1
    v_xor_b32 v13, 0x1000, v12
    s_lshl_b32 s65, s56, 2
    s_add_u32 s65, s65, s52
    s_lshl_b32 s65, s65, 2
    s_lshl_b32 s64, s64, 1
    s_lshr_b32 s62, s65, 4
    s_mul_i32 s90, s62, 2138112
    s_bfe_u32 s62, s65, 0x10003
    s_mul_i32 s62, s62, 24576
    s_xor_b32 s90, s90, s62
    s_and_b32 s62, s65, 7
    s_lshl_b32 s62, s62, 10
    s_add_u32 s90, s90, s62
    s_and_b32 s62, s64, 31
    s_lshl_b32 s62, s62, 16
    s_add_u32 s90, s90, s62
    s_lshl_b32 s62, s64, 22
    s_add_u32 s90, s90, s62
    s_add_u32 s90, s90, 83886080
    s_mov_b32 s78, s90
    v_and_b32 v15, 3, v0
    v_bfe_u32 v8, v0, 2, 1
    v_lshl_add_u32 v15, v8, 4, v15
    v_lshlrev_b32 v15, 8, v15
    s_lshl_b32 s62, s52, 10
    s_add_u32 s62, s62, 2375680
    v_add_u32 v15, s62, v15
    v_mov_b32 v6, 0
    v_mov_b32 v7, 0
    s_barrier
    s_mov_b32 s66, 0
    s_mov_b32 s89, s59
    s_lshr_b32 s67, s66, 0
Lfw_9:
    v_cmp_ge_u32 vcc, s67, v6
    s_cbranch_vccz Lfwd_10
    s_sleep 2
    buffer_load_dword v6, v15, s[4:7], 0 offen offset:0 sc1
    s_waitcnt vmcnt(0)
    s_sub_u32 s89, s89, 1
    s_cbranch_scc0 Lfw_9
    s_mov_b32 s59, 0
Lfwd_10:
L_S2_loop:
    s_mov_b32 s66, s60
    s_mov_b32 s89, s59
    s_lshr_b32 s67, s66, 0
Lfw_11:
    v_cmp_ge_u32 vcc, s67, v6
    s_cbranch_vccz Lfwd_12
    buffer_load_dword v6, v15, s[4:7], 0 offen offset:0 sc1
    s_waitcnt vmcnt(0)
    s_sub_u32 s89, s89, 1
    s_cbranch_scc0 Lfw_11
    s_mov_b32 s59, 0
Lfwd_12:
    s_xor_b32 s62, s78, 0
    buffer_load_dwordx4 a[0:3], v1, s[4:7], s62 offen offset:0 sc1
    buffer_load_dwordx4 a[4:7], v1, s[4:7], s62 offen offset:1024 sc1
    buffer_load_dwordx4 a[8:11], v1, s[4:7], s62 offen offset:2048 sc1
    buffer_load_dwordx4 a[12:15], v1, s[4:7], s62 offen offset:3072 sc1
    s_xor_b32 s62, s78, 2138112
    buffer_load_dwordx4 a[16:19], v1, s[4:7], s62 offen offset:0 sc1
    buffer_load_dwordx4 a[20:23], v1, s[4:7], s62 offen offset:1024 sc1
    buffer_load_dwordx4 a[24:27], v1, s[4:7], s62 offen offset:2048 sc1
    buffer_load_dwordx4 a[28:31], v1, s[4:7], s62 offen offset:3072 sc1
    s_xor_b32 s62, s78, 4259840
    buffer_load_dwordx4 a[32:35], v1, s[4:7], s62 offen offset:0 sc1
    buffer_load_dwordx4 a[36:39], v1, s[4:7], s62 offen offset:1024 sc1
    buffer_load_dwordx4 a[40:43], v1, s[4:7], s62 offen offset:2048 sc1
    buffer_load_dwordx4 a[44:47], v1, s[4:7], s62 offen offset:3072 sc1
    s_xor_b32 s62, s78, 6397952
    buffer_load_dwordx4 a[48:51], v1, s[4:7], s62 offen offset:0 sc1
    buffer_load_dwordx4 a[52:55], v1, s[4:7], s62 offen offset:1024 sc1
    buffer_load_dwordx4 a[56:59], v1, s[4:7], s62 offen offset:2048 sc1
    buffer_load_dwordx4 a[60:63], v1, s[4:7], s62 offen offset:3072 sc1
    buffer_load_dword v6, v15, s[4:7], 0 offen offset:0 sc1
    s_add_u32 s78, s60, 1
    s_lshl_b32 s78, s78, 15
    s_xor_b32 s78, s78, s90
    s_cmp_lg_u32 s60, 12
    s_cbranch_scc1 Lpz_13
    v_and_b32 v9, 7, v0
    v_lshlrev_b32 v9, 8, v9
    v_add_u32 v9, 2375808, v9
    s_mov_b32 s89, s59
Lpz_14:
    buffer_load_dword v8, v9, s[4:7], 0 offen sc1
    s_waitcnt vmcnt(0)
    v_cmp_eq_u32 vcc, 0, v8
    s_cbranch_vccz Lpz_13
    s_sub_u32 s89, s89, 1
    s_cbranch_scc0 Lpz_14
    s_mov_b32 s59, 0
Lpz_13:
    s_mul_i32 s62, s60, 43
    s_lshr_b32 s62, s62, 7
    s_and_b32 s79, s62, 1
    s_lshl_b32 s79, s79, 13
    s_xor_b32 s79, s79, s46
    s_lshl_b32 s62, s62, 17
    s_add_u32 s79, s79, s62
    s_mul_i32 s62, s60, 655360
    s_add_u32 s79, s79, s62
    s_add_u32 s79, s79, 37748736
    s_andn2_b32 s63, s71, 0x2000
    s_add_u32 s64, s79, 16384
    s_setprio 3
    s_barrier
    buffer_load_dwordx4 v[16:19], v10, s[4:7], s71 offen sc1
    buffer_load_dwordx4 v[20:23], v10, s[4:7], s71 offen offset:1280 sc1
    s_setprio 2
    buffer_load_dwordx4 v[24:27], v10, s[4:7], s72 offen sc1
    buffer_load_dwordx4 v[28:31], v10, s[4:7], s72 offen offset:1280 sc1
    buffer_load_dwordx4 v[32:35], v11, s[4:7], s63 offen sc1
    s_setprio 1
    buffer_load_dwordx4 v[36:39], v12, s[4:7], s79 offen sc1
    buffer_load_dwordx4 v[40:43], v13, s[4:7], s79 offen sc1
    buffer_load_dwordx4 v[44:47], v12, s[4:7], s64 offen sc1
    buffer_load_dwordx4 v[48:51], v13, s[4:7], s64 offen sc1
    s_setprio 0
    s_waitcnt vmcnt(7)
Lck_15:
    v_mfma_f32_16x16x32_bf16 v[52:55], a[0:3], v[16:19], 0
    v_mfma_f32_16x16x32_bf16 v[56:59], a[4:7], v[16:19], 0
    v_mfma_f32_16x16x32_bf16 v[60:63], a[32:35], v[16:19], 0
    v_mfma_f32_16x16x32_bf16 v[64:67], a[36:39], v[16:19], 0
    v_mfma_f32_16x16x32_bf16 v[52:55], a[8:11], v[20:23], v[52:55]
    v_mfma_f32_16x16x32_bf16 v[56:59], a[12:15], v[20:23], v[56:59]
    v_mfma_f32_16x16x32_bf16 v[60:63], a[40:43], v[20:23], v[60:63]
    v_mfma_f32_16x16x32_bf16 v[64:67], a[44:47], v[20:23], v[64:67]
    v_max_u32 v8, v16, v17
    v_max3_u32 v8, v8, v18, v19
    v_max3_u32 v8, v8, v20, v21
    v_max3_u32 v8, v8, v22, v23
    v_cmp_eq_u32 vcc, -1, v8
    s_cbranch_vccnz Lrt_16
Lckd_17:
    s_waitcnt vmcnt(4)
Lck_18:
    v_mfma_f32_16x16x32_bf16 v[68:71], a[16:19], v[24:27], v[52:55]
    v_mfma_f32_16x16x32_bf16 v[72:75], a[20:23], v[24:27], v[56:59]
    v_mfma_f32_16x16x32_bf16 v[76:79], a[48:51], v[24:27], v[60:63]
    v_mfma_f32_16x16x32_bf16 v[80:83], a[52:55], v[24:27], v[64:67]
    v_mfma_f32_16x16x32_bf16 v[68:71], a[24:27], v[28:31], v[68:71]
    v_mfma_f32_16x16x32_bf16 v[72:75], a[28:31], v[28:31], v[72:75]
    v_mfma_f32_16x16x32_bf16 v[76:79], a[56:59], v[28:31], v[76:79]
    v_mfma_f32_16x16x32_bf16 v[80:83], a[60:63], v[28:31], v[80:83]
    v_max_u32 v8, v24, v25
    v_max3_u32 v8, v8, v26, v27
    v_max3_u32 v8, v8, v28, v29
    v_max3_u32 v8, v8, v30, v31
    v_max3_u32 v8, v8, v32, v33
    v_max3_u32 v8, v8, v34, v35
    v_cmp_eq_u32 vcc, -1, v8
    s_cbranch_vccnz Lrt_19
Lckd_20:
    s_waitcnt vmcnt(0)
Lck_21:
    v_mfma_f32_16x16x32_bf16 v[52:55], v[36:39], v[32:35], v[68:71]
    v_mfma_f32_16x16x32_bf16 v[56:59], v[40:43], v[32:35], v[72:75]
    v_mfma_f32_16x16x32_bf16 v[60:63], v[44:47], v[32:35], v[76:79]
    v_mfma_f32_16x16x32_bf16 v[64:67], v[48:51], v[32:35], v[80:83]
    v_max_u32 v8, v36, v37
    v_max3_u32 v8, v8, v38, v39
    v_max3_u32 v8, v8, v40, v41
    v_max3_u32 v8, v8, v42, v43
    v_max3_u32 v8, v8, v44, v45
    v_max3_u32 v8, v8, v46, v47
    v_max3_u32 v8, v8, v48, v49
    v_max3_u32 v8, v8, v50, v51
    v_cmp_eq_u32 vcc, -1, v8
    v_add_f32_dpp v52, v56, v52 row_shl:8 row_mask:0xf bank_mask:0xf
    v_add_f32_dpp v53, v57, v53 row_shl:8 row_mask:0xf bank_mask:0xf
    v_add_f32_dpp v54, v58, v54 row_shl:8 row_mask:0xf bank_mask:0xf
    v_add_f32_dpp v55, v59, v55 row_shl:8 row_mask:0xf bank_mask:0xf
    ds_write2st64_b64 v14, v[52:53], v[54:55] offset0:0 offset1:1
    v_add_f32_dpp v60, v64, v60 row_shl:8 row_mask:0xf bank_mask:0xf
    v_add_f32_dpp v61, v65, v61 row_shl:8 row_mask:0xf bank_mask:0xf
    v_add_f32_dpp v62, v66, v62 row_shl:8 row_mask:0xf bank_mask:0xf
    v_add_f32_dpp v63, v67, v63 row_shl:8 row_mask:0xf bank_mask:0xf
    ds_write2st64_b64 v14, v[60:61], v[62:63] offset0:2 offset1:3
    s_cbranch_vccnz Lrt_22
Lckd_23:
    s_waitcnt lgkmcnt(0)
    s_barrier
    s_barrier
    s_add_u32 s60, s60, 1
    s_add_u32 s71, s71, 32768
    s_add_u32 s72, s72, 32768
    s_add_u32 s73, s73, 32768
    s_cmp_lt_u32 s60, 63
    s_cbranch_scc1 L_S2_loop
    s_branch L_end
Lrt_16:
    s_sub_u32 s59, s59, 1
    s_cbranch_scc0 Lrg_24
    s_mov_b32 s59, 0
    s_branch Lckd_17
Lrg_24:
    s_nop 7
    buffer_load_dwordx4 v[16:19], v10, s[4:7], s71 offen sc1
    buffer_load_dwordx4 v[20:23], v10, s[4:7], s71 offen offset:1280 sc1
    s_waitcnt vmcnt(0)
    s_branch Lck_15
Lrt_19:
    s_sub_u32 s59, s59, 1
    s_cbranch_scc0 Lrg_25
    s_mov_b32 s59, 0
    s_branch Lckd_20
Lrg_25:
    s_nop 7
    buffer_load_dwordx4 v[24:27], v10, s[4:7], s72 offen sc1
    buffer_load_dwordx4 v[28:31], v10, s[4:7], s72 offen offset:1280 sc1
    buffer_load_dwordx4 v[32:35], v11, s[4:7], s63 offen sc1
    s_waitcnt vmcnt(0)
    s_branch Lck_18
Lrt_22:
    s_sub_u32 s59, s59, 1
    s_cbranch_scc0 Lrg_26
    s_mov_b32 s59, 0
    s_branch Lckd_23
Lrg_26:
    s_waitcnt lgkmcnt(0)
    s_nop 7
    buffer_load_dwordx4 v[36:39], v12, s[4:7], s79 offen sc1
    buffer_load_dwordx4 v[40:43], v13, s[4:7], s79 offen sc1
    buffer_load_dwordx4 v[44:47], v12, s[4:7], s64 offen sc1
    buffer_load_dwordx4 v[48:51], v13, s[4:7], s64 offen sc1
    s_waitcnt vmcnt(0)
    s_branch Lck_21
L_S2_red:
    s_setprio 3
    s_cmp_lg_u32 s52, 4
    s_cbranch_scc1 L_S2_r567
    v_and_b32 v12, 15, v0
    v_lshlrev_b32 v12, 2, v12
    v_add_u32 v12, 7680, v12
    s_add_u32 s64, s46, 8388608
    s_sub_u32 s64, s64, s68
    v_and_b32 v8, 15, v0
    v_lshlrev_b32 v8, 7, v8
    v_add_u32 v8, s64, v8
    s_lshl_b32 s62, s57, 2
    s_add_u32 s62, s62, 7936
    v_mov_b32 v13, s62
    v_mov_b32 v14, 0
    s_cmp_lg_u32 s61, 0
    s_cbranch_scc1 L_S2_w4_i
    s_barrier
L_S2_w4_p:
    v_add_u32 v14, 1, v14
    s_mov_b32 s89, s59
    buffer_load_dword v28, v12, s[4:7], s68 offen sc1
    s_nop 12
    buffer_load_dword v29, v12, s[4:7], s68 offen sc1
    s_nop 12
    buffer_load_dword v30, v12, s[4:7], s68 offen sc1
    s_nop 12
    buffer_load_dword v31, v12, s[4:7], s68 offen sc1
Lcue_27:
    s_waitcnt vmcnt(3)
    v_cmp_gt_i32 vcc, s60, v28
    s_cbranch_vccz Lcued_28
    buffer_load_dword v28, v12, s[4:7], s68 offen sc1
    s_waitcnt vmcnt(3)
    v_cmp_gt_i32 vcc, s60, v29
    s_cbranch_vccz Lcued_28
    buffer_load_dword v29, v12, s[4:7], s68 offen sc1
    s_waitcnt vmcnt(3)
    v_cmp_gt_i32 vcc, s60, v30
    s_cbranch_vccz Lcued_28
    buffer_load_dword v30, v12, s[4:7], s68 offen sc1
    s_waitcnt vmcnt(3)
    v_cmp_gt_i32 vcc, s60, v31
    s_cbranch_vccz Lcued_28
    buffer_load_dword v31, v12, s[4:7], s68 offen sc1
    s_sub_u32 s89, s89, 1
    s_cbranch_scc0 Lcue_27
    s_mov_b32 s59, 0
Lcued_28:
    s_barrier
    s_barrier
    s_nop 15
    s_mov_b64 exec, 1
    buffer_store_dword v14, v13, s[4:7], s68 offen
    s_mov_b64 exec, -1
    s_barrier
    s_add_u32 s60, s60, 1
    s_cmp_lt_u32 s60, 63
    s_cbranch_scc1 L_S2_w4_p
    s_branch L_end
L_S2_w4_i:
    s_barrier
L_S2_w4_q:
    v_add_u32 v14, 1, v14
    s_mov_b32 s89, s59
    buffer_load_dword v28, v12, s[4:7], s68 offen sc1
    s_nop 12
    buffer_load_dword v29, v12, s[4:7], s68 offen sc1
    s_nop 12
    buffer_load_dword v30, v12, s[4:7], s68 offen sc1
    s_nop 12
    buffer_load_dword v31, v12, s[4:7], s68 offen sc1
Lcue_29:
    s_waitcnt vmcnt(3)
    v_cmp_gt_i32 vcc, s60, v28
    s_cbranch_vccz Lcued_30
    buffer_load_dword v28, v12, s[4:7], s68 offen sc1
    s_waitcnt vmcnt(3)
    v_cmp_gt_i32 vcc, s60, v29
    s_cbranch_vccz Lcued_30
    buffer_load_dword v29, v12, s[4:7], s68 offen sc1
    s_waitcnt vmcnt(3)
    v_cmp_gt_i32 vcc, s60, v30
    s_cbranch_vccz Lcued_30
    buffer_load_dword v30, v12, s[4:7], s68 offen sc1
    s_waitcnt vmcnt(3)
    v_cmp_gt_i32 vcc, s60, v31
    s_cbranch_vccz Lcued_30
    buffer_load_dword v31, v12, s[4:7], s68 offen sc1
    s_sub_u32 s89, s89, 1
    s_cbranch_scc0 Lcue_29
    s_mov_b32 s59, 0
Lcued_30:
    s_barrier
    s_barrier
    s_nop 15
    s_mov_b64 exec, 1
    buffer_store_dword v14, v13, s[4:7], s68 offen sc1
    s_mov_b64 exec, -1
    s_barrier
    s_add_u32 s60, s60, 1
    s_cmp_lt_u32 s60, 63
    s_cbranch_scc1 L_S2_w4_q
    s_branch L_end
L_S2_r567:
    v_lshrrev_b32 v10, 4, v0
    v_lshlrev_b32 v10, 9, v10
    v_and_b32 v8, 15, v0
    v_lshl_add_u32 v10, v8, 4, v10
    s_lshl_b32 s62, s57, 9
    v_lshlrev_b32 v11, 3, v0
    v_add_u32 v11, s62, v11
    s_lshl_b32 s76, s56, 14
    s_add_u32 s76, s76, s46
    s_add_u32 s76, s76, 8390656
    s_cmp_eq_u32 s52, 6
    s_cselect_b32 s76, s73, s76
    s_cmp_eq_u32 s52, 5
    s_cselect_b32 s76, s71, s76
    s_mov_b32 s12, s18
    s_and_b32 s13, s19, 0xffff
    s_mov_b32 s14, 10240
    s_mov_b32 s15, 0x00020000
    v_bfe_u32 v8, v0, 1, 3
    v_mul_u32_u24 v8, 1280, v8
    v_and_b32 v9, 1, v0
    v_lshl_add_u32 v8, v9, 4, v8
    v_bfe_u32 v9, v0, 4, 1
    v_lshl_add_u32 v8, v9, 2, v8
    v_and_b32 v9, 32, v0
    v_add_u32 v8, v8, v9
    s_mul_i32 s62, s56, 10
    s_add_u32 s62, s62, s57
    s_lshl_b32 s62, s62, 6
    buffer_load_dword v16, v8, s[12:15], s62 offen
    buffer_load_dword v17, v8, s[12:15], s62 offen offset:8
    s_waitcnt vmcnt(0)
    v_min_u32 v16, -2, v16
    v_min_u32 v17, -2, v17
    s_cmp_ge_u32 s52, 6
    s_cbranch_scc1 L_S2_rem
    s_lshl_b32 s62, s57, 2
    s_add_u32 s62, s62, 7936
    v_mov_b32 v13, s62
    v_mov_b32 v14, 0
    s_cmp_lg_u32 s61, 0
    s_cbranch_scc1 L_S2_w5_i
    buffer_store_dwordx2 v[16:17], v11, s[4:7], s76 offen
    s_mov_b64 exec, 1
    buffer_store_dword v14, v13, s[4:7], s68 offen
    s_mov_b64 exec, -1
    s_barrier
L_S2_w5_p:
    s_add_u32 s76, s76, 32768
    v_add_u32 v14, 1, v14
    s_barrier
    s_barrier
    ds_read_b128 v[16:19], v10 offset:32768
    ds_read_b128 v[20:23], v10 offset:34816
    ds_read_b128 v[24:27], v10 offset:36864
    ds_read_b128 v[28:31], v10 offset:38912
    s_waitcnt lgkmcnt(2)
    v_pk_add_f32 v[16:17], v[16:17], v[20:21]
    v_pk_add_f32 v[18:19], v[18:19], v[22:23]
    s_waitcnt lgkmcnt(0)
    v_pk_add_f32 v[24:25], v[24:25], v[28:29]
    v_pk_add_f32 v[26:27], v[26:27], v[30:31]
    v_pk_add_f32 v[16:17], v[16:17], v[24:25]
    v_pk_add_f32 v[18:19], v[18:19], v[26:27]
    v_cvt_pk_bf16_f32 v16, v16, v17
    v_cvt_pk_bf16_f32 v17, v18, v19
    buffer_store_dwordx2 v[16:17], v11, s[4:7], s76 offen
    s_barrier
    s_add_u32 s60, s60, 1
    s_cmp_lt_u32 s60, 63
    s_cbranch_scc1 L_S2_w5_p
    s_branch L_end
L_S2_w5_i:
    buffer_store_dwordx2 v[16:17], v11, s[4:7], s76 offen sc1
    s_mov_b64 exec, 1
    buffer_store_dword v14, v13, s[4:7], s68 offen sc1
    s_mov_b64 exec, -1
    s_barrier
L_S2_w5_q:
    s_add_u32 s76, s76, 32768
    v_add_u32 v14, 1, v14
    s_barrier
    s_barrier
    ds_read_b128 v[16:19], v10 offset:32768
    ds_read_b128 v[20:23], v10 offset:34816
    ds_read_b128 v[24:27], v10 offset:36864
    ds_read_b128 v[28:31], v10 offset:38912
    s_waitcnt lgkmcnt(2)
    v_pk_add_f32 v[16:17], v[16:17], v[20:21]
    v_pk_add_f32 v[18:19], v[18:19], v[22:23]
    s_waitcnt lgkmcnt(0)
    v_pk_add_f32 v[24:25], v[24:25], v[28:29]
    v_pk_add_f32 v[26:27], v[26:27], v[30:31]
    v_pk_add_f32 v[16:17], v[16:17], v[24:25]
    v_pk_add_f32 v[18:19], v[18:19], v[26:27]
    v_cvt_pk_bf16_f32 v16, v16, v17
    v_cvt_pk_bf16_f32 v17, v18, v19
    buffer_store_dwordx2 v[16:17], v11, s[4:7], s76 offen sc1
    s_barrier
    s_add_u32 s60, s60, 1
    s_cmp_lt_u32 s60, 63
    s_cbranch_scc1 L_S2_w5_q
    s_branch L_end
L_S2_rem:
    buffer_store_dwordx2 v[16:17], v11, s[4:7], s76 offen sc1
    s_barrier
L_S2_w67:
    s_add_u32 s76, s76, 32768
    s_barrier
    s_barrier
    ds_read_b128 v[16:19], v10 offset:32768
    ds_read_b128 v[20:23], v10 offset:34816
    ds_read_b128 v[24:27], v10 offset:36864
    ds_read_b128 v[28:31], v10 offset:38912
    s_waitcnt lgkmcnt(2)
    v_pk_add_f32 v[16:17], v[16:17], v[20:21]
    v_pk_add_f32 v[18:19], v[18:19], v[22:23]
    s_waitcnt lgkmcnt(0)
    v_pk_add_f32 v[24:25], v[24:25], v[28:29]
    v_pk_add_f32 v[26:27], v[26:27], v[30:31]
    v_pk_add_f32 v[16:17], v[16:17], v[24:25]
    v_pk_add_f32 v[18:19], v[18:19], v[26:27]
    v_cvt_pk_bf16_f32 v16, v16, v17
    v_cvt_pk_bf16_f32 v17, v18, v19
    buffer_store_dwordx2 v[16:17], v11, s[4:7], s76 offen sc1
    s_barrier
    s_add_u32 s60, s60, 1
    s_cmp_lt_u32 s60, 63
    s_cbranch_scc1 L_S2_w67
    s_branch L_end
L_PF:
    s_cmp_ge_u32 s52, 2
    s_cbranch_scc1 L_end
    s_lshl_b32 s79, s52, 14
    s_add_u32 s79, s79, s68
    v_lshlrev_b32 v10, 7, v0
    v_mov_b32 v14, 7936
L_PF_loop:
    s_sub_u32 s66, s60, 2
    s_cmp_lt_i32 s66, 0
    s_cbranch_scc1 Lpwd_32
    s_mov_b32 s89, s59
Lpw_31:
    buffer_load_dword v9, v14, s[4:7], s68 offen sc1
    s_waitcnt vmcnt(0)
    v_cmp_gt_i32 vcc, s66, v9
    s_cbranch_vccz Lpwd_32
    s_sleep 4
    s_sub_u32 s89, s89, 1
    s_cbranch_scc0 Lpw_31
    s_mov_b32 s59, 0
Lpwd_32:
    buffer_load_dword v16, v10, s[4:7], s79 offen sc1
    s_add_u32 s79, s79, 32768
    s_add_u32 s60, s60, 1
    s_cmp_lt_u32 s60, 64
    s_cbranch_scc1 L_PF_loop
    s_branch L_end
L_PZ:
    v_mov_b32 v10, 2359296
    s_mov_b32 s89, s59
    s_cmp_lg_u32 s52, 0
    s_cbranch_scc1 Lpl_34
Lpl_33:
    buffer_load_dword v11, v10, s[4:7], 0 offen sc1
    s_waitcnt vmcnt(0)
    v_cmp_eq_u32 vcc, 0, v11
    s_cbranch_vccz Lpl_34
    s_sleep 16
    s_sub_u32 s89, s89, 1
    s_cbranch_scc0 Lpl_33
Lpl_34:
    s_barrier
    v_mov_b32 v4, -1
    v_mov_b32 v5, -1
    v_mov_b32 v6, -1
    v_mov_b32 v7, -1
    s_lshl_b32 s64, s56, 2
    s_add_u32 s64, s64, s57
    s_sub_u32 s64, s64, 10
    s_add_u32 s78, s64, 16
    s_lshl_b32 s78, s78, 15
    s_lshl_b32 s65, s52, 12
    s_min_u32 s66, s52, 4
    s_lshl_b32 s66, s66, 10
    s_add_u32 s66, s66, s46
    s_add_u32 s66, s66, 8390656
L_PZ_loop:
    s_add_u32 s62, s78, s65
    s_add_u32 s63, s62, 4194304
    buffer_store_dwordx4 v[4:7], v1, s[4:7], s62 offen offset:0 sc1
    buffer_store_dwordx4 v[4:7], v1, s[4:7], s62 offen offset:1024 sc1
    buffer_store_dwordx4 v[4:7], v1, s[4:7], s62 offen offset:2048 sc1
    buffer_store_dwordx4 v[4:7], v1, s[4:7], s62 offen offset:3072 sc1
    buffer_store_dwordx4 v[4:7], v1, s[4:7], s63 offen offset:0 sc1
    buffer_store_dwordx4 v[4:7], v1, s[4:7], s63 offen offset:1024 sc1
    buffer_store_dwordx4 v[4:7], v1, s[4:7], s63 offen offset:2048 sc1
    buffer_store_dwordx4 v[4:7], v1, s[4:7], s63 offen offset:3072 sc1
    s_add_u32 s62, s78, s66
    s_add_u32 s63, s62, 16384
    buffer_store_dwordx4 v[4:7], v1, s[4:7], s62 offen sc1
    buffer_store_dwordx4 v[4:7], v1, s[4:7], s63 offen sc1
    s_add_u32 s78, s78, 262144
    s_cmp_lt_u32 s78, 2097152
    s_cbranch_scc1 L_PZ_loop
    s_waitcnt vmcnt(0)
    s_barrier
    s_cmp_lg_u32 s52, 0
    s_cbranch_scc1 Lpzd_35
    s_lshl_b32 s64, s64, 8
    s_add_u32 s64, s64, 2375808
    v_mov_b32 v8, 1
    v_mov_b32 v9, s64
    s_mov_b64 exec, 1
    buffer_store_dword v8, v9, s[4:7], 0 offen sc1
    s_mov_b64 exec, -1
Lpzd_35:
    s_branch L_end
L_RQK:
    s_lshl_b32 s55, s56, 4
    s_add_u32 s55, s55, s54
    v_lshrrev_b32 v14, 4, v0
    v_bfe_u32 v10, v0, 1, 3
    v_xor_b32 v10, v10, v14
    v_lshlrev_b32 v10, 5, v10
    v_and_b32 v14, 1, v0
    v_lshl_add_u32 v10, v14, 4, v10
    v_lshrrev_b32 v14, 4, v0
    v_mul_u32_u24 v14, 8192, v14
    v_add_u32 v10, v10, v14
    v_lshrrev_b32 v14, 4, v0
    v_or_b32 v14, 4, v14
    v_bfe_u32 v11, v0, 1, 3
    v_xor_b32 v11, v11, v14
    v_lshlrev_b32 v11, 5, v11
    v_and_b32 v14, 1, v0
    v_lshl_add_u32 v11, v14, 4, v11
    v_lshrrev_b32 v14, 4, v0
    v_mul_u32_u24 v14, 8192, v14
    v_add_u32 v11, v11, v14
    v_bfe_u32 v12, v0, 2, 3
    v_xor_b32 v12, s52, v12
    v_lshlrev_b32 v12, 5, v12
    v_and_b32 v14, 3, v0
    v_lshl_add_u32 v12, v14, 3, v12
    v_bfe_u32 v14, v0, 2, 2
    v_lshl_add_u32 v12, v14, 8, v12
    v_lshrrev_b32 v14, 4, v0
    v_lshl_add_u32 v12, v14, 11, v12
    s_mov_b32 s12, s20
    s_and_b32 s13, s21, 0xffff
    s_mov_b32 s14, 5242880
    s_mov_b32 s15, 0x00020000
    s_lshl_b32 s62, s52, 4
    s_add_u32 s62, s62, 0
    s_mul_i32 s63, s56, 320
    s_add_u32 s62, s62, s63
    s_cmp_ge_u32 s62, 640
    s_cselect_b32 s63, 640, 0
    s_sub_u32 s62, s62, s63
    s_lshl_b32 s62, s62, 13
    s_lshl_b32 s63, s55, 8
    s_add_u32 s62, s62, s63
    s_lshl_b32 s63, s52, 12
    s_add_u32 s63, s63, 65536
    s_mov_b32 m0, s63
    s_nop 0
    buffer_load_dwordx4 v10, s[12:15], s62 offen lds
    s_add_u32 s62, s62, 32768
    s_add_u32 s63, s63, 1024
    s_mov_b32 m0, s63
    s_nop 0
    buffer_load_dwordx4 v10, s[12:15], s62 offen lds
    s_add_u32 s62, s62, 32768
    s_add_u32 s63, s63, 1024
    s_mov_b32 m0, s63
    s_nop 0
    buffer_load_dwordx4 v11, s[12:15], s62 offen lds
    s_add_u32 s62, s62, 32768
    s_add_u32 s63, s63, 1024
    s_mov_b32 m0, s63
    s_nop 0
    buffer_load_dwordx4 v11, s[12:15], s62 offen lds
    s_waitcnt vmcnt(4)
    s_barrier
    s_or_b32 s62, s52, s30
    s_cbranch_scc1 Lci_36
    s_lshl_b32 s62, 1, s54
    s_lshl_b32 s63, s53, 5
    v_mov_b32 v20, s62
    v_mov_b32 v14, s63
    s_mov_b64 exec, 1
    buffer_atomic_or v20, v14, s[8:11], 0 offen sc0
    s_mov_b64 exec, -1
Lci_36:
    v_min_u32 v23, 7, v0
    v_lshlrev_b32 v23, 5, v23
    s_lshl_b32 s62, s52, 4
    s_add_u32 s62, s62, 128
    s_mul_i32 s63, s56, 320
    s_add_u32 s62, s62, s63
    s_cmp_ge_u32 s62, 640
    s_cselect_b32 s63, 640, 0
    s_sub_u32 s62, s62, s63
    s_lshl_b32 s62, s62, 13
    s_lshl_b32 s63, s55, 8
    s_add_u32 s62, s62, s63
    s_lshl_b32 s63, s52, 12
    s_add_u32 s63, s63, 98304
    s_mov_b32 m0, s63
    s_nop 0
    buffer_load_dwordx4 v10, s[12:15], s62 offen lds
    s_add_u32 s62, s62, 32768
    s_add_u32 s63, s63, 1024
    s_mov_b32 m0, s63
    s_nop 0
    buffer_load_dwordx4 v10, s[12:15], s62 offen lds
    s_add_u32 s62, s62, 32768
    s_add_u32 s63, s63, 1024
    s_mov_b32 m0, s63
    s_nop 0
    buffer_load_dwordx4 v11, s[12:15], s62 offen lds
    s_add_u32 s62, s62, 32768
    s_add_u32 s63, s63, 1024
    s_mov_b32 m0, s63
    s_nop 0
    buffer_load_dwordx4 v11, s[12:15], s62 offen lds
    s_lshl_b32 s62, s52, 4
    s_add_u32 s62, s62, 256
    s_mul_i32 s63, s56, 320
    s_add_u32 s62, s62, s63
    s_cmp_ge_u32 s62, 640
    s_cselect_b32 s63, 640, 0
    s_sub_u32 s62, s62, s63
    s_lshl_b32 s62, s62, 13
    s_lshl_b32 s63, s55, 8
    s_add_u32 s62, s62, s63
    s_lshl_b32 s63, s52, 12
    s_add_u32 s63, s63, 131072
    s_mov_b32 m0, s63
    s_nop 0
    buffer_load_dwordx4 v10, s[12:15], s62 offen lds
    s_add_u32 s62, s62, 32768
    s_add_u32 s63, s63, 1024
    s_mov_b32 m0, s63
    s_nop 0
    buffer_load_dwordx4 v10, s[12:15], s62 offen lds
    s_add_u32 s62, s62, 32768
    s_add_u32 s63, s63, 1024
    s_mov_b32 m0, s63
    s_nop 0
    buffer_load_dwordx4 v11, s[12:15], s62 offen lds
    s_add_u32 s62, s62, 32768
    s_add_u32 s63, s63, 1024
    s_mov_b32 m0, s63
    s_nop 0
    buffer_load_dwordx4 v11, s[12:15], s62 offen lds
    s_waitcnt vmcnt(8)
    s_barrier
    v_add_u32 v13, 65536, v12
    ds_read_b64_tr_b16 a[0:1], v13 offset:0
    ds_read_b64_tr_b16 a[2:3], v13 offset:1024
    ds_read_b64_tr_b16 a[4:5], v13 offset:8192
    ds_read_b64_tr_b16 a[6:7], v13 offset:9216
    ds_read_b64_tr_b16 a[8:9], v13 offset:16384
    ds_read_b64_tr_b16 a[10:11], v13 offset:17408
    ds_read_b64_tr_b16 a[12:13], v13 offset:24576
    ds_read_b64_tr_b16 a[14:15], v13 offset:25600
    s_waitcnt lgkmcnt(0)
    s_barrier
    s_lshl_b32 s62, s52, 4
    s_add_u32 s62, s62, 384
    s_mul_i32 s63, s56, 320
    s_add_u32 s62, s62, s63
    s_cmp_ge_u32 s62, 640
    s_cselect_b32 s63, 640, 0
    s_sub_u32 s62, s62, s63
    s_lshl_b32 s62, s62, 13
    s_lshl_b32 s63, s55, 8
    s_add_u32 s62, s62, s63
    s_lshl_b32 s63, s52, 12
    s_add_u32 s63, s63, 65536
    s_mov_b32 m0, s63
    s_nop 0
    buffer_load_dwordx4 v10, s[12:15], s62 offen lds
    s_add_u32 s62, s62, 32768
    s_add_u32 s63, s63, 1024
    s_mov_b32 m0, s63
    s_nop 0
    buffer_load_dwordx4 v10, s[12:15], s62 offen lds
    s_add_u32 s62, s62, 32768
    s_add_u32 s63, s63, 1024
    s_mov_b32 m0, s63
    s_nop 0
    buffer_load_dwordx4 v11, s[12:15], s62 offen lds
    s_add_u32 s62, s62, 32768
    s_add_u32 s63, s63, 1024
    s_mov_b32 m0, s63
    s_nop 0
    buffer_load_dwordx4 v11, s[12:15], s62 offen lds
    s_waitcnt vmcnt(8)
    s_barrier
    v_add_u32 v13, 98304, v12
    ds_read_b64_tr_b16 a[16:17], v13 offset:0
    ds_read_b64_tr_b16 a[18:19], v13 offset:1024
    ds_read_b64_tr_b16 a[20:21], v13 offset:8192
    ds_read_b64_tr_b16 a[22:23], v13 offset:9216
    ds_read_b64_tr_b16 a[24:25], v13 offset:16384
    ds_read_b64_tr_b16 a[26:27], v13 offset:17408
    ds_read_b64_tr_b16 a[28:29], v13 offset:24576
    ds_read_b64_tr_b16 a[30:31], v13 offset:25600
    s_waitcnt lgkmcnt(0)
    s_barrier
    s_lshl_b32 s62, s52, 4
    s_add_u32 s62, s62, 512
    s_mul_i32 s63, s56, 320
    s_add_u32 s62, s62, s63
    s_cmp_ge_u32 s62, 640
    s_cselect_b32 s63, 640, 0
    s_sub_u32 s62, s62, s63
    s_lshl_b32 s62, s62, 13
    s_lshl_b32 s63, s55, 8
    s_add_u32 s62, s62, s63
    s_lshl_b32 s63, s52, 12
    s_add_u32 s63, s63, 98304
    s_mov_b32 m0, s63
    s_nop 0
    buffer_load_dwordx4 v10, s[12:15], s62 offen lds
    s_add_u32 s62, s62, 32768
    s_add_u32 s63, s63, 1024
    s_mov_b32 m0, s63
    s_nop 0
    buffer_load_dwordx4 v10, s[12:15], s62 offen lds
    s_add_u32 s62, s62, 32768
    s_add_u32 s63, s63, 1024
    s_mov_b32 m0, s63
    s_nop 0
    buffer_load_dwordx4 v11, s[12:15], s62 offen lds
    s_add_u32 s62, s62, 32768
    s_add_u32 s63, s63, 1024
    s_mov_b32 m0, s63
    s_nop 0
    buffer_load_dwordx4 v11, s[12:15], s62 offen lds
    s_waitcnt vmcnt(8)
    s_barrier
    v_add_u32 v13, 131072, v12
    ds_read_b64_tr_b16 a[32:33], v13 offset:0
    ds_read_b64_tr_b16 a[34:35], v13 offset:1024
    ds_read_b64_tr_b16 a[36:37], v13 offset:8192
    ds_read_b64_tr_b16 a[38:39], v13 offset:9216
    ds_read_b64_tr_b16 a[40:41], v13 offset:16384
    ds_read_b64_tr_b16 a[42:43], v13 offset:17408
    ds_read_b64_tr_b16 a[44:45], v13 offset:24576
    ds_read_b64_tr_b16 a[46:47], v13 offset:25600
    s_waitcnt lgkmcnt(0)
    s_barrier
    s_mov_b32 s12, s22
    s_and_b32 s13, s23, 0xffff
    s_mov_b32 s14, 5242880
    s_mov_b32 s15, 0x00020000
    s_lshl_b32 s62, s52, 4
    s_add_u32 s62, s62, 0
    s_mul_i32 s63, s56, 320
    s_add_u32 s62, s62, s63
    s_cmp_ge_u32 s62, 640
    s_cselect_b32 s63, 640, 0
    s_sub_u32 s62, s62, s63
    s_lshl_b32 s62, s62, 13
    s_lshl_b32 s63, s55, 8
    s_add_u32 s62, s62, s63
    s_lshl_b32 s63, s52, 12
    s_add_u32 s63, s63, 131072
    s_mov_b32 m0, s63
    s_nop 0
    buffer_load_dwordx4 v10, s[12:15], s62 offen lds
    s_add_u32 s62, s62, 32768
    s_add_u32 s63, s63, 1024
    s_mov_b32 m0, s63
    s_nop 0
    buffer_load_dwordx4 v10, s[12:15], s62 offen lds
    s_add_u32 s62, s62, 32768
    s_add_u32 s63, s63, 1024
    s_mov_b32 m0, s63
    s_nop 0
    buffer_load_dwordx4 v11, s[12:15], s62 offen lds
    s_add_u32 s62, s62, 32768
    s_add_u32 s63, s63, 1024
    s_mov_b32 m0, s63
    s_nop 0
    buffer_load_dwordx4 v11, s[12:15], s62 offen lds
    s_waitcnt vmcnt(8)
    s_barrier
    v_add_u32 v13, 65536, v12
    ds_read_b64_tr_b16 a[48:49], v13 offset:0
    ds_read_b64_tr_b16 a[50:51], v13 offset:1024
    ds_read_b64_tr_b16 a[52:53], v13 offset:8192
    ds_read_b64_tr_b16 a[54:55], v13 offset:9216
    ds_read_b64_tr_b16 a[56:57], v13 offset:16384
    ds_read_b64_tr_b16 a[58:59], v13 offset:17408
    ds_read_b64_tr_b16 a[60:61], v13 offset:24576
    ds_read_b64_tr_b16 a[62:63], v13 offset:25600
    s_waitcnt lgkmcnt(0)
    s_barrier
    s_lshl_b32 s62, s52, 4
    s_add_u32 s62, s62, 128
    s_mul_i32 s63, s56, 320
    s_add_u32 s62, s62, s63
    s_cmp_ge_u32 s62, 640
    s_cselect_b32 s63, 640, 0
    s_sub_u32 s62, s62, s63
    s_lshl_b32 s62, s62, 13
    s_lshl_b32 s63, s55, 8
    s_add_u32 s62, s62, s63
    s_lshl_b32 s63, s52, 12
    s_add_u32 s63, s63, 65536
    s_mov_b32 m0, s63
    s_nop 0
    buffer_load_dwordx4 v10, s[12:15], s62 offen lds
    s_add_u32 s62, s62, 32768
    s_add_u32 s63, s63, 1024
    s_mov_b32 m0, s63
    s_nop 0
    buffer_load_dwordx4 v10, s[12:15], s62 offen lds
    s_add_u32 s62, s62, 32768
    s_add_u32 s63, s63, 1024
    s_mov_b32 m0, s63
    s_nop 0
    buffer_load_dwordx4 v11, s[12:15], s62 offen lds
    s_add_u32 s62, s62, 32768
    s_add_u32 s63, s63, 1024
    s_mov_b32 m0, s63
    s_nop 0
    buffer_load_dwordx4 v11, s[12:15], s62 offen lds
    s_waitcnt vmcnt(8)
    s_barrier
    v_add_u32 v13, 98304, v12
    ds_read_b64_tr_b16 a[64:65], v13 offset:0
    ds_read_b64_tr_b16 a[66:67], v13 offset:1024
    ds_read_b64_tr_b16 a[68:69], v13 offset:8192
    ds_read_b64_tr_b16 a[70:71], v13 offset:9216
    ds_read_b64_tr_b16 a[72:73], v13 offset:16384
    ds_read_b64_tr_b16 a[74:75], v13 offset:17408
    ds_read_b64_tr_b16 a[76:77], v13 offset:24576
    ds_read_b64_tr_b16 a[78:79], v13 offset:25600
    s_waitcnt lgkmcnt(0)
    s_barrier
    s_lshl_b32 s62, s52, 4
    s_add_u32 s62, s62, 256
    s_mul_i32 s63, s56, 320
    s_add_u32 s62, s62, s63
    s_cmp_ge_u32 s62, 640
    s_cselect_b32 s63, 640, 0
    s_sub_u32 s62, s62, s63
    s_lshl_b32 s62, s62, 13
    s_lshl_b32 s63, s55, 8
    s_add_u32 s62, s62, s63
    s_lshl_b32 s63, s52, 12
    s_add_u32 s63, s63, 98304
    s_mov_b32 m0, s63
    s_nop 0
    buffer_load_dwordx4 v10, s[12:15], s62 offen lds
    s_add_u32 s62, s62, 32768
    s_add_u32 s63, s63, 1024
    s_mov_b32 m0, s63
    s_nop 0
    buffer_load_dwordx4 v10, s[12:15], s62 offen lds
    s_add_u32 s62, s62, 32768
    s_add_u32 s63, s63, 1024
    s_mov_b32 m0, s63
    s_nop 0
    buffer_load_dwordx4 v11, s[12:15], s62 offen lds
    s_add_u32 s62, s62, 32768
    s_add_u32 s63, s63, 1024
    s_mov_b32 m0, s63
    s_nop 0
    buffer_load_dwordx4 v11, s[12:15], s62 offen lds
    s_waitcnt vmcnt(8)
    s_barrier
    buffer_load_dword v21, v23, s[8:11], 0 offen sc1
    v_add_u32 v13, 131072, v12
    ds_read_b64_tr_b16 a[80:81], v13 offset:0
    ds_read_b64_tr_b16 a[82:83], v13 offset:1024
    ds_read_b64_tr_b16 a[84:85], v13 offset:8192
    ds_read_b64_tr_b16 a[86:87], v13 offset:9216
    ds_read_b64_tr_b16 a[88:89], v13 offset:16384
    ds_read_b64_tr_b16 a[90:91], v13 offset:17408
    ds_read_b64_tr_b16 a[92:93], v13 offset:24576
    ds_read_b64_tr_b16 a[94:95], v13 offset:25600
    s_waitcnt lgkmcnt(0)
    s_barrier
    s_lshl_b32 s62, s52, 4
    s_add_u32 s62, s62, 384
    s_mul_i32 s63, s56, 320
    s_add_u32 s62, s62, s63
    s_cmp_ge_u32 s62, 640
    s_cselect_b32 s63, 640, 0
    s_sub_u32 s62, s62, s63
    s_lshl_b32 s62, s62, 13
    s_lshl_b32 s63, s55, 8
    s_add_u32 s62, s62, s63
    s_lshl_b32 s63, s52, 12
    s_add_u32 s63, s63, 131072
    s_mov_b32 m0, s63
    s_nop 0
    buffer_load_dwordx4 v10, s[12:15], s62 offen lds
    s_add_u32 s62, s62, 32768
    s_add_u32 s63, s63, 1024
    s_mov_b32 m0, s63
    s_nop 0
    buffer_load_dwordx4 v10, s[12:15], s62 offen lds
    s_add_u32 s62, s62, 32768
    s_add_u32 s63, s63, 1024
    s_mov_b32 m0, s63
    s_nop 0
    buffer_load_dwordx4 v11, s[12:15], s62 offen lds
    s_add_u32 s62, s62, 32768
    s_add_u32 s63, s63, 1024
    s_mov_b32 m0, s63
    s_nop 0
    buffer_load_dwordx4 v11, s[12:15], s62 offen lds
    s_waitcnt vmcnt(8)
    s_barrier
    v_add_u32 v13, 65536, v12
    ds_read_b64_tr_b16 a[96:97], v13 offset:0
    ds_read_b64_tr_b16 a[98:99], v13 offset:1024
    ds_read_b64_tr_b16 a[100:101], v13 offset:8192
    ds_read_b64_tr_b16 a[102:103], v13 offset:9216
    ds_read_b64_tr_b16 a[104:105], v13 offset:16384
    ds_read_b64_tr_b16 a[106:107], v13 offset:17408
    ds_read_b64_tr_b16 a[108:109], v13 offset:24576
    ds_read_b64_tr_b16 a[110:111], v13 offset:25600
    s_waitcnt lgkmcnt(0)
    s_barrier
    s_lshl_b32 s62, s52, 4
    s_add_u32 s62, s62, 512
    s_mul_i32 s63, s56, 320
    s_add_u32 s62, s62, s63
    s_cmp_ge_u32 s62, 640
    s_cselect_b32 s63, 640, 0
    s_sub_u32 s62, s62, s63
    s_lshl_b32 s62, s62, 13
    s_lshl_b32 s63, s55, 8
    s_add_u32 s62, s62, s63
    s_lshl_b32 s63, s52, 12
    s_add_u32 s63, s63, 65536
    s_mov_b32 m0, s63
    s_nop 0
    buffer_load_dwordx4 v10, s[12:15], s62 offen lds
    s_add_u32 s62, s62, 32768
    s_add_u32 s63, s63, 1024
    s_mov_b32 m0, s63
    s_nop 0
    buffer_load_dwordx4 v10, s[12:15], s62 offen lds
    s_add_u32 s62, s62, 32768
    s_add_u32 s63, s63, 1024
    s_mov_b32 m0, s63
    s_nop 0
    buffer_load_dwordx4 v11, s[12:15], s62 offen lds
    s_add_u32 s62, s62, 32768
    s_add_u32 s63, s63, 1024
    s_mov_b32 m0, s63
    s_nop 0
    buffer_load_dwordx4 v11, s[12:15], s62 offen lds
    s_waitcnt vmcnt(8)
    s_barrier
    v_add_u32 v13, 98304, v12
    ds_read_b64_tr_b16 a[112:113], v13 offset:0
    ds_read_b64_tr_b16 a[114:115], v13 offset:1024
    ds_read_b64_tr_b16 a[116:117], v13 offset:8192
    ds_read_b64_tr_b16 a[118:119], v13 offset:9216
    ds_read_b64_tr_b16 a[120:121], v13 offset:16384
    ds_read_b64_tr_b16 a[122:123], v13 offset:17408
    ds_read_b64_tr_b16 a[124:125], v13 offset:24576
    ds_read_b64_tr_b16 a[126:127], v13 offset:25600
    s_waitcnt lgkmcnt(0)
    s_waitcnt vmcnt(4)
    s_barrier
    buffer_load_dword v22, v23, s[8:11], 0 offen offset:4 sc1
    v_add_u32 v13, 131072, v12
    ds_read_b64_tr_b16 a[128:129], v13 offset:0
    ds_read_b64_tr_b16 a[130:131], v13 offset:1024
    ds_read_b64_tr_b16 a[132:133], v13 offset:8192
    ds_read_b64_tr_b16 a[134:135], v13 offset:9216
    ds_read_b64_tr_b16 a[136:137], v13 offset:16384
    ds_read_b64_tr_b16 a[138:139], v13 offset:17408
    ds_read_b64_tr_b16 a[140:141], v13 offset:24576
    ds_read_b64_tr_b16 a[142:143], v13 offset:25600
    s_waitcnt lgkmcnt(0)
    s_waitcnt vmcnt(0)
    s_barrier
    s_cmp_lg_u32 s52, 0
    s_cbranch_scc1 Llc_37
    v_readfirstlane_b32 s62, v20
    s_nop 0
    s_lshr_b32 s62, s62, s54
    s_andn2_b32 s62, s62, s30
    s_and_b32 s62, s62, 1
    v_cmp_ne_u32 vcc, -1, v21
    s_nop 0
    s_cmp_lg_u64 vcc, 0
    s_cselect_b32 s62, 1, s62
    v_mov_b32 v21, s62
    v_mov_b32 v23, 131072
    ds_write_b32 v23, v21
Llc_37:
    v_add_u32 v13, 65536, v12
    ds_read_b64_tr_b16 a[144:145], v13 offset:0
    ds_read_b64_tr_b16 a[146:147], v13 offset:1024
    ds_read_b64_tr_b16 a[148:149], v13 offset:8192
    ds_read_b64_tr_b16 a[150:151], v13 offset:9216
    ds_read_b64_tr_b16 a[152:153], v13 offset:16384
    ds_read_b64_tr_b16 a[154:155], v13 offset:17408
    ds_read_b64_tr_b16 a[156:157], v13 offset:24576
    ds_read_b64_tr_b16 a[158:159], v13 offset:25600
    s_waitcnt lgkmcnt(0)
    s_barrier
    v_mov_b32 v23, 131072
    ds_read_b32 v23, v23
    v_readlane_b32 s62, v22, 1
    v_readlane_b32 s63, v22, 2
    v_readlane_b32 s61, v22, 3
    s_waitcnt lgkmcnt(0)
    v_cmp_eq_u32 vcc, 0, v23
    s_cbranch_vccnz Llf_38
    v_min_u32 v15, 7, v0
    v_lshlrev_b32 v15, 5, v15
    s_cmp_lg_u32 s52, 0
    s_cbranch_scc1 Lwid_40
    s_mov_b32 s64, 0
    s_cmp_lg_u32 s30, 0
    s_cbranch_scc1 Lwok_41
    s_waitcnt vmcnt(0)
    v_readfirstlane_b32 s62, v20
    s_nop 0
    s_lshr_b32 s62, s62, s54
    s_and_b32 s64, s62, 1
Lwok_41:
    v_mov_b32 v14, 163832
    v_mov_b32 v20, s64
    ds_write_b32 v14, v20
    s_waitcnt lgkmcnt(0)
    s_cmp_lg_u32 s64, 0
    s_cbranch_scc1 Lwid_40
    s_mov_b32 s89, s59
Lwi_39:
    buffer_load_dword v14, v15, s[8:11], 0 offen sc1
    s_waitcnt vmcnt(0)
    v_cmp_ne_u32 vcc, -1, v14
    s_cbranch_vccz Lwid_40
    s_sleep 8
    s_sub_u32 s89, s89, 8
    s_cbranch_scc0 Lwi_39
    s_mov_b32 s59, 0
Lwid_40:
    s_barrier
    buffer_load_dword v14, v15, s[8:11], 0 offen offset:4 sc1
    v_mov_b32 v15, 163832
    ds_read_b32 v15, v15
    s_waitcnt vmcnt(0) lgkmcnt(0)
    v_readfirstlane_b32 s62, v15
    s_nop 0
    s_cmp_lg_u32 s62, 0
    s_cbranch_scc1 L_reclaim
    v_readlane_b32 s62, v14, 1
    v_readlane_b32 s63, v14, 2
    v_readlane_b32 s61, v14, 3
Llf_38:
    s_cmp_gt_u32 s63, s62
    s_cselect_b32 s46, 0x2000, 0
    s_mul_i32 s65, s56, 4194304
    s_add_u32 s69, s65, s46
    s_xor_b32 s68, s69, 0x2000
    s_sub_u32 s65, 4194304, s65
    s_add_u32 s70, s65, s46
    s_mov_b32 s60, 0
    s_mov_b32 s71, s68
    s_mov_b32 s72, s69
    s_mov_b32 s73, s70
    v_lshlrev_b32 v1, 4, v0
    v_mov_b32 v2, 0x4444
    v_mov_b32 v8, 0xeeee
    v_and_b32 v9, 8, v0
    v_cmp_ne_u32 vcc, 0, v9
    s_nop 1
    v_cndmask_b32 v2, v2, v8, vcc
    v_and_b32 v3, 15, v0
    v_lshlrev_b32 v3, 5, v3
    v_lshrrev_b32 v8, 4, v0
    v_lshl_add_u32 v3, v8, 3, v3
    s_lshl_b32 s62, s52, 9
    s_add_u32 s62, s62, 10240
    v_add_u32 v3, s62, v3
    v_lshlrev_b32 v10, 3, v0
    s_and_b32 s62, s52, 3
    s_mul_i32 s62, s62, 1280
    v_add_u32 v88, s62, v1
    s_add_u32 s62, s62, 1024
    v_lshlrev_b32 v89, 2, v0
    v_add_u32 v89, s62, v89
    s_mul_i32 s76, s52, 1280
    v_mov_b32 v6, 14336
    s_cmp_lt_u32 s52, 4
    s_cbranch_scc1 L_QK_lo
    s_mov_b32 m0, s76
L_QK_hi:
    s_barrier
    v_mov_b32 v16, 0
    v_mov_b32 v17, 0
    v_mov_b32 v18, 0
    v_mov_b32 v19, 0
    v_mov_b32 v20, 0
    v_mov_b32 v21, 0
    v_mov_b32 v22, 0
    v_mov_b32 v23, 0
    s_nop 7
    buffer_load_dwordx4 v[44:47], v88, s[4:7], s72 offen sc1
    buffer_load_dword v48, v89, s[4:7], s72 offen sc1
    s_barrier
    ds_read_b128 v[24:27], v1 offset:0
    ds_read_b128 v[28:31], v1 offset:1024
    ds_read_b128 v[32:35], v1 offset:2048
    ds_read_b128 v[36:39], v1 offset:3072
    ds_read_b128 v[40:43], v1 offset:4096
    s_waitcnt vmcnt(0)
Lck_42:
    ds_write_b128 v88, v[44:47] offset:5120
    ds_write_b32 v89, v48 offset:5120
    v_max3_u32 v8, v44, v45, v46
    v_max3_u32 v8, v8, v47, v48
    v_cmp_eq_u32 vcc, -1, v8
    s_cbranch_vccnz Lrt_43
Lckd_44:
    s_waitcnt lgkmcnt(2)
    v_smfmac_f32_16x16x64_bf16 v[16:19], v[24:27], a[0:7], v2
    v_smfmac_f32_16x16x64_bf16 v[20:23], v[24:27], a[80:87], v2
    v_smfmac_f32_16x16x64_bf16 v[16:19], v[28:31], a[8:15], v2
    v_smfmac_f32_16x16x64_bf16 v[20:23], v[28:31], a[88:95], v2
    s_waitcnt lgkmcnt(0)
    s_barrier
    ds_read_b128 v[56:59], v1 offset:5120
    ds_read_b128 v[60:63], v1 offset:6144
    ds_read_b128 v[64:67], v1 offset:7168
    ds_read_b128 v[68:71], v1 offset:8192
    ds_read_b128 v[72:75], v1 offset:9216
    s_waitcnt lgkmcnt(5)
    v_smfmac_f32_16x16x64_bf16 v[16:19], v[32:35], a[16:23], v2
    v_smfmac_f32_16x16x64_bf16 v[20:23], v[32:35], a[96:103], v2
    v_smfmac_f32_16x16x64_bf16 v[16:19], v[36:39], a[24:31], v2
    v_smfmac_f32_16x16x64_bf16 v[20:23], v[36:39], a[104:111], v2
    v_smfmac_f32_16x16x64_bf16 v[16:19], v[40:43], a[32:39], v2
    v_smfmac_f32_16x16x64_bf16 v[20:23], v[40:43], a[112:119], v2
    s_waitcnt lgkmcnt(4)
    v_smfmac_f32_16x16x64_bf16 v[16:19], v[56:59], a[40:47], v2
    v_smfmac_f32_16x16x64_bf16 v[20:23], v[56:59], a[120:127], v2
    s_waitcnt lgkmcnt(3)
    v_smfmac_f32_16x16x64_bf16 v[16:19], v[60:63], a[48:55], v2
    v_smfmac_f32_16x16x64_bf16 v[20:23], v[60:63], a[128:135], v2
    s_waitcnt lgkmcnt(2)
    v_smfmac_f32_16x16x64_bf16 v[16:19], v[64:67], a[56:63], v2
    v_smfmac_f32_16x16x64_bf16 v[20:23], v[64:67], a[136:143], v2
    s_waitcnt lgkmcnt(1)
    v_smfmac_f32_16x16x64_bf16 v[16:19], v[68:71], a[64:71], v2
    v_smfmac_f32_16x16x64_bf16 v[20:23], v[68:71], a[144:151], v2
    s_waitcnt lgkmcnt(0)
    v_smfmac_f32_16x16x64_bf16 v[16:19], v[72:75], a[72:79], v2
    v_smfmac_f32_16x16x64_bf16 v[20:23], v[72:75], a[152:159], v2
    s_nop 7
    v_permlane32_swap_b32 v16, v20
    v_permlane32_swap_b32 v17, v21
    v_permlane32_swap_b32 v18, v22
    v_permlane32_swap_b32 v19, v23
    v_pk_add_f32 v[16:17], v[16:17], v[20:21]
    v_pk_add_f32 v[18:19], v[18:19], v[22:23]
    v_cvt_pk_bf16_f32 v16, v16, v17
    v_cvt_pk_bf16_f32 v17, v18, v19
    ds_write_b64 v3, v[16:17]
    s_waitcnt lgkmcnt(0)
    s_barrier
L_QK_hi_b:
    s_add_u32 s60, s60, 1
    s_add_u32 s72, s72, 32768
    s_barrier
    s_cmp_lt_u32 s60, 64
    s_cbranch_scc1 L_QK_hi
    s_branch L_end
Lrt_43:
    s_sub_u32 s59, s59, 1
    s_cbranch_scc0 Lrg_45
    s_mov_b32 s59, 0
    s_branch Lckd_44
Lrg_45:
    s_waitcnt lgkmcnt(0)
    s_nop 7
    buffer_load_dwordx4 v[44:47], v88, s[4:7], s72 offen sc1
    buffer_load_dword v48, v89, s[4:7], s72 offen sc1
    s_waitcnt vmcnt(0)
    s_branch Lck_42
L_QK_lo:
    s_setprio 1
    v_and_b32 v93, 7, v0
    v_lshlrev_b32 v93, 4, v93
    v_lshrrev_b32 v8, 4, v0
    v_lshl_add_u32 v93, v8, 7, v93
    s_cmp_eq_u32 s52, 1
    s_cbranch_scc1 L_QK_w1
    s_cmp_eq_u32 s52, 2
    s_cbranch_scc1 L_QK_w2
    s_cmp_eq_u32 s52, 3
    s_cbranch_scc1 L_QK_w3
    s_bfe_u32 s63, s55, 0x20002
    s_mul_i32 s62, s63, 2560
    s_add_u32 s62, s62, 16384
    s_cmp_eq_u32 s63, 3
    s_cselect_b32 s62, 5120, s62
    s_and_b32 s63, s55, 3
    s_mul_i32 s63, s63, 640
    s_add_u32 s62, s62, s63
    v_bfe_u32 v8, v0, 3, 1
    v_lshl_add_u32 v90, v8, 8, v93
    v_add_u32 v90, s62, v90
    s_mov_b32 s80, 0
    s_mov_b32 s81, 0x00ff00ff
    v_mov_b32 v8, 0xff7fffff
    v_mov_b32 v9, 0
    v_cndmask_b32 v12, v8, v9, s[80:81]
    v_cndmask_b32 v13, v8, v9, s[80:81]
    v_cndmask_b32 v14, v8, v9, s[80:81]
    v_cndmask_b32 v15, v8, v9, s[80:81]
    s_mov_b32 s80, 0x00ff00ff
    s_mov_b32 s81, 0x00ffffff
    s_mov_b32 s82, 1040356334
    s_mov_b32 s83, 1040356334
    s_mov_b32 s90, 3187839982
    v_add_u32 v91, 16384, v1
    s_lshl_b32 s62, s54, 2
    s_add_u32 s62, s62, 7680
    v_mov_b32 v94, s62
    s_cmp_lg_u32 s61, 0
    s_cbranch_scc1 L_QK_w0_i
L_QK_w0_p:
    v_mov_b32 v16, 0
    v_mov_b32 v17, 0
    v_mov_b32 v18, 0
    v_mov_b32 v19, 0
    v_mov_b32 v20, 0
    v_mov_b32 v21, 0
    v_mov_b32 v22, 0
    v_mov_b32 v23, 0
    s_mov_b32 m0, s76
    v_mov_b32 v11, s60
    s_barrier
    buffer_load_dwordx4 v[44:47], v88, s[4:7], s71 offen sc1
    buffer_load_dword v48, v89, s[4:7], s71 offen sc1
    s_waitcnt vmcnt(0)
Lck_46:
    ds_write_b128 v88, v[44:47] offset:0
    ds_write_b32 v89, v48 offset:0
    v_max3_u32 v8, v44, v45, v46
    v_max3_u32 v8, v8, v47, v48
    v_cmp_eq_u32 vcc, -1, v8
    s_waitcnt lgkmcnt(0)
    s_cbranch_vccnz Lrt_47
Lckd_48:
    s_barrier
    ds_read_b128 v[24:27], v1 offset:0
    ds_read_b128 v[28:31], v1 offset:1024
    ds_read_b128 v[32:35], v1 offset:2048
    ds_read_b128 v[36:39], v1 offset:3072
    ds_read_b128 v[40:43], v1 offset:4096
    s_waitcnt lgkmcnt(4)
    v_smfmac_f32_16x16x64_bf16 v[16:19], v[24:27], a[0:7], v2
    v_smfmac_f32_16x16x64_bf16 v[20:23], v[24:27], a[80:87], v2
    s_waitcnt lgkmcnt(3)
    v_smfmac_f32_16x16x64_bf16 v[16:19], v[28:31], a[8:15], v2
    v_smfmac_f32_16x16x64_bf16 v[20:23], v[28:31], a[88:95], v2
    s_waitcnt lgkmcnt(2)
    v_smfmac_f32_16x16x64_bf16 v[16:19], v[32:35], a[16:23], v2
    v_smfmac_f32_16x16x64_bf16 v[20:23], v[32:35], a[96:103], v2
    s_waitcnt lgkmcnt(1)
    v_smfmac_f32_16x16x64_bf16 v[16:19], v[36:39], a[24:31], v2
    v_smfmac_f32_16x16x64_bf16 v[20:23], v[36:39], a[104:111], v2
    s_waitcnt lgkmcnt(0)
    v_smfmac_f32_16x16x64_bf16 v[16:19], v[40:43], a[32:39], v2
    v_smfmac_f32_16x16x64_bf16 v[20:23], v[40:43], a[112:119], v2
    ds_read_b128 v[56:59], v91 offset:0
    ds_read_b128 v[60:63], v91 offset:1024
    ds_read_b128 v[64:67], v91 offset:2048
    ds_read_b128 v[68:71], v91 offset:3072
    ds_read_b128 v[72:75], v91 offset:4096
    ds_read_b128 v[76:79], v91 offset:5120
    ds_read_b128 v[80:83], v91 offset:6144
    ds_read_b128 v[84:87], v91 offset:7168
    v_xor_b32 v91, 0x2000, v91
    s_barrier
    ds_read_b128 v[24:27], v1 offset:5120
    ds_read_b128 v[28:31], v1 offset:6144
    ds_read_b128 v[32:35], v1 offset:7168
    ds_read_b128 v[36:39], v1 offset:8192
    ds_read_b128 v[40:43], v1 offset:9216
    s_waitcnt lgkmcnt(4)
    v_smfmac_f32_16x16x64_bf16 v[16:19], v[24:27], a[40:47], v2
    v_smfmac_f32_16x16x64_bf16 v[20:23], v[24:27], a[120:127], v2
    s_waitcnt lgkmcnt(3)
    v_smfmac_f32_16x16x64_bf16 v[16:19], v[28:31], a[48:55], v2
    v_smfmac_f32_16x16x64_bf16 v[20:23], v[28:31], a[128:135], v2
    s_waitcnt lgkmcnt(2)
    v_smfmac_f32_16x16x64_bf16 v[16:19], v[32:35], a[56:63], v2
    v_smfmac_f32_16x16x64_bf16 v[20:23], v[32:35], a[136:143], v2
    s_waitcnt lgkmcnt(1)
    v_smfmac_f32_16x16x64_bf16 v[16:19], v[36:39], a[64:71], v2
    v_smfmac_f32_16x16x64_bf16 v[20:23], v[36:39], a[144:151], v2
    s_waitcnt lgkmcnt(0)
    v_smfmac_f32_16x16x64_bf16 v[16:19], v[40:43], a[72:79], v2
    v_smfmac_f32_16x16x64_bf16 v[20:23], v[40:43], a[152:159], v2
    s_nop 7
    v_permlane32_swap_b32 v16, v20
    v_permlane32_swap_b32 v17, v21
    v_permlane32_swap_b32 v18, v22
    v_permlane32_swap_b32 v19, v23
    v_pk_add_f32 v[16:17], v[16:17], v[20:21]
    v_pk_add_f32 v[18:19], v[18:19], v[22:23]
    v_cvt_pk_bf16_f32 v16, v16, v17
    v_cvt_pk_bf16_f32 v17, v18, v19
    ds_write_b64 v3, v[16:17]
    s_waitcnt lgkmcnt(0)
    s_barrier
Lqb_49:
    ds_read_b64_tr_b16 v[24:25], v10 offset:10240
    ds_read_b64_tr_b16 v[26:27], v10 offset:10752
    ds_read_b64_tr_b16 v[28:29], v10 offset:11264
    ds_read_b64_tr_b16 v[30:31], v10 offset:11776
    ds_read_b64_tr_b16 v[32:33], v10 offset:12288
    ds_read_b64_tr_b16 v[34:35], v10 offset:12800
    ds_read_b64_tr_b16 v[36:37], v10 offset:13312
    ds_read_b64_tr_b16 v[38:39], v10 offset:13824
    s_waitcnt lgkmcnt(6)
    v_mfma_f32_16x16x32_bf16 v[48:51], v[24:27], v[24:27], v[12:15]
    v_mfma_f32_16x16x32_bf16 v[44:47], v[72:75], v[24:27], 0
    v_mfma_f32_16x16x32_bf16 v[40:43], v[56:59], v[24:27], 0
    s_waitcnt lgkmcnt(4)
    v_mfma_f32_16x16x32_bf16 v[48:51], v[28:31], v[28:31], v[48:51]
    v_mfma_f32_16x16x32_bf16 v[44:47], v[76:79], v[28:31], v[44:47]
    v_mfma_f32_16x16x32_bf16 v[40:43], v[60:63], v[28:31], v[40:43]
    s_waitcnt lgkmcnt(2)
    v_mfma_f32_16x16x32_bf16 v[48:51], v[32:35], v[32:35], v[48:51]
    v_mfma_f32_16x16x32_bf16 v[44:47], v[80:83], v[32:35], v[44:47]
    v_mfma_f32_16x16x32_bf16 v[40:43], v[64:67], v[32:35], v[40:43]
    s_waitcnt lgkmcnt(0)
    v_mfma_f32_16x16x32_bf16 v[48:51], v[36:39], v[36:39], v[48:51]
    v_mfma_f32_16x16x32_bf16 v[44:47], v[84:87], v[36:39], v[44:47]
    v_mfma_f32_16x16x32_bf16 v[40:43], v[68:71], v[36:39], v[40:43]
    s_nop 5
    v_max3_f32 v8, v48, v49, v50
    v_max_f32 v8, v8, v51
    v_mov_b32_dpp v40, v44 row_shr:8 row_mask:0xf bank_mask:0xc
    v_mov_b32_dpp v41, v45 row_shr:8 row_mask:0xf bank_mask:0xc
    v_mov_b32_dpp v42, v46 row_shr:8 row_mask:0xf bank_mask:0xc
    v_mov_b32_dpp v43, v47 row_shr:8 row_mask:0xf bank_mask:0xc
    v_max3_f32 v8, v8, v40, v41
    v_max3_f32 v8, v8, v42, v43
    s_nop 1
    v_max_f32_dpp v9, v8, v8 row_ror:8 row_mask:0xf bank_mask:0xf
    v_max_f32_dpp v8, v8, v8 row_ror:8 row_mask:0xf bank_mask:0xf
    s_nop 1
    v_permlane32_swap_b32 v8, v9
    v_max_f32 v44, v8, v9
    v_max_f32 v8, v8, v9
    s_nop 1
    v_permlane16_swap_b32 v8, v44
    v_max_f32 v8, v8, v44
    v_mul_f32 v8, s90, v8
    v_pk_fma_f32 v[40:41], v[40:41], s[82:83], v[8:9] op_sel_hi:[1,1,0]
    v_pk_fma_f32 v[42:43], v[42:43], s[82:83], v[8:9] op_sel_hi:[1,1,0]
    v_pk_fma_f32 v[48:49], v[48:49], s[82:83], v[8:9] op_sel_hi:[1,1,0]
    v_pk_fma_f32 v[50:51], v[50:51], s[82:83], v[8:9] op_sel_hi:[1,1,0]
    v_exp_f32 v40, v40
    v_exp_f32 v41, v41
    v_exp_f32 v42, v42
    v_exp_f32 v43, v43
    v_exp_f32 v48, v48
    v_exp_f32 v49, v49
    v_exp_f32 v50, v50
    v_exp_f32 v51, v51
    v_pk_add_f32 v[8:9], v[40:41], v[42:43]
    v_pk_add_f32 v[44:45], v[48:49], v[50:51]
    v_pk_add_f32 v[8:9], v[8:9], v[44:45]
    v_add_f32 v8, v8, v9
    s_nop 1
    v_add_f32_dpp v9, v8, v8 row_ror:8 row_mask:0xf bank_mask:0xf
    v_add_f32_dpp v8, v8, v8 row_ror:8 row_mask:0xf bank_mask:0xf
    s_nop 1
    v_permlane32_swap_b32 v8, v9
    v_add_f32 v44, v8, v9
    v_add_f32 v8, v8, v9
    s_nop 1
    v_permlane16_swap_b32 v8, v44
    v_add_f32 v8, v8, v44
    v_rcp_f32 v8, v8
    s_nop 0
    v_pk_mul_f32 v[50:51], v[50:51], v[8:9] op_sel_hi:[1,0]
    v_pk_mul_f32 v[48:49], v[48:49], v[8:9] op_sel_hi:[1,0]
    v_pk_mul_f32 v[42:43], v[42:43], v[8:9] op_sel_hi:[1,0]
    v_pk_mul_f32 v[40:41], v[40:41], v[8:9] op_sel_hi:[1,0]
    v_cvt_pk_bf16_f32 v48, v48, v49
    v_cvt_pk_bf16_f32 v49, v50, v51
    v_cvt_pk_bf16_f32 v40, v40, v41
    v_cvt_pk_bf16_f32 v41, v42, v43
    v_permlane16_swap_b32 v48, v50
    v_permlane16_swap_b32 v49, v51
    v_mov_b32_dpp v42, v40 row_shl:8 row_mask:0xf bank_mask:0x3
    v_mov_b32_dpp v43, v41 row_shl:8 row_mask:0xf bank_mask:0x3
    v_mov_b32_dpp v40, v48 row_shr:8 row_mask:0x4 bank_mask:0xc
    v_mov_b32_dpp v41, v49 row_shr:8 row_mask:0x4 bank_mask:0xc
    v_mov_b32_dpp v42, v50 row_shr:8 row_mask:0x4 bank_mask:0xc
    v_mov_b32_dpp v43, v51 row_shr:8 row_mask:0x4 bank_mask:0xc
    s_mov_b64 exec, 1
    buffer_store_dword v11, v94, s[4:7], s68 offen
    s_mov_b64 exec, -1
    s_mov_b64 exec, s[80:81]
    buffer_store_dwordx4 v[40:43], v90, s[4:7], s71 offen
    buffer_store_dwordx4 v[40:43], v90, s[4:7], s73 offen sc1
    s_mov_b64 exec, -1
    s_barrier
    s_add_u32 s60, s60, 1
    s_add_u32 s71, s71, 32768
    s_add_u32 s72, s72, 32768
    s_add_u32 s73, s73, 32768
    s_cmp_lt_u32 s60, 64
    s_cbranch_scc1 L_QK_w0_p
    s_branch L_end
Lrt_47:
    s_sub_u32 s59, s59, 1
    s_cbranch_scc0 Lrg_50
    s_mov_b32 s59, 0
    s_branch Lckd_48
Lrg_50:
    s_waitcnt lgkmcnt(0)
    s_nop 7
    buffer_load_dwordx4 v[44:47], v88, s[4:7], s71 offen sc1
    buffer_load_dword v48, v89, s[4:7], s71 offen sc1
    s_waitcnt vmcnt(0)
    s_branch Lck_46
L_QK_w0_i:
L_QK_w0_q:
    v_mov_b32 v16, 0
    v_mov_b32 v17, 0
    v_mov_b32 v18, 0
    v_mov_b32 v19, 0
    v_mov_b32 v20, 0
    v_mov_b32 v21, 0
    v_mov_b32 v22, 0
    v_mov_b32 v23, 0
    s_mov_b32 m0, s76
    v_mov_b32 v11, s60
    s_barrier
    buffer_load_dwordx4 v[44:47], v88, s[4:7], s71 offen sc1
    buffer_load_dword v48, v89, s[4:7], s71 offen sc1
    s_waitcnt vmcnt(0)
Lck_51:
    ds_write_b128 v88, v[44:47] offset:0
    ds_write_b32 v89, v48 offset:0
    v_max3_u32 v8, v44, v45, v46
    v_max3_u32 v8, v8, v47, v48
    v_cmp_eq_u32 vcc, -1, v8
    s_waitcnt lgkmcnt(0)
    s_cbranch_vccnz Lrt_52
Lckd_53:
    s_barrier
    ds_read_b128 v[24:27], v1 offset:0
    ds_read_b128 v[28:31], v1 offset:1024
    ds_read_b128 v[32:35], v1 offset:2048
    ds_read_b128 v[36:39], v1 offset:3072
    ds_read_b128 v[40:43], v1 offset:4096
    s_waitcnt lgkmcnt(4)
    v_smfmac_f32_16x16x64_bf16 v[16:19], v[24:27], a[0:7], v2
    v_smfmac_f32_16x16x64_bf16 v[20:23], v[24:27], a[80:87], v2
    s_waitcnt lgkmcnt(3)
    v_smfmac_f32_16x16x64_bf16 v[16:19], v[28:31], a[8:15], v2
    v_smfmac_f32_16x16x64_bf16 v[20:23], v[28:31], a[88:95], v2
    s_waitcnt lgkmcnt(2)
    v_smfmac_f32_16x16x64_bf16 v[16:19], v[32:35], a[16:23], v2
    v_smfmac_f32_16x16x64_bf16 v[20:23], v[32:35], a[96:103], v2
    s_waitcnt lgkmcnt(1)
    v_smfmac_f32_16x16x64_bf16 v[16:19], v[36:39], a[24:31], v2
    v_smfmac_f32_16x16x64_bf16 v[20:23], v[36:39], a[104:111], v2
    s_waitcnt lgkmcnt(0)
    v_smfmac_f32_16x16x64_bf16 v[16:19], v[40:43], a[32:39], v2
    v_smfmac_f32_16x16x64_bf16 v[20:23], v[40:43], a[112:119], v2
    ds_read_b128 v[56:59], v91 offset:0
    ds_read_b128 v[60:63], v91 offset:1024
    ds_read_b128 v[64:67], v91 offset:2048
    ds_read_b128 v[68:71], v91 offset:3072
    ds_read_b128 v[72:75], v91 offset:4096
    ds_read_b128 v[76:79], v91 offset:5120
    ds_read_b128 v[80:83], v91 offset:6144
    ds_read_b128 v[84:87], v91 offset:7168
    v_xor_b32 v91, 0x2000, v91
    s_barrier
    ds_read_b128 v[24:27], v1 offset:5120
    ds_read_b128 v[28:31], v1 offset:6144
    ds_read_b128 v[32:35], v1 offset:7168
    ds_read_b128 v[36:39], v1 offset:8192
    ds_read_b128 v[40:43], v1 offset:9216
    s_waitcnt lgkmcnt(4)
    v_smfmac_f32_16x16x64_bf16 v[16:19], v[24:27], a[40:47], v2
    v_smfmac_f32_16x16x64_bf16 v[20:23], v[24:27], a[120:127], v2
    s_waitcnt lgkmcnt(3)
    v_smfmac_f32_16x16x64_bf16 v[16:19], v[28:31], a[48:55], v2
    v_smfmac_f32_16x16x64_bf16 v[20:23], v[28:31], a[128:135], v2
    s_waitcnt lgkmcnt(2)
    v_smfmac_f32_16x16x64_bf16 v[16:19], v[32:35], a[56:63], v2
    v_smfmac_f32_16x16x64_bf16 v[20:23], v[32:35], a[136:143], v2
    s_waitcnt lgkmcnt(1)
    v_smfmac_f32_16x16x64_bf16 v[16:19], v[36:39], a[64:71], v2
    v_smfmac_f32_16x16x64_bf16 v[20:23], v[36:39], a[144:151], v2
    s_waitcnt lgkmcnt(0)
    v_smfmac_f32_16x16x64_bf16 v[16:19], v[40:43], a[72:79], v2
    v_smfmac_f32_16x16x64_bf16 v[20:23], v[40:43], a[152:159], v2
    s_nop 7
    v_permlane32_swap_b32 v16, v20
    v_permlane32_swap_b32 v17, v21
    v_permlane32_swap_b32 v18, v22
    v_permlane32_swap_b32 v19, v23
    v_pk_add_f32 v[16:17], v[16:17], v[20:21]
    v_pk_add_f32 v[18:19], v[18:19], v[22:23]
    v_cvt_pk_bf16_f32 v16, v16, v17
    v_cvt_pk_bf16_f32 v17, v18, v19
    ds_write_b64 v3, v[16:17]
    s_waitcnt lgkmcnt(0)
    s_barrier
Lqb_54:
    ds_read_b64_tr_b16 v[24:25], v10 offset:10240
    ds_read_b64_tr_b16 v[26:27], v10 offset:10752
    ds_read_b64_tr_b16 v[28:29], v10 offset:11264
    ds_read_b64_tr_b16 v[30:31], v10 offset:11776
    ds_read_b64_tr_b16 v[32:33], v10 offset:12288
    ds_read_b64_tr_b16 v[34:35], v10 offset:12800
    ds_read_b64_tr_b16 v[36:37], v10 offset:13312
    ds_read_b64_tr_b16 v[38:39], v10 offset:13824
    s_waitcnt lgkmcnt(6)
    v_mfma_f32_16x16x32_bf16 v[48:51], v[24:27], v[24:27], v[12:15]
    v_mfma_f32_16x16x32_bf16 v[44:47], v[72:75], v[24:27], 0
    v_mfma_f32_16x16x32_bf16 v[40:43], v[56:59], v[24:27], 0
    s_waitcnt lgkmcnt(4)
    v_mfma_f32_16x16x32_bf16 v[48:51], v[28:31], v[28:31], v[48:51]
    v_mfma_f32_16x16x32_bf16 v[44:47], v[76:79], v[28:31], v[44:47]
    v_mfma_f32_16x16x32_bf16 v[40:43], v[60:63], v[28:31], v[40:43]
    s_waitcnt lgkmcnt(2)
    v_mfma_f32_16x16x32_bf16 v[48:51], v[32:35], v[32:35], v[48:51]
    v_mfma_f32_16x16x32_bf16 v[44:47], v[80:83], v[32:35], v[44:47]
    v_mfma_f32_16x16x32_bf16 v[40:43], v[64:67], v[32:35], v[40:43]
    s_waitcnt lgkmcnt(0)
    v_mfma_f32_16x16x32_bf16 v[48:51], v[36:39], v[36:39], v[48:51]
    v_mfma_f32_16x16x32_bf16 v[44:47], v[84:87], v[36:39], v[44:47]
    v_mfma_f32_16x16x32_bf16 v[40:43], v[68:71], v[36:39], v[40:43]
    s_nop 5
    v_max3_f32 v8, v48, v49, v50
    v_max_f32 v8, v8, v51
    v_mov_b32_dpp v40, v44 row_shr:8 row_mask:0xf bank_mask:0xc
    v_mov_b32_dpp v41, v45 row_shr:8 row_mask:0xf bank_mask:0xc
    v_mov_b32_dpp v42, v46 row_shr:8 row_mask:0xf bank_mask:0xc
    v_mov_b32_dpp v43, v47 row_shr:8 row_mask:0xf bank_mask:0xc
    v_max3_f32 v8, v8, v40, v41
    v_max3_f32 v8, v8, v42, v43
    s_nop 1
    v_max_f32_dpp v9, v8, v8 row_ror:8 row_mask:0xf bank_mask:0xf
    v_max_f32_dpp v8, v8, v8 row_ror:8 row_mask:0xf bank_mask:0xf
    s_nop 1
    v_permlane32_swap_b32 v8, v9
    v_max_f32 v44, v8, v9
    v_max_f32 v8, v8, v9
    s_nop 1
    v_permlane16_swap_b32 v8, v44
    v_max_f32 v8, v8, v44
    v_mul_f32 v8, s90, v8
    v_pk_fma_f32 v[40:41], v[40:41], s[82:83], v[8:9] op_sel_hi:[1,1,0]
    v_pk_fma_f32 v[42:43], v[42:43], s[82:83], v[8:9] op_sel_hi:[1,1,0]
    v_pk_fma_f32 v[48:49], v[48:49], s[82:83], v[8:9] op_sel_hi:[1,1,0]
    v_pk_fma_f32 v[50:51], v[50:51], s[82:83], v[8:9] op_sel_hi:[1,1,0]
    v_exp_f32 v40, v40
    v_exp_f32 v41, v41
    v_exp_f32 v42, v42
    v_exp_f32 v43, v43
    v_exp_f32 v48, v48
    v_exp_f32 v49, v49
    v_exp_f32 v50, v50
    v_exp_f32 v51, v51
    v_pk_add_f32 v[8:9], v[40:41], v[42:43]
    v_pk_add_f32 v[44:45], v[48:49], v[50:51]
    v_pk_add_f32 v[8:9], v[8:9], v[44:45]
    v_add_f32 v8, v8, v9
    s_nop 1
    v_add_f32_dpp v9, v8, v8 row_ror:8 row_mask:0xf bank_mask:0xf
    v_add_f32_dpp v8, v8, v8 row_ror:8 row_mask:0xf bank_mask:0xf
    s_nop 1
    v_permlane32_swap_b32 v8, v9
    v_add_f32 v44, v8, v9
    v_add_f32 v8, v8, v9
    s_nop 1
    v_permlane16_swap_b32 v8, v44
    v_add_f32 v8, v8, v44
    v_rcp_f32 v8, v8
    s_nop 0
    v_pk_mul_f32 v[50:51], v[50:51], v[8:9] op_sel_hi:[1,0]
    v_pk_mul_f32 v[48:49], v[48:49], v[8:9] op_sel_hi:[1,0]
    v_pk_mul_f32 v[42:43], v[42:43], v[8:9] op_sel_hi:[1,0]
    v_pk_mul_f32 v[40:41], v[40:41], v[8:9] op_sel_hi:[1,0]
    v_cvt_pk_bf16_f32 v48, v48, v49
    v_cvt_pk_bf16_f32 v49, v50, v51
    v_cvt_pk_bf16_f32 v40, v40, v41
    v_cvt_pk_bf16_f32 v41, v42, v43
    v_permlane16_swap_b32 v48, v50
    v_permlane16_swap_b32 v49, v51
    v_mov_b32_dpp v42, v40 row_shl:8 row_mask:0xf bank_mask:0x3
    v_mov_b32_dpp v43, v41 row_shl:8 row_mask:0xf bank_mask:0x3
    v_mov_b32_dpp v40, v48 row_shr:8 row_mask:0x4 bank_mask:0xc
    v_mov_b32_dpp v41, v49 row_shr:8 row_mask:0x4 bank_mask:0xc
    v_mov_b32_dpp v42, v50 row_shr:8 row_mask:0x4 bank_mask:0xc
    v_mov_b32_dpp v43, v51 row_shr:8 row_mask:0x4 bank_mask:0xc
    s_mov_b64 exec, 1
    buffer_store_dword v11, v94, s[4:7], s68 offen sc1
    s_mov_b64 exec, -1
    s_mov_b64 exec, s[80:81]
    buffer_store_dwordx4 v[40:43], v90, s[4:7], s71 offen sc1
    buffer_store_dwordx4 v[40:43], v90, s[4:7], s73 offen sc1
    s_mov_b64 exec, -1
    s_barrier
    s_add_u32 s60, s60, 1
    s_add_u32 s71, s71, 32768
    s_add_u32 s72, s72, 32768
    s_add_u32 s73, s73, 32768
    s_cmp_lt_u32 s60, 64
    s_cbranch_scc1 L_QK_w0_q
    s_branch L_end
Lrt_52:
    s_sub_u32 s59, s59, 1
    s_cbranch_scc0 Lrg_55
    s_mov_b32 s59, 0
    s_branch Lckd_53
Lrg_55:
    s_waitcnt lgkmcnt(0)
    s_nop 7
    buffer_load_dwordx4 v[44:47], v88, s[4:7], s71 offen sc1
    buffer_load_dword v48, v89, s[4:7], s71 offen sc1
    s_waitcnt vmcnt(0)
    s_branch Lck_51
L_QK_w1:
    s_mov_b32 s82, 0xff00ff00
    s_mov_b32 s83, 0xff00ff00
    s_lshl_b32 s79, s55, 11
    s_add_u32 s79, s79, 27262976
L_QK_w1_loop:
    v_mov_b32 v16, 0
    v_mov_b32 v17, 0
    v_mov_b32 v18, 0
    v_mov_b32 v19, 0
    v_mov_b32 v20, 0
    v_mov_b32 v21, 0
    v_mov_b32 v22, 0
    v_mov_b32 v23, 0
    s_mov_b32 m0, s76
    s_barrier
    buffer_load_dwordx4 v[44:47], v88, s[4:7], s71 offen sc1
    buffer_load_dword v48, v89, s[4:7], s71 offen sc1
    s_waitcnt vmcnt(0)
Lck_56:
    ds_write_b128 v88, v[44:47] offset:0
    ds_write_b32 v89, v48 offset:0
    v_max3_u32 v8, v44, v45, v46
    v_max3_u32 v8, v8, v47, v48
    v_cmp_eq_u32 vcc, -1, v8
    s_waitcnt lgkmcnt(0)
    s_cbranch_vccnz Lrt_57
Lckd_58:
    s_barrier
    ds_read_b128 v[24:27], v1 offset:0
    ds_read_b128 v[28:31], v1 offset:1024
    ds_read_b128 v[32:35], v1 offset:2048
    ds_read_b128 v[36:39], v1 offset:3072
    ds_read_b128 v[40:43], v1 offset:4096
    s_waitcnt lgkmcnt(4)
    v_smfmac_f32_16x16x64_bf16 v[16:19], v[24:27], a[0:7], v2
    v_smfmac_f32_16x16x64_bf16 v[20:23], v[24:27], a[80:87], v2
    s_waitcnt lgkmcnt(3)
    v_smfmac_f32_16x16x64_bf16 v[16:19], v[28:31], a[8:15], v2
    v_smfmac_f32_16x16x64_bf16 v[20:23], v[28:31], a[88:95], v2
    s_waitcnt lgkmcnt(2)
    v_smfmac_f32_16x16x64_bf16 v[16:19], v[32:35], a[16:23], v2
    v_smfmac_f32_16x16x64_bf16 v[20:23], v[32:35], a[96:103], v2
    s_waitcnt lgkmcnt(1)
    v_smfmac_f32_16x16x64_bf16 v[16:19], v[36:39], a[24:31], v2
    v_smfmac_f32_16x16x64_bf16 v[20:23], v[36:39], a[104:111], v2
    s_waitcnt lgkmcnt(0)
    v_smfmac_f32_16x16x64_bf16 v[16:19], v[40:43], a[32:39], v2
    v_smfmac_f32_16x16x64_bf16 v[20:23], v[40:43], a[112:119], v2
    s_barrier
    ds_read_b128 v[24:27], v1 offset:5120
    ds_read_b128 v[28:31], v1 offset:6144
    ds_read_b128 v[32:35], v1 offset:7168
    ds_read_b128 v[36:39], v1 offset:8192
    ds_read_b128 v[40:43], v1 offset:9216
    s_waitcnt lgkmcnt(4)
    v_smfmac_f32_16x16x64_bf16 v[16:19], v[24:27], a[40:47], v2
    v_smfmac_f32_16x16x64_bf16 v[20:23], v[24:27], a[120:127], v2
    s_waitcnt lgkmcnt(3)
    v_smfmac_f32_16x16x64_bf16 v[16:19], v[28:31], a[48:55], v2
    v_smfmac_f32_16x16x64_bf16 v[20:23], v[28:31], a[128:135], v2
    s_waitcnt lgkmcnt(2)
    v_smfmac_f32_16x16x64_bf16 v[16:19], v[32:35], a[56:63], v2
    v_smfmac_f32_16x16x64_bf16 v[20:23], v[32:35], a[136:143], v2
    s_waitcnt lgkmcnt(1)
    v_smfmac_f32_16x16x64_bf16 v[16:19], v[36:39], a[64:71], v2
    v_smfmac_f32_16x16x64_bf16 v[20:23], v[36:39], a[144:151], v2
    s_waitcnt lgkmcnt(0)
    v_smfmac_f32_16x16x64_bf16 v[16:19], v[40:43], a[72:79], v2
    v_smfmac_f32_16x16x64_bf16 v[20:23], v[40:43], a[152:159], v2
    s_nop 7
    v_permlane32_swap_b32 v16, v20
    v_permlane32_swap_b32 v17, v21
    v_permlane32_swap_b32 v18, v22
    v_permlane32_swap_b32 v19, v23
    v_pk_add_f32 v[16:17], v[16:17], v[20:21]
    v_pk_add_f32 v[18:19], v[18:19], v[22:23]
    v_cvt_pk_bf16_f32 v16, v16, v17
    v_cvt_pk_bf16_f32 v17, v18, v19
    ds_write_b64 v3, v[16:17]
    s_waitcnt lgkmcnt(0)
    s_barrier
Lqb_59:
    ds_read_b64_tr_b16 v[56:57], v10 offset:10240
    ds_read_b64_tr_b16 v[58:59], v10 offset:10752
    ds_read_b64_tr_b16 v[60:61], v10 offset:11264
    ds_read_b64_tr_b16 v[62:63], v10 offset:11776
    ds_read_b64_tr_b16 v[64:65], v10 offset:12288
    ds_read_b64_tr_b16 v[66:67], v10 offset:12800
    ds_read_b64_tr_b16 v[68:69], v10 offset:13312
    ds_read_b64_tr_b16 v[70:71], v10 offset:13824
    s_cmp_eq_u32 s60, 63
    s_cbranch_scc1 Lkl_60
    s_barrier
Lkl_60:
    s_waitcnt lgkmcnt(0)
    s_mov_b64 exec, s[82:83]
    buffer_store_dwordx4 v[56:59], v93, s[4:7], s79 offen offset:0 sc1
    buffer_store_dwordx4 v[60:63], v93, s[4:7], s79 offen offset:512 sc1
    buffer_store_dwordx4 v[64:67], v93, s[4:7], s79 offen offset:1024 sc1
    buffer_store_dwordx4 v[68:71], v93, s[4:7], s79 offen offset:1536 sc1
    s_mov_b64 exec, -1
    s_add_u32 s79, s79, 65536
    s_add_u32 s60, s60, 1
    s_add_u32 s71, s71, 32768
    s_add_u32 s72, s72, 32768
    s_add_u32 s73, s73, 32768
    s_cmp_lt_u32 s60, 64
    s_cbranch_scc1 L_QK_w1_loop
    s_branch L_end
Lrt_57:
    s_sub_u32 s59, s59, 1
    s_cbranch_scc0 Lrg_61
    s_mov_b32 s59, 0
    s_branch Lckd_58
Lrg_61:
    s_waitcnt lgkmcnt(0)
    s_nop 7
    buffer_load_dwordx4 v[44:47], v88, s[4:7], s71 offen sc1
    buffer_load_dword v48, v89, s[4:7], s71 offen sc1
    s_waitcnt vmcnt(0)
    s_branch Lck_56
L_QK_w2:
    v_min_u32 v95, 9, v0
    v_lshlrev_b32 v95, 2, v95
    v_add_u32 v95, 7936, v95
    s_lshl_b32 s62, s56, 14
    s_lshl_b32 s63, s54, 7
    s_add_u32 s62, s62, s63
    s_add_u32 s62, s62, s46
    s_add_u32 s62, s62, 8388608
    v_mov_b32 v94, s62
L_QK_w2_loop:
    v_mov_b32 v16, 0
    v_mov_b32 v17, 0
    v_mov_b32 v18, 0
    v_mov_b32 v19, 0
    v_mov_b32 v20, 0
    v_mov_b32 v21, 0
    v_mov_b32 v22, 0
    v_mov_b32 v23, 0
    s_mov_b32 m0, s76
    s_mov_b32 s89, s59
    buffer_load_dword v56, v95, s[4:7], s68 offen sc1
    s_nop 12
    buffer_load_dword v57, v95, s[4:7], s68 offen sc1
    s_nop 12
    buffer_load_dword v58, v95, s[4:7], s68 offen sc1
    s_nop 12
    buffer_load_dword v59, v95, s[4:7], s68 offen sc1
Lcue_62:
    s_waitcnt vmcnt(3)
    v_cmp_gt_i32 vcc, s60, v56
    s_cbranch_vccz Lcued_63
    buffer_load_dword v56, v95, s[4:7], s68 offen sc1
    s_waitcnt vmcnt(3)
    v_cmp_gt_i32 vcc, s60, v57
    s_cbranch_vccz Lcued_63
    buffer_load_dword v57, v95, s[4:7], s68 offen sc1
    s_waitcnt vmcnt(3)
    v_cmp_gt_i32 vcc, s60, v58
    s_cbranch_vccz Lcued_63
    buffer_load_dword v58, v95, s[4:7], s68 offen sc1
    s_waitcnt vmcnt(3)
    v_cmp_gt_i32 vcc, s60, v59
    s_cbranch_vccz Lcued_63
    buffer_load_dword v59, v95, s[4:7], s68 offen sc1
    s_sub_u32 s89, s89, 1
    s_cbranch_scc0 Lcue_62
    s_mov_b32 s59, 0
Lcued_63:
    s_barrier
    buffer_load_dwordx4 v[44:47], v88, s[4:7], s71 offen sc1
    buffer_load_dword v48, v89, s[4:7], s71 offen sc1
    s_waitcnt vmcnt(0)
Lck_64:
    ds_write_b128 v88, v[44:47] offset:0
    ds_write_b32 v89, v48 offset:0
    v_max3_u32 v8, v44, v45, v46
    v_max3_u32 v8, v8, v47, v48
    v_cmp_eq_u32 vcc, -1, v8
    s_waitcnt lgkmcnt(0)
    s_cbranch_vccnz Lrt_65
Lckd_66:
    s_barrier
    ds_read_b128 v[24:27], v1 offset:0
    ds_read_b128 v[28:31], v1 offset:1024
    ds_read_b128 v[32:35], v1 offset:2048
    ds_read_b128 v[36:39], v1 offset:3072
    ds_read_b128 v[40:43], v1 offset:4096
    s_waitcnt lgkmcnt(4)
    v_smfmac_f32_16x16x64_bf16 v[16:19], v[24:27], a[0:7], v2
    v_smfmac_f32_16x16x64_bf16 v[20:23], v[24:27], a[80:87], v2
    s_waitcnt lgkmcnt(3)
    v_smfmac_f32_16x16x64_bf16 v[16:19], v[28:31], a[8:15], v2
    v_smfmac_f32_16x16x64_bf16 v[20:23], v[28:31], a[88:95], v2
    s_waitcnt lgkmcnt(2)
    v_smfmac_f32_16x16x64_bf16 v[16:19], v[32:35], a[16:23], v2
    v_smfmac_f32_16x16x64_bf16 v[20:23], v[32:35], a[96:103], v2
    s_waitcnt lgkmcnt(1)
    v_smfmac_f32_16x16x64_bf16 v[16:19], v[36:39], a[24:31], v2
    v_smfmac_f32_16x16x64_bf16 v[20:23], v[36:39], a[104:111], v2
    s_waitcnt lgkmcnt(0)
    v_smfmac_f32_16x16x64_bf16 v[16:19], v[40:43], a[32:39], v2
    v_smfmac_f32_16x16x64_bf16 v[20:23], v[40:43], a[112:119], v2
    s_barrier
    ds_read_b128 v[24:27], v1 offset:5120
    ds_read_b128 v[28:31], v1 offset:6144
    ds_read_b128 v[32:35], v1 offset:7168
    ds_read_b128 v[36:39], v1 offset:8192
    ds_read_b128 v[40:43], v1 offset:9216
    s_waitcnt lgkmcnt(4)
    v_smfmac_f32_16x16x64_bf16 v[16:19], v[24:27], a[40:47], v2
    v_smfmac_f32_16x16x64_bf16 v[20:23], v[24:27], a[120:127], v2
    s_waitcnt lgkmcnt(3)
    v_smfmac_f32_16x16x64_bf16 v[16:19], v[28:31], a[48:55], v2
    v_smfmac_f32_16x16x64_bf16 v[20:23], v[28:31], a[128:135], v2
    s_waitcnt lgkmcnt(2)
    v_smfmac_f32_16x16x64_bf16 v[16:19], v[32:35], a[56:63], v2
    v_smfmac_f32_16x16x64_bf16 v[20:23], v[32:35], a[136:143], v2
    s_waitcnt lgkmcnt(1)
    v_smfmac_f32_16x16x64_bf16 v[16:19], v[36:39], a[64:71], v2
    v_smfmac_f32_16x16x64_bf16 v[20:23], v[36:39], a[144:151], v2
    s_waitcnt lgkmcnt(0)
    v_smfmac_f32_16x16x64_bf16 v[16:19], v[40:43], a[72:79], v2
    v_smfmac_f32_16x16x64_bf16 v[20:23], v[40:43], a[152:159], v2
    s_nop 7
    v_permlane32_swap_b32 v16, v20
    v_permlane32_swap_b32 v17, v21
    v_permlane32_swap_b32 v18, v22
    v_permlane32_swap_b32 v19, v23
    v_pk_add_f32 v[16:17], v[16:17], v[20:21]
    v_pk_add_f32 v[18:19], v[18:19], v[22:23]
    v_cvt_pk_bf16_f32 v16, v16, v17
    v_cvt_pk_bf16_f32 v17, v18, v19
    ds_write_b64 v3, v[16:17]
    s_waitcnt lgkmcnt(0)
    s_barrier
Lqb_67:
    s_barrier
    s_add_u32 s60, s60, 1
    s_add_u32 s71, s71, 32768
    s_add_u32 s72, s72, 32768
    s_add_u32 s73, s73, 32768
    s_cmp_lt_u32 s60, 64
    s_cbranch_scc1 L_QK_w2_loop
    s_branch L_end
Lrt_65:
    s_sub_u32 s59, s59, 1
    s_cbranch_scc0 Lrg_68
    s_mov_b32 s59, 0
    s_branch Lckd_66
Lrg_68:
    s_waitcnt lgkmcnt(0)
    s_nop 7
    buffer_load_dwordx4 v[44:47], v88, s[4:7], s71 offen sc1
    buffer_load_dword v48, v89, s[4:7], s71 offen sc1
    s_waitcnt vmcnt(0)
    s_branch Lck_64
L_QK_w3:
    s_lshl_b32 s63, s55, 8
    s_add_u32 s63, s63, 2359296
    v_mov_b32 v92, s63
    s_lshl_b32 s90, s55, 19
    s_add_u32 s90, s90, 10485760
    s_mov_b32 s91, 16384
    v_mov_b32 v56, 0
    v_mov_b32 v57, 0
    s_mov_b32 s66, 0
    s_mov_b32 s89, s59
    s_lshr_b32 s67, s66, 1
Lfw_69:
    s_bitcmp1_b32 s66, 0
    s_cselect_b64 vcc, -1, 0
    v_cndmask_b32 v8, v56, v57, vcc
    v_cmp_ge_u32 vcc, s67, v8
    s_cbranch_vccz Lfwd_70
    buffer_load_dword v56, v92, s[4:7], 0 offen offset:0 sc1
    buffer_load_dword v57, v92, s[4:7], 0 offen offset:128 sc1
    s_waitcnt vmcnt(0)
    s_sub_u32 s89, s89, 1
    s_cbranch_scc0 Lfw_69
    s_mov_b32 s59, 0
Lfwd_70:
    s_mov_b32 m0, s91
    s_nop 0
    buffer_load_dwordx4 v1, s[4:7], s90 offen offset:0 sc1 lds
    buffer_load_dwordx4 v1, s[4:7], s90 offen offset:1024 sc1 lds
    buffer_load_dwordx4 v1, s[4:7], s90 offen offset:2048 sc1 lds
    buffer_load_dwordx4 v1, s[4:7], s90 offen offset:3072 sc1 lds
    s_add_u32 s90, s90, 4096
    s_add_u32 s91, s91, 4096
    s_mov_b32 m0, s91
    s_nop 0
    buffer_load_dwordx4 v1, s[4:7], s90 offen offset:0 sc1 lds
    buffer_load_dwordx4 v1, s[4:7], s90 offen offset:1024 sc1 lds
    buffer_load_dwordx4 v1, s[4:7], s90 offen offset:2048 sc1 lds
    buffer_load_dwordx4 v1, s[4:7], s90 offen offset:3072 sc1 lds
    s_add_u32 s90, s90, 4096
    s_add_u32 s91, s91, 4096
    buffer_load_dword v56, v92, s[4:7], 0 offen offset:0 sc1
    buffer_load_dword v57, v92, s[4:7], 0 offen offset:128 sc1
    s_and_b32 s91, s91, 0x3fff
    s_or_b32 s91, s91, 16384
L_QK_w3_loop:
    v_mov_b32 v16, 0
    v_mov_b32 v17, 0
    v_mov_b32 v18, 0
    v_mov_b32 v19, 0
    v_mov_b32 v20, 0
    v_mov_b32 v21, 0
    v_mov_b32 v22, 0
    v_mov_b32 v23, 0
    s_mov_b32 m0, s76
    s_barrier
    buffer_load_dwordx4 v[44:47], v88, s[4:7], s71 offen sc1
    buffer_load_dword v48, v89, s[4:7], s71 offen sc1
    s_waitcnt vmcnt(0)
Lck_71:
    ds_write_b128 v88, v[44:47] offset:0
    ds_write_b32 v89, v48 offset:0
    v_max3_u32 v8, v44, v45, v46
    v_max3_u32 v8, v8, v47, v48
    v_cmp_eq_u32 vcc, -1, v8
    s_waitcnt lgkmcnt(0)
    s_cbranch_vccnz Lrt_72
Lckd_73:
    s_barrier
    ds_read_b128 v[24:27], v1 offset:0
    ds_read_b128 v[28:31], v1 offset:1024
    ds_read_b128 v[32:35], v1 offset:2048
    ds_read_b128 v[36:39], v1 offset:3072
    ds_read_b128 v[40:43], v1 offset:4096
    s_waitcnt lgkmcnt(4)
    v_smfmac_f32_16x16x64_bf16 v[16:19], v[24:27], a[0:7], v2
    v_smfmac_f32_16x16x64_bf16 v[20:23], v[24:27], a[80:87], v2
    s_waitcnt lgkmcnt(3)
    v_smfmac_f32_16x16x64_bf16 v[16:19], v[28:31], a[8:15], v2
    v_smfmac_f32_16x16x64_bf16 v[20:23], v[28:31], a[88:95], v2
    s_waitcnt lgkmcnt(2)
    v_smfmac_f32_16x16x64_bf16 v[16:19], v[32:35], a[16:23], v2
    v_smfmac_f32_16x16x64_bf16 v[20:23], v[32:35], a[96:103], v2
    s_waitcnt lgkmcnt(1)
    v_smfmac_f32_16x16x64_bf16 v[16:19], v[36:39], a[24:31], v2
    v_smfmac_f32_16x16x64_bf16 v[20:23], v[36:39], a[104:111], v2
    s_waitcnt lgkmcnt(0)
    v_smfmac_f32_16x16x64_bf16 v[16:19], v[40:43], a[32:39], v2
    v_smfmac_f32_16x16x64_bf16 v[20:23], v[40:43], a[112:119], v2
    s_barrier
    ds_read_b128 v[24:27], v1 offset:5120
    ds_read_b128 v[28:31], v1 offset:6144
    ds_read_b128 v[32:35], v1 offset:7168
    ds_read_b128 v[36:39], v1 offset:8192
    ds_read_b128 v[40:43], v1 offset:9216
    s_waitcnt lgkmcnt(4)
    v_smfmac_f32_16x16x64_bf16 v[16:19], v[24:27], a[40:47], v2
    v_smfmac_f32_16x16x64_bf16 v[20:23], v[24:27], a[120:127], v2
    s_waitcnt lgkmcnt(3)
    v_smfmac_f32_16x16x64_bf16 v[16:19], v[28:31], a[48:55], v2
    v_smfmac_f32_16x16x64_bf16 v[20:23], v[28:31], a[128:135], v2
    s_waitcnt lgkmcnt(2)
    v_smfmac_f32_16x16x64_bf16 v[16:19], v[32:35], a[56:63], v2
    v_smfmac_f32_16x16x64_bf16 v[20:23], v[32:35], a[136:143], v2
    s_waitcnt lgkmcnt(1)
    v_smfmac_f32_16x16x64_bf16 v[16:19], v[36:39], a[64:71], v2
    v_smfmac_f32_16x16x64_bf16 v[20:23], v[36:39], a[144:151], v2
    s_waitcnt lgkmcnt(0)
    v_smfmac_f32_16x16x64_bf16 v[16:19], v[40:43], a[72:79], v2
    v_smfmac_f32_16x16x64_bf16 v[20:23], v[40:43], a[152:159], v2
    s_nop 7
    v_permlane32_swap_b32 v16, v20
    v_permlane32_swap_b32 v17, v21
    v_permlane32_swap_b32 v18, v22
    v_permlane32_swap_b32 v19, v23
    v_pk_add_f32 v[16:17], v[16:17], v[20:21]
    v_pk_add_f32 v[18:19], v[18:19], v[22:23]
    v_cvt_pk_bf16_f32 v16, v16, v17
    v_cvt_pk_bf16_f32 v17, v18, v19
    ds_write_b64 v3, v[16:17]
    s_waitcnt lgkmcnt(0)
    s_barrier
Lqb_74:
    s_barrier
    s_add_u32 s66, s60, 1
    s_cmp_ge_u32 s66, 64
    s_cbranch_scc1 Lk3_75
    s_mov_b32 s89, s59
    s_lshr_b32 s67, s66, 1
Lfw_76:
    s_bitcmp1_b32 s66, 0
    s_cselect_b64 vcc, -1, 0
    v_cndmask_b32 v8, v56, v57, vcc
    v_cmp_ge_u32 vcc, s67, v8
    s_cbranch_vccz Lfwd_77
    buffer_load_dword v56, v92, s[4:7], 0 offen offset:0 sc1
    buffer_load_dword v57, v92, s[4:7], 0 offen offset:128 sc1
    s_waitcnt vmcnt(0)
    s_sub_u32 s89, s89, 1
    s_cbranch_scc0 Lfw_76
    s_mov_b32 s59, 0
Lfwd_77:
    s_mov_b32 m0, s91
    s_nop 0
    buffer_load_dwordx4 v1, s[4:7], s90 offen offset:0 sc1 lds
    buffer_load_dwordx4 v1, s[4:7], s90 offen offset:1024 sc1 lds
    buffer_load_dwordx4 v1, s[4:7], s90 offen offset:2048 sc1 lds
    buffer_load_dwordx4 v1, s[4:7], s90 offen offset:3072 sc1 lds
    s_add_u32 s90, s90, 4096
    s_add_u32 s91, s91, 4096
    s_mov_b32 m0, s91
    s_nop 0
    buffer_load_dwordx4 v1, s[4:7], s90 offen offset:0 sc1 lds
    buffer_load_dwordx4 v1, s[4:7], s90 offen offset:1024 sc1 lds
    buffer_load_dwordx4 v1, s[4:7], s90 offen offset:2048 sc1 lds
    buffer_load_dwordx4 v1, s[4:7], s90 offen offset:3072 sc1 lds
    s_add_u32 s90, s90, 4096
    s_add_u32 s91, s91, 4096
    buffer_load_dword v56, v92, s[4:7], 0 offen offset:0 sc1
    buffer_load_dword v57, v92, s[4:7], 0 offen offset:128 sc1
    s_and_b32 s91, s91, 0x3fff
    s_or_b32 s91, s91, 16384
Lk3_75:
    s_add_u32 s60, s60, 1
    s_add_u32 s71, s71, 32768
    s_add_u32 s72, s72, 32768
    s_add_u32 s73, s73, 32768
    s_cmp_lt_u32 s60, 64
    s_cbranch_scc1 L_QK_w3_loop
    s_branch L_end
Lrt_72:
    s_sub_u32 s59, s59, 1
    s_cbranch_scc0 Lrg_78
    s_mov_b32 s59, 0
    s_branch Lckd_73
Lrg_78:
    s_waitcnt lgkmcnt(0)
    s_nop 7
    buffer_load_dwordx4 v[44:47], v88, s[4:7], s71 offen sc1
    buffer_load_dword v48, v89, s[4:7], s71 offen sc1
    s_waitcnt vmcnt(0)
    s_branch Lck_71
L_RVO:
    s_mov_b32 s55, s54
    v_lshrrev_b32 v14, 4, v0
    v_bfe_u32 v10, v0, 1, 3
    v_xor_b32 v10, v10, v14
    v_lshlrev_b32 v10, 5, v10
    v_and_b32 v14, 1, v0
    v_lshl_add_u32 v10, v14, 4, v10
    v_lshrrev_b32 v14, 4, v0
    v_mul_u32_u24 v14, 8192, v14
    v_add_u32 v10, v10, v14
    v_lshrrev_b32 v14, 4, v0
    v_or_b32 v14, 4, v14
    v_bfe_u32 v11, v0, 1, 3
    v_xor_b32 v11, v11, v14
    v_lshlrev_b32 v11, 5, v11
    v_and_b32 v14, 1, v0
    v_lshl_add_u32 v11, v14, 4, v11
    v_lshrrev_b32 v14, 4, v0
    v_mul_u32_u24 v14, 8192, v14
    v_add_u32 v11, v11, v14
    s_and_b32 s64, s52, 3
    s_lshl_b32 s64, s64, 1
    v_bfe_u32 v12, v0, 2, 3
    v_xor_b32 v12, s64, v12
    v_lshlrev_b32 v12, 5, v12
    v_and_b32 v14, 3, v0
    v_lshl_add_u32 v12, v14, 3, v12
    v_bfe_u32 v14, v0, 2, 2
    v_lshl_add_u32 v12, v14, 8, v12
    v_lshrrev_b32 v14, 4, v0
    v_lshl_add_u32 v12, v14, 11, v12
    v_bfe_u32 v16, v0, 3, 1
    v_or_b32 v16, s64, v16
    v_bfe_u32 v14, v0, 2, 1
    v_lshlrev_b32 v14, 1, v14
    v_xor_b32 v16, v16, v14
    v_bfe_u32 v14, v0, 4, 1
    v_lshlrev_b32 v14, 2, v14
    v_xor_b32 v16, v16, v14
    v_lshlrev_b32 v16, 5, v16
    v_and_b32 v14, 3, v0
    v_lshl_add_u32 v16, v14, 3, v16
    v_bfe_u32 v14, v0, 2, 1
    v_lshl_add_u32 v16, v14, 8, v16
    v_lshrrev_b32 v14, 4, v0
    v_lshl_add_u32 v16, v14, 10, v16
    s_mov_b32 s12, s24
    s_and_b32 s13, s25, 0xffff
    s_mov_b32 s14, 5242880
    s_mov_b32 s15, 0x00020000
    s_lshl_b32 s62, s52, 4
    s_add_u32 s62, s62, 0
    s_lshl_b32 s62, s62, 13
    s_lshl_b32 s63, s55, 8
    s_add_u32 s62, s62, s63
    s_lshl_b32 s63, s52, 12
    s_add_u32 s63, s63, 65536
    s_mov_b32 m0, s63
    s_nop 0
    buffer_load_dwordx4 v10, s[12:15], s62 offen lds
    s_add_u32 s62, s62, 32768
    s_add_u32 s63, s63, 1024
    s_mov_b32 m0, s63
    s_nop 0
    buffer_load_dwordx4 v10, s[12:15], s62 offen lds
    s_add_u32 s62, s62, 32768
    s_add_u32 s63, s63, 1024
    s_mov_b32 m0, s63
    s_nop 0
    buffer_load_dwordx4 v11, s[12:15], s62 offen lds
    s_add_u32 s62, s62, 32768
    s_add_u32 s63, s63, 1024
    s_mov_b32 m0, s63
    s_nop 0
    buffer_load_dwordx4 v11, s[12:15], s62 offen lds
    s_waitcnt vmcnt(4)
    s_barrier
    s_or_b32 s62, s52, s30
    s_cbranch_scc1 Lci_79
    s_lshl_b32 s62, 1, s54
    s_lshl_b32 s63, s53, 5
    v_mov_b32 v20, s62
    v_mov_b32 v14, s63
    s_mov_b64 exec, 1
    buffer_atomic_or v20, v14, s[8:11], 0 offen sc0
    s_mov_b64 exec, -1
Lci_79:
    v_min_u32 v23, 7, v0
    v_lshlrev_b32 v23, 5, v23
    s_lshl_b32 s62, s52, 4
    s_add_u32 s62, s62, 128
    s_lshl_b32 s62, s62, 13
    s_lshl_b32 s63, s55, 8
    s_add_u32 s62, s62, s63
    s_lshl_b32 s63, s52, 12
    s_add_u32 s63, s63, 98304
    s_mov_b32 m0, s63
    s_nop 0
    buffer_load_dwordx4 v10, s[12:15], s62 offen lds
    s_add_u32 s62, s62, 32768
    s_add_u32 s63, s63, 1024
    s_mov_b32 m0, s63
    s_nop 0
    buffer_load_dwordx4 v10, s[12:15], s62 offen lds
    s_add_u32 s62, s62, 32768
    s_add_u32 s63, s63, 1024
    s_mov_b32 m0, s63
    s_nop 0
    buffer_load_dwordx4 v11, s[12:15], s62 offen lds
    s_add_u32 s62, s62, 32768
    s_add_u32 s63, s63, 1024
    s_mov_b32 m0, s63
    s_nop 0
    buffer_load_dwordx4 v11, s[12:15], s62 offen lds
    s_lshl_b32 s62, s52, 4
    s_add_u32 s62, s62, 256
    s_lshl_b32 s62, s62, 13
    s_lshl_b32 s63, s55, 8
    s_add_u32 s62, s62, s63
    s_lshl_b32 s63, s52, 12
    s_add_u32 s63, s63, 131072
    s_mov_b32 m0, s63
    s_nop 0
    buffer_load_dwordx4 v10, s[12:15], s62 offen lds
    s_add_u32 s62, s62, 32768
    s_add_u32 s63, s63, 1024
    s_mov_b32 m0, s63
    s_nop 0
    buffer_load_dwordx4 v10, s[12:15], s62 offen lds
    s_add_u32 s62, s62, 32768
    s_add_u32 s63, s63, 1024
    s_mov_b32 m0, s63
    s_nop 0
    buffer_load_dwordx4 v11, s[12:15], s62 offen lds
    s_add_u32 s62, s62, 32768
    s_add_u32 s63, s63, 1024
    s_mov_b32 m0, s63
    s_nop 0
    buffer_load_dwordx4 v11, s[12:15], s62 offen lds
    s_waitcnt vmcnt(8)
    s_barrier
    v_add_u32 v13, 65536, v12
    s_cmp_ge_u32 s52, 4
    s_cbranch_scc1 Lvv_80
    ds_read_b64_tr_b16 a[0:1], v13 offset:0
    ds_read_b64_tr_b16 a[2:3], v13 offset:1024
    ds_read_b64_tr_b16 a[4:5], v13 offset:8192
    ds_read_b64_tr_b16 a[6:7], v13 offset:9216
    ds_read_b64_tr_b16 a[8:9], v13 offset:16384
    ds_read_b64_tr_b16 a[10:11], v13 offset:17408
    ds_read_b64_tr_b16 a[12:13], v13 offset:24576
    ds_read_b64_tr_b16 a[14:15], v13 offset:25600
    v_xor_b32 v13, 32, v13
    ds_read_b64_tr_b16 a[80:81], v13 offset:0
    ds_read_b64_tr_b16 a[82:83], v13 offset:1024
    ds_read_b64_tr_b16 a[84:85], v13 offset:8192
    ds_read_b64_tr_b16 a[86:87], v13 offset:9216
    ds_read_b64_tr_b16 a[88:89], v13 offset:16384
    ds_read_b64_tr_b16 a[90:91], v13 offset:17408
    ds_read_b64_tr_b16 a[92:93], v13 offset:24576
    ds_read_b64_tr_b16 a[94:95], v13 offset:25600
Lvv_80:
    s_waitcnt lgkmcnt(0)
    s_barrier
    s_lshl_b32 s62, s52, 4
    s_add_u32 s62, s62, 384
    s_lshl_b32 s62, s62, 13
    s_lshl_b32 s63, s55, 8
    s_add_u32 s62, s62, s63
    s_lshl_b32 s63, s52, 12
    s_add_u32 s63, s63, 65536
    s_mov_b32 m0, s63
    s_nop 0
    buffer_load_dwordx4 v10, s[12:15], s62 offen lds
    s_add_u32 s62, s62, 32768
    s_add_u32 s63, s63, 1024
    s_mov_b32 m0, s63
    s_nop 0
    buffer_load_dwordx4 v10, s[12:15], s62 offen lds
    s_add_u32 s62, s62, 32768
    s_add_u32 s63, s63, 1024
    s_mov_b32 m0, s63
    s_nop 0
    buffer_load_dwordx4 v11, s[12:15], s62 offen lds
    s_add_u32 s62, s62, 32768
    s_add_u32 s63, s63, 1024
    s_mov_b32 m0, s63
    s_nop 0
    buffer_load_dwordx4 v11, s[12:15], s62 offen lds
    s_waitcnt vmcnt(8)
    s_barrier
    v_add_u32 v13, 98304, v12
    s_cmp_ge_u32 s52, 4
    s_cbranch_scc1 Lvv_81
    ds_read_b64_tr_b16 a[16:17], v13 offset:0
    ds_read_b64_tr_b16 a[18:19], v13 offset:1024
    ds_read_b64_tr_b16 a[20:21], v13 offset:8192
    ds_read_b64_tr_b16 a[22:23], v13 offset:9216
    ds_read_b64_tr_b16 a[24:25], v13 offset:16384
    ds_read_b64_tr_b16 a[26:27], v13 offset:17408
    ds_read_b64_tr_b16 a[28:29], v13 offset:24576
    ds_read_b64_tr_b16 a[30:31], v13 offset:25600
    v_xor_b32 v13, 32, v13
    ds_read_b64_tr_b16 a[96:97], v13 offset:0
    ds_read_b64_tr_b16 a[98:99], v13 offset:1024
    ds_read_b64_tr_b16 a[100:101], v13 offset:8192
    ds_read_b64_tr_b16 a[102:103], v13 offset:9216
    ds_read_b64_tr_b16 a[104:105], v13 offset:16384
    ds_read_b64_tr_b16 a[106:107], v13 offset:17408
    ds_read_b64_tr_b16 a[108:109], v13 offset:24576
    ds_read_b64_tr_b16 a[110:111], v13 offset:25600
Lvv_81:
    s_waitcnt lgkmcnt(0)
    s_barrier
    s_lshl_b32 s62, s52, 4
    s_add_u32 s62, s62, 512
    s_lshl_b32 s62, s62, 13
    s_lshl_b32 s63, s55, 8
    s_add_u32 s62, s62, s63
    s_lshl_b32 s63, s52, 12
    s_add_u32 s63, s63, 98304
    s_mov_b32 m0, s63
    s_nop 0
    buffer_load_dwordx4 v10, s[12:15], s62 offen lds
    s_add_u32 s62, s62, 32768
    s_add_u32 s63, s63, 1024
    s_mov_b32 m0, s63
    s_nop 0
    buffer_load_dwordx4 v10, s[12:15], s62 offen lds
    s_add_u32 s62, s62, 32768
    s_add_u32 s63, s63, 1024
    s_mov_b32 m0, s63
    s_nop 0
    buffer_load_dwordx4 v11, s[12:15], s62 offen lds
    s_add_u32 s62, s62, 32768
    s_add_u32 s63, s63, 1024
    s_mov_b32 m0, s63
    s_nop 0
    buffer_load_dwordx4 v11, s[12:15], s62 offen lds
    s_waitcnt vmcnt(8)
    s_barrier
    v_add_u32 v13, 131072, v12
    s_cmp_ge_u32 s52, 4
    s_cbranch_scc1 Lvv_82
    ds_read_b64_tr_b16 a[32:33], v13 offset:0
    ds_read_b64_tr_b16 a[34:35], v13 offset:1024
    ds_read_b64_tr_b16 a[36:37], v13 offset:8192
    ds_read_b64_tr_b16 a[38:39], v13 offset:9216
    ds_read_b64_tr_b16 a[40:41], v13 offset:16384
    ds_read_b64_tr_b16 a[42:43], v13 offset:17408
    ds_read_b64_tr_b16 a[44:45], v13 offset:24576
    ds_read_b64_tr_b16 a[46:47], v13 offset:25600
    v_xor_b32 v13, 32, v13
    ds_read_b64_tr_b16 a[112:113], v13 offset:0
    ds_read_b64_tr_b16 a[114:115], v13 offset:1024
    ds_read_b64_tr_b16 a[116:117], v13 offset:8192
    ds_read_b64_tr_b16 a[118:119], v13 offset:9216
    ds_read_b64_tr_b16 a[120:121], v13 offset:16384
    ds_read_b64_tr_b16 a[122:123], v13 offset:17408
    ds_read_b64_tr_b16 a[124:125], v13 offset:24576
    ds_read_b64_tr_b16 a[126:127], v13 offset:25600
Lvv_82:
    s_waitcnt lgkmcnt(0)
    s_barrier
    s_mov_b32 s12, s26
    s_and_b32 s13, s27, 0xffff
    s_mov_b32 s14, 5242880
    s_mov_b32 s15, 0x00020000
    v_bfe_u32 v14, v0, 4, 1
    v_lshlrev_b32 v14, 1, v14
    v_bfe_u32 v10, v0, 1, 3
    v_xor_b32 v10, v10, v14
    v_lshlrev_b32 v10, 5, v10
    v_and_b32 v14, 1, v0
    v_lshl_add_u32 v10, v14, 4, v10
    v_lshrrev_b32 v14, 4, v0
    v_mul_u32_u24 v14, 1280, v14
    v_add_u32 v10, v10, v14
    v_bfe_u32 v14, v0, 4, 1
    v_lshlrev_b32 v14, 1, v14
    v_or_b32 v14, 4, v14
    v_bfe_u32 v11, v0, 1, 3
    v_xor_b32 v11, v11, v14
    v_lshlrev_b32 v11, 5, v11
    v_and_b32 v14, 1, v0
    v_lshl_add_u32 v11, v14, 4, v11
    v_lshrrev_b32 v14, 4, v0
    v_mul_u32_u24 v14, 1280, v14
    v_add_u32 v11, v11, v14
    s_lshl_b32 s62, s55, 7
    s_lshl_b32 s63, s52, 4
    s_add_u32 s62, s62, s63
    s_mul_i32 s62, s62, 1280
    s_add_u32 s62, s62, 0
    s_lshl_b32 s63, s52, 12
    s_add_u32 s63, s63, 131072
    s_mov_b32 m0, s63
    s_nop 0
    buffer_load_dwordx4 v10, s[12:15], s62 offen lds
    s_add_u32 s62, s62, 5120
    s_add_u32 s63, s63, 1024
    s_mov_b32 m0, s63
    s_nop 0
    buffer_load_dwordx4 v11, s[12:15], s62 offen lds
    s_add_u32 s62, s62, 5120
    s_add_u32 s63, s63, 1024
    s_mov_b32 m0, s63
    s_nop 0
    buffer_load_dwordx4 v10, s[12:15], s62 offen lds
    s_add_u32 s62, s62, 5120
    s_add_u32 s63, s63, 1024
    s_mov_b32 m0, s63
    s_nop 0
    buffer_load_dwordx4 v11, s[12:15], s62 offen lds
    s_waitcnt vmcnt(8)
    s_barrier
    v_add_u32 v13, 65536, v12
    s_cmp_ge_u32 s52, 4
    s_cbranch_scc1 Lvv_83
    ds_read_b64_tr_b16 a[48:49], v13 offset:0
    ds_read_b64_tr_b16 a[50:51], v13 offset:1024
    ds_read_b64_tr_b16 a[52:53], v13 offset:8192
    ds_read_b64_tr_b16 a[54:55], v13 offset:9216
    ds_read_b64_tr_b16 a[56:57], v13 offset:16384
    ds_read_b64_tr_b16 a[58:59], v13 offset:17408
    ds_read_b64_tr_b16 a[60:61], v13 offset:24576
    ds_read_b64_tr_b16 a[62:63], v13 offset:25600
    v_xor_b32 v13, 32, v13
    ds_read_b64_tr_b16 a[128:129], v13 offset:0
    ds_read_b64_tr_b16 a[130:131], v13 offset:1024
    ds_read_b64_tr_b16 a[132:133], v13 offset:8192
    ds_read_b64_tr_b16 a[134:135], v13 offset:9216
    ds_read_b64_tr_b16 a[136:137], v13 offset:16384
    ds_read_b64_tr_b16 a[138:139], v13 offset:17408
    ds_read_b64_tr_b16 a[140:141], v13 offset:24576
    ds_read_b64_tr_b16 a[142:143], v13 offset:25600
Lvv_83:
    s_waitcnt lgkmcnt(0)
    s_barrier
    s_lshl_b32 s62, s55, 7
    s_lshl_b32 s63, s52, 4
    s_add_u32 s62, s62, s63
    s_mul_i32 s62, s62, 1280
    s_add_u32 s62, s62, 256
    s_lshl_b32 s63, s52, 12
    s_add_u32 s63, s63, 65536
    s_mov_b32 m0, s63
    s_nop 0
    buffer_load_dwordx4 v10, s[12:15], s62 offen lds
    s_add_u32 s62, s62, 5120
    s_add_u32 s63, s63, 1024
    s_mov_b32 m0, s63
    s_nop 0
    buffer_load_dwordx4 v11, s[12:15], s62 offen lds
    s_add_u32 s62, s62, 5120
    s_add_u32 s63, s63, 1024
    s_mov_b32 m0, s63
    s_nop 0
    buffer_load_dwordx4 v10, s[12:15], s62 offen lds
    s_add_u32 s62, s62, 5120
    s_add_u32 s63, s63, 1024
    s_mov_b32 m0, s63
    s_nop 0
    buffer_load_dwordx4 v11, s[12:15], s62 offen lds
    s_waitcnt vmcnt(8)
    s_barrier
    v_add_u32 v13, 98304, v12
    s_cmp_ge_u32 s52, 4
    s_cbranch_scc1 Lvv_84
    ds_read_b64_tr_b16 a[64:65], v13 offset:0
    ds_read_b64_tr_b16 a[66:67], v13 offset:1024
    ds_read_b64_tr_b16 a[68:69], v13 offset:8192
    ds_read_b64_tr_b16 a[70:71], v13 offset:9216
    ds_read_b64_tr_b16 a[72:73], v13 offset:16384
    ds_read_b64_tr_b16 a[74:75], v13 offset:17408
    ds_read_b64_tr_b16 a[76:77], v13 offset:24576
    ds_read_b64_tr_b16 a[78:79], v13 offset:25600
    v_xor_b32 v13, 32, v13
    ds_read_b64_tr_b16 a[144:145], v13 offset:0
    ds_read_b64_tr_b16 a[146:147], v13 offset:1024
    ds_read_b64_tr_b16 a[148:149], v13 offset:8192
    ds_read_b64_tr_b16 a[150:151], v13 offset:9216
    ds_read_b64_tr_b16 a[152:153], v13 offset:16384
    ds_read_b64_tr_b16 a[154:155], v13 offset:17408
    ds_read_b64_tr_b16 a[156:157], v13 offset:24576
    ds_read_b64_tr_b16 a[158:159], v13 offset:25600
Lvv_84:
    s_waitcnt lgkmcnt(0)
    s_barrier
    s_lshl_b32 s62, s55, 7
    s_lshl_b32 s63, s52, 4
    s_add_u32 s62, s62, s63
    s_mul_i32 s62, s62, 1280
    s_add_u32 s62, s62, 512
    s_lshl_b32 s63, s52, 12
    s_add_u32 s63, s63, 98304
    s_mov_b32 m0, s63
    s_nop 0
    buffer_load_dwordx4 v10, s[12:15], s62 offen lds
    s_add_u32 s62, s62, 5120
    s_add_u32 s63, s63, 1024
    s_mov_b32 m0, s63
    s_nop 0
    buffer_load_dwordx4 v11, s[12:15], s62 offen lds
    s_add_u32 s62, s62, 5120
    s_add_u32 s63, s63, 1024
    s_mov_b32 m0, s63
    s_nop 0
    buffer_load_dwordx4 v10, s[12:15], s62 offen lds
    s_add_u32 s62, s62, 5120
    s_add_u32 s63, s63, 1024
    s_mov_b32 m0, s63
    s_nop 0
    buffer_load_dwordx4 v11, s[12:15], s62 offen lds
    s_waitcnt vmcnt(8)
    s_barrier
    buffer_load_dword v21, v23, s[8:11], 0 offen sc1
    v_add_u32 v13, 131072, v16
    s_cmp_ge_u32 s52, 4
    s_cbranch_scc0 Lwo_85
    ds_read_b64_tr_b16 a[0:1], v13 offset:0
    ds_read_b64_tr_b16 a[2:3], v13 offset:512
    ds_read_b64_tr_b16 a[4:5], v13 offset:4096
    ds_read_b64_tr_b16 a[6:7], v13 offset:4608
    ds_read_b64_tr_b16 a[8:9], v13 offset:8192
    ds_read_b64_tr_b16 a[10:11], v13 offset:8704
    ds_read_b64_tr_b16 a[12:13], v13 offset:12288
    ds_read_b64_tr_b16 a[14:15], v13 offset:12800
    ds_read_b64_tr_b16 a[16:17], v13 offset:16384
    ds_read_b64_tr_b16 a[18:19], v13 offset:16896
    ds_read_b64_tr_b16 a[20:21], v13 offset:20480
    ds_read_b64_tr_b16 a[22:23], v13 offset:20992
    ds_read_b64_tr_b16 a[24:25], v13 offset:24576
    ds_read_b64_tr_b16 a[26:27], v13 offset:25088
    ds_read_b64_tr_b16 a[28:29], v13 offset:28672
    ds_read_b64_tr_b16 a[30:31], v13 offset:29184
Lwo_85:
    s_waitcnt lgkmcnt(0)
    s_barrier
    s_lshl_b32 s62, s55, 7
    s_lshl_b32 s63, s52, 4
    s_add_u32 s62, s62, s63
    s_mul_i32 s62, s62, 1280
    s_add_u32 s62, s62, 768
    s_lshl_b32 s63, s52, 12
    s_add_u32 s63, s63, 131072
    s_mov_b32 m0, s63
    s_nop 0
    buffer_load_dwordx4 v10, s[12:15], s62 offen lds
    s_add_u32 s62, s62, 5120
    s_add_u32 s63, s63, 1024
    s_mov_b32 m0, s63
    s_nop 0
    buffer_load_dwordx4 v11, s[12:15], s62 offen lds
    s_add_u32 s62, s62, 5120
    s_add_u32 s63, s63, 1024
    s_mov_b32 m0, s63
    s_nop 0
    buffer_load_dwordx4 v10, s[12:15], s62 offen lds
    s_add_u32 s62, s62, 5120
    s_add_u32 s63, s63, 1024
    s_mov_b32 m0, s63
    s_nop 0
    buffer_load_dwordx4 v11, s[12:15], s62 offen lds
    s_waitcnt vmcnt(8)
    s_barrier
    v_add_u32 v13, 65536, v16
    s_cmp_ge_u32 s52, 4
    s_cbranch_scc0 Lwo_86
    ds_read_b64_tr_b16 a[32:33], v13 offset:0
    ds_read_b64_tr_b16 a[34:35], v13 offset:512
    ds_read_b64_tr_b16 a[36:37], v13 offset:4096
    ds_read_b64_tr_b16 a[38:39], v13 offset:4608
    ds_read_b64_tr_b16 a[40:41], v13 offset:8192
    ds_read_b64_tr_b16 a[42:43], v13 offset:8704
    ds_read_b64_tr_b16 a[44:45], v13 offset:12288
    ds_read_b64_tr_b16 a[46:47], v13 offset:12800
    ds_read_b64_tr_b16 a[48:49], v13 offset:16384
    ds_read_b64_tr_b16 a[50:51], v13 offset:16896
    ds_read_b64_tr_b16 a[52:53], v13 offset:20480
    ds_read_b64_tr_b16 a[54:55], v13 offset:20992
    ds_read_b64_tr_b16 a[56:57], v13 offset:24576
    ds_read_b64_tr_b16 a[58:59], v13 offset:25088
    ds_read_b64_tr_b16 a[60:61], v13 offset:28672
    ds_read_b64_tr_b16 a[62:63], v13 offset:29184
Lwo_86:
    s_waitcnt lgkmcnt(0)
    s_barrier
    s_lshl_b32 s62, s55, 7
    s_lshl_b32 s63, s52, 4
    s_add_u32 s62, s62, s63
    s_mul_i32 s62, s62, 1280
    s_add_u32 s62, s62, 1024
    s_lshl_b32 s63, s52, 12
    s_add_u32 s63, s63, 65536
    s_mov_b32 m0, s63
    s_nop 0
    buffer_load_dwordx4 v10, s[12:15], s62 offen lds
    s_add_u32 s62, s62, 5120
    s_add_u32 s63, s63, 1024
    s_mov_b32 m0, s63
    s_nop 0
    buffer_load_dwordx4 v11, s[12:15], s62 offen lds
    s_add_u32 s62, s62, 5120
    s_add_u32 s63, s63, 1024
    s_mov_b32 m0, s63
    s_nop 0
    buffer_load_dwordx4 v10, s[12:15], s62 offen lds
    s_add_u32 s62, s62, 5120
    s_add_u32 s63, s63, 1024
    s_mov_b32 m0, s63
    s_nop 0
    buffer_load_dwordx4 v11, s[12:15], s62 offen lds
    s_waitcnt vmcnt(8)
    s_barrier
    v_add_u32 v13, 98304, v16
    s_cmp_ge_u32 s52, 4
    s_cbranch_scc0 Lwo_87
    ds_read_b64_tr_b16 a[64:65], v13 offset:0
    ds_read_b64_tr_b16 a[66:67], v13 offset:512
    ds_read_b64_tr_b16 a[68:69], v13 offset:4096
    ds_read_b64_tr_b16 a[70:71], v13 offset:4608
    ds_read_b64_tr_b16 a[72:73], v13 offset:8192
    ds_read_b64_tr_b16 a[74:75], v13 offset:8704
    ds_read_b64_tr_b16 a[76:77], v13 offset:12288
    ds_read_b64_tr_b16 a[78:79], v13 offset:12800
    ds_read_b64_tr_b16 a[80:81], v13 offset:16384
    ds_read_b64_tr_b16 a[82:83], v13 offset:16896
    ds_read_b64_tr_b16 a[84:85], v13 offset:20480
    ds_read_b64_tr_b16 a[86:87], v13 offset:20992
    ds_read_b64_tr_b16 a[88:89], v13 offset:24576
    ds_read_b64_tr_b16 a[90:91], v13 offset:25088
    ds_read_b64_tr_b16 a[92:93], v13 offset:28672
    ds_read_b64_tr_b16 a[94:95], v13 offset:29184
Lwo_87:
    s_waitcnt lgkmcnt(0)
    s_waitcnt vmcnt(4)
    s_barrier
    buffer_load_dword v22, v23, s[8:11], 0 offen offset:4 sc1
    v_add_u32 v13, 131072, v16
    s_cmp_ge_u32 s52, 4
    s_cbranch_scc0 Lwo_88
    ds_read_b64_tr_b16 a[96:97], v13 offset:0
    ds_read_b64_tr_b16 a[98:99], v13 offset:512
    ds_read_b64_tr_b16 a[100:101], v13 offset:4096
    ds_read_b64_tr_b16 a[102:103], v13 offset:4608
    ds_read_b64_tr_b16 a[104:105], v13 offset:8192
    ds_read_b64_tr_b16 a[106:107], v13 offset:8704
    ds_read_b64_tr_b16 a[108:109], v13 offset:12288
    ds_read_b64_tr_b16 a[110:111], v13 offset:12800
    ds_read_b64_tr_b16 a[112:113], v13 offset:16384
    ds_read_b64_tr_b16 a[114:115], v13 offset:16896
    ds_read_b64_tr_b16 a[116:117], v13 offset:20480
    ds_read_b64_tr_b16 a[118:119], v13 offset:20992
    ds_read_b64_tr_b16 a[120:121], v13 offset:24576
    ds_read_b64_tr_b16 a[122:123], v13 offset:25088
    ds_read_b64_tr_b16 a[124:125], v13 offset:28672
    ds_read_b64_tr_b16 a[126:127], v13 offset:29184
Lwo_88:
    s_waitcnt lgkmcnt(0)
    s_waitcnt vmcnt(0)
    s_barrier
    s_cmp_lg_u32 s52, 0
    s_cbranch_scc1 Llc_89
    v_readfirstlane_b32 s62, v20
    s_nop 0
    s_lshr_b32 s62, s62, s54
    s_andn2_b32 s62, s62, s30
    s_and_b32 s62, s62, 1
    v_cmp_ne_u32 vcc, -1, v21
    s_nop 0
    s_cmp_lg_u64 vcc, 0
    s_cselect_b32 s62, 1, s62
    v_mov_b32 v21, s62
    v_mov_b32 v23, 131072
    ds_write_b32 v23, v21
Llc_89:
    v_add_u32 v13, 65536, v16
    s_cmp_ge_u32 s52, 4
    s_cbranch_scc0 Lwo_90
    ds_read_b64_tr_b16 a[128:129], v13 offset:0
    ds_read_b64_tr_b16 a[130:131], v13 offset:512
    ds_read_b64_tr_b16 a[132:133], v13 offset:4096
    ds_read_b64_tr_b16 a[134:135], v13 offset:4608
    ds_read_b64_tr_b16 a[136:137], v13 offset:8192
    ds_read_b64_tr_b16 a[138:139], v13 offset:8704
    ds_read_b64_tr_b16 a[140:141], v13 offset:12288
    ds_read_b64_tr_b16 a[142:143], v13 offset:12800
    ds_read_b64_tr_b16 a[144:145], v13 offset:16384
    ds_read_b64_tr_b16 a[146:147], v13 offset:16896
    ds_read_b64_tr_b16 a[148:149], v13 offset:20480
    ds_read_b64_tr_b16 a[150:151], v13 offset:20992
    ds_read_b64_tr_b16 a[152:153], v13 offset:24576
    ds_read_b64_tr_b16 a[154:155], v13 offset:25088
    ds_read_b64_tr_b16 a[156:157], v13 offset:28672
    ds_read_b64_tr_b16 a[158:159], v13 offset:29184
Lwo_90:
    s_waitcnt lgkmcnt(0)
    s_barrier
    v_mov_b32 v23, 131072
    ds_read_b32 v23, v23
    v_readlane_b32 s62, v22, 1
    v_readlane_b32 s63, v22, 2
    v_readlane_b32 s61, v22, 3
    s_waitcnt lgkmcnt(0)
    v_cmp_eq_u32 vcc, 0, v23
    s_cbranch_vccnz Llf_91
    v_min_u32 v15, 7, v0
    v_lshlrev_b32 v15, 5, v15
    s_cmp_lg_u32 s52, 0
    s_cbranch_scc1 Lwid_93
    s_mov_b32 s64, 0
    s_cmp_lg_u32 s30, 0
    s_cbranch_scc1 Lwok_94
    s_waitcnt vmcnt(0)
    v_readfirstlane_b32 s62, v20
    s_nop 0
    s_lshr_b32 s62, s62, s54
    s_and_b32 s64, s62, 1
Lwok_94:
    v_mov_b32 v14, 163832
    v_mov_b32 v20, s64
    ds_write_b32 v14, v20
    s_waitcnt lgkmcnt(0)
    s_cmp_lg_u32 s64, 0
    s_cbranch_scc1 Lwid_93
    s_mov_b32 s89, s59
Lwi_92:
    buffer_load_dword v14, v15, s[8:11], 0 offen sc1
    s_waitcnt vmcnt(0)
    v_cmp_ne_u32 vcc, -1, v14
    s_cbranch_vccz Lwid_93
    s_sleep 8
    s_sub_u32 s89, s89, 8
    s_cbranch_scc0 Lwi_92
    s_mov_b32 s59, 0
Lwid_93:
    s_barrier
    buffer_load_dword v14, v15, s[8:11], 0 offen offset:4 sc1
    v_mov_b32 v15, 163832
    ds_read_b32 v15, v15
    s_waitcnt vmcnt(0) lgkmcnt(0)
    v_readfirstlane_b32 s62, v15
    s_nop 0
    s_cmp_lg_u32 s62, 0
    s_cbranch_scc1 L_reclaim
    v_readlane_b32 s62, v14, 1
    v_readlane_b32 s63, v14, 2
    v_readlane_b32 s61, v14, 3
Llf_91:
    s_cmp_gt_u32 s63, s62
    s_cselect_b32 s46, 0x2000, 0
    s_mul_i32 s65, s56, 4194304
    s_add_u32 s69, s65, s46
    s_xor_b32 s68, s69, 0x2000
    s_sub_u32 s65, 4194304, s65
    s_add_u32 s70, s65, s46
    s_mov_b32 s60, 0
    s_mov_b32 s71, s68
    s_mov_b32 s72, s69
    s_mov_b32 s73, s70
    v_lshlrev_b32 v1, 4, v0
    v_mov_b32 v2, 0x4444
    v_mov_b32 v8, 0xeeee
    v_and_b32 v9, 8, v0
    v_cmp_ne_u32 vcc, 0, v9
    s_nop 1
    v_cndmask_b32 v2, v2, v8, vcc
    s_mul_i32 s62, s52, 1280
    v_add_u32 v15, s62, v1
    s_add_u32 s62, s62, 1024
    v_lshlrev_b32 v4, 2, v0
    v_add_u32 v4, s62, v4
    s_lshr_b32 s62, s52, 2
    s_mul_i32 s62, s62, 11264
    s_add_u32 s62, s62, 2048
    v_add_u32 v13, s62, v15
    v_add_u32 v14, s62, v4
    s_cmp_ge_u32 s52, 4
    s_cbranch_scc1 L_VO_hi
    v_and_b32 v3, 15, v0
    v_lshlrev_b32 v3, 4, v3
    v_bfe_u32 v8, v0, 4, 1
    v_lshl_add_u32 v3, v8, 3, v3
    v_lshrrev_b32 v8, 5, v0
    v_lshl_add_u32 v3, v8, 8, v3
    s_lshl_b32 s62, s52, 9
    s_add_u32 s62, s62, 10240
    v_add_u32 v3, s62, v3
L_VO_lo:
    v_mov_b32 v16, 0
    v_mov_b32 v17, 0
    v_mov_b32 v18, 0
    v_mov_b32 v19, 0
    v_mov_b32 v20, 0
    v_mov_b32 v21, 0
    v_mov_b32 v22, 0
    v_mov_b32 v23, 0
Lvp_95:
    buffer_load_dwordx4 v[64:67], v13, s[4:7], s72 offen sc1
    buffer_load_dword v68, v14, s[4:7], s72 offen sc1
    s_waitcnt vmcnt(0)
    v_max3_u32 v8, v64, v65, v66
    v_max3_u32 v8, v8, v67, v68
    v_cmp_eq_u32 vcc, -1, v8
    s_cbranch_vccz Lvk_97
    s_sub_u32 s59, s59, 1
    s_cbranch_scc0 Lvp_95
    s_mov_b32 s59, 0
Lvk_97:
    ds_write_b128 v15, v[64:67] offset:0
    ds_write_b32 v4, v68 offset:0
Lvd_96:
    s_waitcnt lgkmcnt(0)
    s_barrier
    ds_read_b128 v[24:27], v1 offset:0
    ds_read_b128 v[28:31], v1 offset:1024
    ds_read_b128 v[32:35], v1 offset:2048
    ds_read_b128 v[36:39], v1 offset:3072
    ds_read_b128 v[40:43], v1 offset:4096
    ds_read_b128 v[44:47], v1 offset:5120
    ds_read_b128 v[48:51], v1 offset:6144
    ds_read_b128 v[52:55], v1 offset:7168
    ds_read_b128 v[56:59], v1 offset:8192
    ds_read_b128 v[60:63], v1 offset:9216
    s_waitcnt lgkmcnt(9)
    v_smfmac_f32_16x16x64_bf16 v[16:19], v[24:27], a[0:7], v2
    v_smfmac_f32_16x16x64_bf16 v[20:23], v[24:27], a[80:87], v2
    s_waitcnt lgkmcnt(8)
    v_smfmac_f32_16x16x64_bf16 v[16:19], v[28:31], a[8:15], v2
    v_smfmac_f32_16x16x64_bf16 v[20:23], v[28:31], a[88:95], v2
    s_waitcnt lgkmcnt(7)
    v_smfmac_f32_16x16x64_bf16 v[16:19], v[32:35], a[16:23], v2
    v_smfmac_f32_16x16x64_bf16 v[20:23], v[32:35], a[96:103], v2
    s_waitcnt lgkmcnt(6)
    v_smfmac_f32_16x16x64_bf16 v[16:19], v[36:39], a[24:31], v2
    v_smfmac_f32_16x16x64_bf16 v[20:23], v[36:39], a[104:111], v2
    s_waitcnt lgkmcnt(5)
    v_smfmac_f32_16x16x64_bf16 v[16:19], v[40:43], a[32:39], v2
    v_smfmac_f32_16x16x64_bf16 v[20:23], v[40:43], a[112:119], v2
    s_waitcnt lgkmcnt(4)
    v_smfmac_f32_16x16x64_bf16 v[16:19], v[44:47], a[40:47], v2
    v_smfmac_f32_16x16x64_bf16 v[20:23], v[44:47], a[120:127], v2
    s_waitcnt lgkmcnt(3)
    v_smfmac_f32_16x16x64_bf16 v[16:19], v[48:51], a[48:55], v2
    v_smfmac_f32_16x16x64_bf16 v[20:23], v[48:51], a[128:135], v2
    s_waitcnt lgkmcnt(2)
    v_smfmac_f32_16x16x64_bf16 v[16:19], v[52:55], a[56:63], v2
    v_smfmac_f32_16x16x64_bf16 v[20:23], v[52:55], a[136:143], v2
    s_waitcnt lgkmcnt(1)
    v_smfmac_f32_16x16x64_bf16 v[16:19], v[56:59], a[64:71], v2
    v_smfmac_f32_16x16x64_bf16 v[20:23], v[56:59], a[144:151], v2
    s_waitcnt lgkmcnt(0)
    v_smfmac_f32_16x16x64_bf16 v[16:19], v[60:63], a[72:79], v2
    v_smfmac_f32_16x16x64_bf16 v[20:23], v[60:63], a[152:159], v2
    s_nop 7
    v_permlane32_swap_b32 v16, v20
    v_permlane32_swap_b32 v17, v21
    v_permlane32_swap_b32 v18, v22
    v_permlane32_swap_b32 v19, v23
    v_pk_add_f32 v[16:17], v[16:17], v[20:21]
    v_pk_add_f32 v[18:19], v[18:19], v[22:23]
    v_cvt_pk_bf16_f32 v16, v16, v17
    v_cvt_pk_bf16_f32 v17, v18, v19
    ds_write_b64 v3, v[16:17]
    s_waitcnt lgkmcnt(0)
    s_barrier
    s_barrier
    s_add_u32 s60, s60, 1
    s_add_u32 s71, s71, 32768
    s_add_u32 s72, s72, 32768
    s_add_u32 s73, s73, 32768
    s_cmp_lt_u32 s60, 64
    s_cbranch_scc1 L_VO_lo
    s_branch L_end
L_VO_hi:
    v_and_b32 v10, 1, v0
    v_lshlrev_b32 v10, 3, v10
    v_bfe_u32 v8, v0, 2, 2
    v_lshl_add_u32 v10, v8, 4, v10
    v_lshrrev_b32 v8, 4, v0
    v_lshl_add_u32 v10, v8, 7, v10
    v_and_b32 v11, 15, v0
    v_lshlrev_b32 v11, 4, v11
    v_bfe_u32 v8, v0, 4, 1
    v_lshl_add_u32 v11, v8, 17, v11
    v_lshrrev_b32 v8, 5, v0
    v_lshl_add_u32 v11, v8, 14, v11
    s_and_b32 s62, s52, 3
    s_lshl_b32 s62, s62, 15
    s_lshl_b32 s63, s55, 8
    s_add_u32 s62, s62, s63
    v_add_u32 v11, s62, v11
    s_mov_b32 s80, 0xffff
    s_mov_b32 s81, 0xffff
    s_lshr_b32 s62, s55, 4
    s_lshl_b32 s62, s62, 14
    s_and_b32 s63, s55, 15
    s_lshl_b32 s63, s63, 7
    s_add_u32 s62, s62, s63
    s_add_u32 s62, s62, s46
    s_add_u32 s62, s62, 8421376
    v_mov_b32 v12, s62
L_VO_hi_loop:
Lvp_98:
    buffer_load_dwordx4 v[64:67], v13, s[4:7], s72 offen sc1
    buffer_load_dword v68, v14, s[4:7], s72 offen sc1
    s_waitcnt vmcnt(0)
    v_max3_u32 v8, v64, v65, v66
    v_max3_u32 v8, v8, v67, v68
    v_cmp_eq_u32 vcc, -1, v8
    s_cbranch_vccz Lvk_100
    s_sub_u32 s59, s59, 1
    s_cbranch_scc0 Lvp_98
    s_mov_b32 s59, 0
Lvk_100:
    ds_write_b128 v15, v[64:67] offset:0
    ds_write_b32 v4, v68 offset:0
Lvd_99:
    s_waitcnt lgkmcnt(0)
    s_barrier
    v_mov_b32 v24, 0
    v_mov_b32 v25, 0
    v_mov_b32 v26, 0
    v_mov_b32 v27, 0
    v_mov_b32 v28, 0
    v_mov_b32 v29, 0
    v_mov_b32 v30, 0
    v_mov_b32 v31, 0
    v_mov_b32 v32, 0
    v_mov_b32 v33, 0
    v_mov_b32 v34, 0
    v_mov_b32 v35, 0
    v_mov_b32 v36, 0
    v_mov_b32 v37, 0
    v_mov_b32 v38, 0
    v_mov_b32 v39, 0
    v_mov_b32 v40, 0
    v_mov_b32 v41, 0
    v_mov_b32 v42, 0
    v_mov_b32 v43, 0
    s_mul_i32 s62, s60, 43
    s_lshr_b32 s62, s62, 7
    s_and_b32 s79, s62, 1
    s_lshl_b32 s79, s79, 13
    s_xor_b32 s79, s79, s46
    s_lshl_b32 s62, s62, 17
    s_add_u32 s79, s79, s62
    s_mul_i32 s62, s60, 655360
    s_add_u32 s79, s79, s62
    s_add_u32 s79, s79, 37748736
    s_add_u32 s64, s79, 262144
    s_add_u32 s65, s79, 524288
    s_barrier
    ds_read_b64_tr_b16 v[72:73], v10 offset:10240
    ds_read_b64_tr_b16 v[74:75], v10 offset:10304
    ds_read_b64_tr_b16 v[76:77], v10 offset:10752
    ds_read_b64_tr_b16 v[78:79], v10 offset:10816
    ds_read_b64_tr_b16 v[80:81], v10 offset:11264
    ds_read_b64_tr_b16 v[82:83], v10 offset:11328
    ds_read_b64_tr_b16 v[84:85], v10 offset:11776
    ds_read_b64_tr_b16 v[86:87], v10 offset:11840
    s_waitcnt lgkmcnt(6)
    v_smfmac_f32_16x16x64_bf16 v[40:43], v[72:75], a[128:135], v2
    s_waitcnt lgkmcnt(4)
    v_smfmac_f32_16x16x64_bf16 v[40:43], v[76:79], a[136:143], v2
    s_waitcnt lgkmcnt(2)
    v_smfmac_f32_16x16x64_bf16 v[40:43], v[80:83], a[144:151], v2
    s_waitcnt lgkmcnt(0)
    v_smfmac_f32_16x16x64_bf16 v[40:43], v[84:87], a[152:159], v2
    v_smfmac_f32_16x16x64_bf16 v[24:27], v[72:75], a[0:7], v2
    v_smfmac_f32_16x16x64_bf16 v[28:31], v[72:75], a[32:39], v2
    v_smfmac_f32_16x16x64_bf16 v[24:27], v[76:79], a[8:15], v2
    v_smfmac_f32_16x16x64_bf16 v[28:31], v[76:79], a[40:47], v2
    s_nop 3
    v_cvt_pk_bf16_f32 v56, v40, v41
    v_smfmac_f32_16x16x64_bf16 v[24:27], v[80:83], a[16:23], v2
    v_cvt_pk_bf16_f32 v57, v42, v43
    v_smfmac_f32_16x16x64_bf16 v[28:31], v[80:83], a[48:55], v2
    v_permlane16_swap_b32 v56, v58
    v_smfmac_f32_16x16x64_bf16 v[24:27], v[84:87], a[24:31], v2
    v_permlane16_swap_b32 v57, v59
    v_smfmac_f32_16x16x64_bf16 v[28:31], v[84:87], a[56:63], v2
    s_mov_b64 exec, s[80:81]
    buffer_store_dwordx4 v[56:59], v11, s[4:7], s65 offen sc1
    s_mov_b64 exec, -1
    v_smfmac_f32_16x16x64_bf16 v[32:35], v[72:75], a[64:71], v2
    v_smfmac_f32_16x16x64_bf16 v[36:39], v[72:75], a[96:103], v2
    v_smfmac_f32_16x16x64_bf16 v[32:35], v[76:79], a[72:79], v2
    v_smfmac_f32_16x16x64_bf16 v[36:39], v[76:79], a[104:111], v2
    v_cvt_pk_bf16_f32 v48, v24, v25
    v_smfmac_f32_16x16x64_bf16 v[32:35], v[80:83], a[80:87], v2
    v_cvt_pk_bf16_f32 v49, v26, v27
    v_smfmac_f32_16x16x64_bf16 v[36:39], v[80:83], a[112:119], v2
    v_cvt_pk_bf16_f32 v50, v28, v29
    v_smfmac_f32_16x16x64_bf16 v[32:35], v[84:87], a[88:95], v2
    v_cvt_pk_bf16_f32 v51, v30, v31
    v_smfmac_f32_16x16x64_bf16 v[36:39], v[84:87], a[120:127], v2
    v_permlane16_swap_b32 v48, v50
    v_permlane16_swap_b32 v49, v51
    buffer_store_dwordx4 v[48:51], v11, s[4:7], s79 offen sc1
    s_nop 2
    v_cvt_pk_bf16_f32 v52, v32, v33
    v_cvt_pk_bf16_f32 v53, v34, v35
    v_cvt_pk_bf16_f32 v54, v36, v37
    v_cvt_pk_bf16_f32 v55, v38, v39
    s_nop 0
    v_permlane16_swap_b32 v52, v54
    v_permlane16_swap_b32 v53, v55
    buffer_store_dwordx4 v[52:55], v11, s[4:7], s64 offen sc1
    s_barrier
    s_add_u32 s60, s60, 1
    s_add_u32 s71, s71, 32768
    s_add_u32 s72, s72, 32768
    s_add_u32 s73, s73, 32768
    s_cmp_lt_u32 s60, 64
    s_cbranch_scc1 L_VO_hi_loop
    s_branch L_end
L_QKX:
    s_lshl_b32 s62, s55, 1
    s_add_u32 s62, s62, s56
    s_lshl_b32 s62, s62, 7
    s_add_u32 s91, s62, 2367488
    s_add_u32 s90, s62, 2359296
    s_mov_b32 s48, s16
    s_and_b32 s49, s17, 0xffff
    s_mov_b32 s50, 2621440
    s_mov_b32 s51, 0x00020000
    v_lshrrev_b32 v19, 3, v0
    v_and_b32 v64, 7, v0
    v_xor_b32 v64, v64, v19
    v_lshlrev_b32 v64, 4, v64
    v_mul_u32_u24 v19, 1280, v19
    v_add_u32 v64, v64, v19
    s_lshr_b32 s62, s52, 1
    s_mul_i32 s62, s62, 10240
    s_and_b32 s63, s52, 1
    s_mul_i32 s63, s63, 640
    s_add_u32 s71, s62, s63
    s_mul_i32 s62, s56, 40960
    s_add_u32 s71, s71, s62
    s_mul_i32 s72, s52, 5120
    s_add_u32 s72, s72, 0
    v_lshrrev_b32 v2, 4, v0
    v_and_b32 v19, 7, v0
    v_xor_b32 v2, v2, v19
    v_lshlrev_b32 v2, 4, v2
    v_lshl_add_u32 v2, v19, 7, v2
    v_bfe_u32 v19, v0, 3, 1
    v_mul_u32_u24 v19, 10240, v19
    v_add_u32 v2, v2, v19
    v_add_u32 v2, 0, v2
    v_xor_b32 v3, 64, v2
    v_lshrrev_b32 v14, 4, v0
    v_bfe_u32 v10, v0, 1, 3
    v_xor_b32 v10, v10, v14
    v_lshlrev_b32 v10, 5, v10
    v_and_b32 v14, 1, v0
    v_lshl_add_u32 v10, v14, 4, v10
    v_lshrrev_b32 v14, 4, v0
    v_mul_u32_u24 v14, 8192, v14
    v_add_u32 v10, v10, v14
    v_lshrrev_b32 v14, 4, v0
    v_or_b32 v14, 4, v14
    v_bfe_u32 v11, v0, 1, 3
    v_xor_b32 v11, v11, v14
    v_lshlrev_b32 v11, 5, v11
    v_and_b32 v14, 1, v0
    v_lshl_add_u32 v11, v14, 4, v11
    v_lshrrev_b32 v14, 4, v0
    v_mul_u32_u24 v14, 8192, v14
    v_add_u32 v11, v11, v14
    s_and_b32 s64, s52, 3
    s_lshl_b32 s64, s64, 1
    v_bfe_u32 v12, v0, 2, 3
    v_xor_b32 v12, s64, v12
    v_lshlrev_b32 v12, 5, v12
    v_and_b32 v14, 3, v0
    v_lshl_add_u32 v12, v14, 3, v12
    v_bfe_u32 v14, v0, 2, 2
    v_lshl_add_u32 v12, v14, 8, v12
    v_lshrrev_b32 v14, 4, v0
    v_lshl_add_u32 v12, v14, 11, v12
    s_mov_b32 s12, s22
    s_and_b32 s13, s23, 0xffff
    s_mov_b32 s14, 5242880
    s_mov_b32 s15, 0x00020000
    s_lshl_b32 s62, s52, 4
    s_add_u32 s62, s62, 0
    s_mul_i32 s62, s62, 8192
    s_mul_i32 s63, s55, 256
    s_add_u32 s62, s62, s63
    s_lshl_b32 s63, s52, 12
    s_add_u32 s63, s63, 98304
    s_mov_b32 m0, s63
    s_nop 0
    buffer_load_dwordx4 v10, s[12:15], s62 offen lds
    s_add_u32 s62, s62, 32768
    s_add_u32 s63, s63, 1024
    s_mov_b32 m0, s63
    s_nop 0
    buffer_load_dwordx4 v10, s[12:15], s62 offen lds
    s_add_u32 s62, s62, 32768
    s_add_u32 s63, s63, 1024
    s_mov_b32 m0, s63
    s_nop 0
    buffer_load_dwordx4 v11, s[12:15], s62 offen lds
    s_add_u32 s62, s62, 32768
    s_add_u32 s63, s63, 1024
    s_mov_b32 m0, s63
    s_nop 0
    buffer_load_dwordx4 v11, s[12:15], s62 offen lds
    s_waitcnt vmcnt(4)
    s_barrier
    s_or_b32 s62, s52, s30
    s_cbranch_scc1 Lci_101
    s_lshl_b32 s62, 1, s54
    s_lshl_b32 s63, s53, 5
    v_mov_b32 v20, s62
    v_mov_b32 v14, s63
    s_mov_b64 exec, 1
    buffer_atomic_or v20, v14, s[8:11], 0 offen sc0
    s_mov_b64 exec, -1
Lci_101:
    v_min_u32 v23, 7, v0
    v_lshlrev_b32 v23, 5, v23
    s_add_u32 m0, s72, 0
    s_nop 0
    buffer_load_dwordx4 v64, s[48:51], s71 offen offset:0 lds
    s_add_u32 m0, s72, 896
    s_nop 0
    buffer_load_dwordx4 v64, s[48:51], s71 offen offset:128 lds
    s_add_u32 m0, s72, 1792
    s_nop 0
    buffer_load_dwordx4 v64, s[48:51], s71 offen offset:256 lds
    s_add_u32 m0, s72, 2688
    s_nop 0
    buffer_load_dwordx4 v64, s[48:51], s71 offen offset:384 lds
    s_add_u32 m0, s72, 3584
    s_nop 0
    buffer_load_dwordx4 v64, s[48:51], s71 offen offset:512 lds
    s_add_u32 s71, s71, 81920
    s_add_u32 s62, s72, 40960
    s_sub_u32 s63, s72, 40960
    s_cmp_lt_u32 s72, 40960
    s_cselect_b32 s72, s62, s63
    s_lshl_b32 s62, s52, 4
    s_add_u32 s62, s62, 128
    s_mul_i32 s62, s62, 8192
    s_mul_i32 s63, s55, 256
    s_add_u32 s62, s62, s63
    s_lshl_b32 s63, s52, 12
    s_add_u32 s63, s63, 131072
    s_mov_b32 m0, s63
    s_nop 0
    buffer_load_dwordx4 v10, s[12:15], s62 offen lds
    s_add_u32 s62, s62, 32768
    s_add_u32 s63, s63, 1024
    s_mov_b32 m0, s63
    s_nop 0
    buffer_load_dwordx4 v10, s[12:15], s62 offen lds
    s_add_u32 s62, s62, 32768
    s_add_u32 s63, s63, 1024
    s_mov_b32 m0, s63
    s_nop 0
    buffer_load_dwordx4 v11, s[12:15], s62 offen lds
    s_add_u32 s62, s62, 32768
    s_add_u32 s63, s63, 1024
    s_mov_b32 m0, s63
    s_nop 0
    buffer_load_dwordx4 v11, s[12:15], s62 offen lds
    s_waitcnt vmcnt(4)
    s_barrier
    v_add_u32 v13, 98304, v12
    s_cmp_ge_u32 s52, 4
    s_cbranch_scc1 Lqk_102
    ds_read_b64_tr_b16 a[0:1], v13 offset:0
    ds_read_b64_tr_b16 a[2:3], v13 offset:1024
    ds_read_b64_tr_b16 a[4:5], v13 offset:8192
    ds_read_b64_tr_b16 a[6:7], v13 offset:9216
    ds_read_b64_tr_b16 a[8:9], v13 offset:16384
    ds_read_b64_tr_b16 a[10:11], v13 offset:17408
    ds_read_b64_tr_b16 a[12:13], v13 offset:24576
    ds_read_b64_tr_b16 a[14:15], v13 offset:25600
    v_xor_b32 v13, 32, v13
    ds_read_b64_tr_b16 a[80:81], v13 offset:0
    ds_read_b64_tr_b16 a[82:83], v13 offset:1024
    ds_read_b64_tr_b16 a[84:85], v13 offset:8192
    ds_read_b64_tr_b16 a[86:87], v13 offset:9216
    ds_read_b64_tr_b16 a[88:89], v13 offset:16384
    ds_read_b64_tr_b16 a[90:91], v13 offset:17408
    ds_read_b64_tr_b16 a[92:93], v13 offset:24576
    ds_read_b64_tr_b16 a[94:95], v13 offset:25600
Lqk_102:
    s_waitcnt lgkmcnt(0)
    s_barrier
    s_lshl_b32 s62, s52, 4
    s_add_u32 s62, s62, 256
    s_mul_i32 s62, s62, 8192
    s_mul_i32 s63, s55, 256
    s_add_u32 s62, s62, s63
    s_lshl_b32 s63, s52, 12
    s_add_u32 s63, s63, 98304
    s_mov_b32 m0, s63
    s_nop 0
    buffer_load_dwordx4 v10, s[12:15], s62 offen lds
    s_add_u32 s62, s62, 32768
    s_add_u32 s63, s63, 1024
    s_mov_b32 m0, s63
    s_nop 0
    buffer_load_dwordx4 v10, s[12:15], s62 offen lds
    s_add_u32 s62, s62, 32768
    s_add_u32 s63, s63, 1024
    s_mov_b32 m0, s63
    s_nop 0
    buffer_load_dwordx4 v11, s[12:15], s62 offen lds
    s_add_u32 s62, s62, 32768
    s_add_u32 s63, s63, 1024
    s_mov_b32 m0, s63
    s_nop 0
    buffer_load_dwordx4 v11, s[12:15], s62 offen lds
    s_cmp_ge_u32 s52, 4
    s_cbranch_scc1 Lqk_103
    ds_read_b128 v[24:27], v2 offset:0
    ds_read_b128 v[28:31], v2 offset:20480
    ds_read_b128 v[32:35], v3 offset:0
    ds_read_b128 v[36:39], v3 offset:20480
    s_waitcnt lgkmcnt(0)
    v_mfma_f32_16x16x32_bf16 v[48:51], a[0:3], v[24:27], 0
    v_mfma_f32_16x16x32_bf16 v[52:55], a[80:83], v[24:27], 0
    v_mfma_f32_16x16x32_bf16 v[56:59], a[0:3], v[28:31], 0
    v_mfma_f32_16x16x32_bf16 v[60:63], a[80:83], v[28:31], 0
    v_mfma_f32_16x16x32_bf16 v[48:51], a[4:7], v[32:35], v[48:51]
    v_mfma_f32_16x16x32_bf16 v[52:55], a[84:87], v[32:35], v[52:55]
    v_mfma_f32_16x16x32_bf16 v[56:59], a[4:7], v[36:39], v[56:59]
    v_mfma_f32_16x16x32_bf16 v[60:63], a[84:87], v[36:39], v[60:63]
    ds_read_b128 v[24:27], v2 offset:1024
    ds_read_b128 v[28:31], v2 offset:21504
    ds_read_b128 v[32:35], v3 offset:1024
    ds_read_b128 v[36:39], v3 offset:21504
    s_waitcnt lgkmcnt(0)
    v_mfma_f32_16x16x32_bf16 v[48:51], a[8:11], v[24:27], v[48:51]
    v_mfma_f32_16x16x32_bf16 v[52:55], a[88:91], v[24:27], v[52:55]
    v_mfma_f32_16x16x32_bf16 v[56:59], a[8:11], v[28:31], v[56:59]
    v_mfma_f32_16x16x32_bf16 v[60:63], a[88:91], v[28:31], v[60:63]
    v_mfma_f32_16x16x32_bf16 v[48:51], a[12:15], v[32:35], v[48:51]
    v_mfma_f32_16x16x32_bf16 v[52:55], a[92:95], v[32:35], v[52:55]
    v_mfma_f32_16x16x32_bf16 v[56:59], a[12:15], v[36:39], v[56:59]
    v_mfma_f32_16x16x32_bf16 v[60:63], a[92:95], v[36:39], v[60:63]
Lqk_103:
    s_waitcnt lgkmcnt(0)
    s_waitcnt vmcnt(4)
    s_barrier
    v_add_u32 v13, 131072, v12
    s_cmp_ge_u32 s52, 4
    s_cbranch_scc1 Lqk_104
    ds_read_b64_tr_b16 a[16:17], v13 offset:0
    ds_read_b64_tr_b16 a[18:19], v13 offset:1024
    ds_read_b64_tr_b16 a[20:21], v13 offset:8192
    ds_read_b64_tr_b16 a[22:23], v13 offset:9216
    ds_read_b64_tr_b16 a[24:25], v13 offset:16384
    ds_read_b64_tr_b16 a[26:27], v13 offset:17408
    ds_read_b64_tr_b16 a[28:29], v13 offset:24576
    ds_read_b64_tr_b16 a[30:31], v13 offset:25600
    v_xor_b32 v13, 32, v13
    ds_read_b64_tr_b16 a[96:97], v13 offset:0
    ds_read_b64_tr_b16 a[98:99], v13 offset:1024
    ds_read_b64_tr_b16 a[100:101], v13 offset:8192
    ds_read_b64_tr_b16 a[102:103], v13 offset:9216
    ds_read_b64_tr_b16 a[104:105], v13 offset:16384
    ds_read_b64_tr_b16 a[106:107], v13 offset:17408
    ds_read_b64_tr_b16 a[108:109], v13 offset:24576
    ds_read_b64_tr_b16 a[110:111], v13 offset:25600
Lqk_104:
    s_waitcnt lgkmcnt(0)
    s_barrier
    s_lshl_b32 s62, s52, 4
    s_add_u32 s62, s62, 384
    s_mul_i32 s62, s62, 8192
    s_mul_i32 s63, s55, 256
    s_add_u32 s62, s62, s63
    s_lshl_b32 s63, s52, 12
    s_add_u32 s63, s63, 131072
    s_mov_b32 m0, s63
    s_nop 0
    buffer_load_dwordx4 v10, s[12:15], s62 offen lds
    s_add_u32 s62, s62, 32768
    s_add_u32 s63, s63, 1024
    s_mov_b32 m0, s63
    s_nop 0
    buffer_load_dwordx4 v10, s[12:15], s62 offen lds
    s_add_u32 s62, s62, 32768
    s_add_u32 s63, s63, 1024
    s_mov_b32 m0, s63
    s_nop 0
    buffer_load_dwordx4 v11, s[12:15], s62 offen lds
    s_add_u32 s62, s62, 32768
    s_add_u32 s63, s63, 1024
    s_mov_b32 m0, s63
    s_nop 0
    buffer_load_dwordx4 v11, s[12:15], s62 offen lds
    s_cmp_ge_u32 s52, 4
    s_cbranch_scc1 Lqk_105
    ds_read_b128 v[24:27], v2 offset:2048
    ds_read_b128 v[28:31], v2 offset:22528
    ds_read_b128 v[32:35], v3 offset:2048
    ds_read_b128 v[36:39], v3 offset:22528
    s_waitcnt lgkmcnt(0)
    v_mfma_f32_16x16x32_bf16 v[48:51], a[16:19], v[24:27], v[48:51]
    v_mfma_f32_16x16x32_bf16 v[52:55], a[96:99], v[24:27], v[52:55]
    v_mfma_f32_16x16x32_bf16 v[56:59], a[16:19], v[28:31], v[56:59]
    v_mfma_f32_16x16x32_bf16 v[60:63], a[96:99], v[28:31], v[60:63]
    v_mfma_f32_16x16x32_bf16 v[48:51], a[20:23], v[32:35], v[48:51]
    v_mfma_f32_16x16x32_bf16 v[52:55], a[100:103], v[32:35], v[52:55]
    v_mfma_f32_16x16x32_bf16 v[56:59], a[20:23], v[36:39], v[56:59]
    v_mfma_f32_16x16x32_bf16 v[60:63], a[100:103], v[36:39], v[60:63]
    ds_read_b128 v[24:27], v2 offset:3072
    ds_read_b128 v[28:31], v2 offset:23552
    ds_read_b128 v[32:35], v3 offset:3072
    ds_read_b128 v[36:39], v3 offset:23552
    s_waitcnt lgkmcnt(0)
    v_mfma_f32_16x16x32_bf16 v[48:51], a[24:27], v[24:27], v[48:51]
    v_mfma_f32_16x16x32_bf16 v[52:55], a[104:107], v[24:27], v[52:55]
    v_mfma_f32_16x16x32_bf16 v[56:59], a[24:27], v[28:31], v[56:59]
    v_mfma_f32_16x16x32_bf16 v[60:63], a[104:107], v[28:31], v[60:63]
    v_mfma_f32_16x16x32_bf16 v[48:51], a[28:31], v[32:35], v[48:51]
    v_mfma_f32_16x16x32_bf16 v[52:55], a[108:111], v[32:35], v[52:55]
    v_mfma_f32_16x16x32_bf16 v[56:59], a[28:31], v[36:39], v[56:59]
    v_mfma_f32_16x16x32_bf16 v[60:63], a[108:111], v[36:39], v[60:63]
Lqk_105:
    s_waitcnt lgkmcnt(0)
    s_waitcnt vmcnt(4)
    s_barrier
    v_add_u32 v13, 98304, v12
    s_cmp_ge_u32 s52, 4
    s_cbranch_scc1 Lqk_106
    ds_read_b64_tr_b16 a[32:33], v13 offset:0
    ds_read_b64_tr_b16 a[34:35], v13 offset:1024
    ds_read_b64_tr_b16 a[36:37], v13 offset:8192
    ds_read_b64_tr_b16 a[38:39], v13 offset:9216
    ds_read_b64_tr_b16 a[40:41], v13 offset:16384
    ds_read_b64_tr_b16 a[42:43], v13 offset:17408
    ds_read_b64_tr_b16 a[44:45], v13 offset:24576
    ds_read_b64_tr_b16 a[46:47], v13 offset:25600
    v_xor_b32 v13, 32, v13
    ds_read_b64_tr_b16 a[112:113], v13 offset:0
    ds_read_b64_tr_b16 a[114:115], v13 offset:1024
    ds_read_b64_tr_b16 a[116:117], v13 offset:8192
    ds_read_b64_tr_b16 a[118:119], v13 offset:9216
    ds_read_b64_tr_b16 a[120:121], v13 offset:16384
    ds_read_b64_tr_b16 a[122:123], v13 offset:17408
    ds_read_b64_tr_b16 a[124:125], v13 offset:24576
    ds_read_b64_tr_b16 a[126:127], v13 offset:25600
Lqk_106:
    s_waitcnt lgkmcnt(0)
    s_barrier
    s_lshl_b32 s62, s52, 4
    s_add_u32 s62, s62, 512
    s_mul_i32 s62, s62, 8192
    s_mul_i32 s63, s55, 256
    s_add_u32 s62, s62, s63
    s_lshl_b32 s63, s52, 12
    s_add_u32 s63, s63, 98304
    s_mov_b32 m0, s63
    s_nop 0
    buffer_load_dwordx4 v10, s[12:15], s62 offen lds
    s_add_u32 s62, s62, 32768
    s_add_u32 s63, s63, 1024
    s_mov_b32 m0, s63
    s_nop 0
    buffer_load_dwordx4 v10, s[12:15], s62 offen lds
    s_add_u32 s62, s62, 32768
    s_add_u32 s63, s63, 1024
    s_mov_b32 m0, s63
    s_nop 0
    buffer_load_dwordx4 v11, s[12:15], s62 offen lds
    s_add_u32 s62, s62, 32768
    s_add_u32 s63, s63, 1024
    s_mov_b32 m0, s63
    s_nop 0
    buffer_load_dwordx4 v11, s[12:15], s62 offen lds
    s_cmp_ge_u32 s52, 4
    s_cbranch_scc1 Lqk_107
    ds_read_b128 v[24:27], v2 offset:4096
    ds_read_b128 v[28:31], v2 offset:24576
    ds_read_b128 v[32:35], v3 offset:4096
    ds_read_b128 v[36:39], v3 offset:24576
    s_waitcnt lgkmcnt(0)
    v_mfma_f32_16x16x32_bf16 v[48:51], a[32:35], v[24:27], v[48:51]
    v_mfma_f32_16x16x32_bf16 v[52:55], a[112:115], v[24:27], v[52:55]
    v_mfma_f32_16x16x32_bf16 v[56:59], a[32:35], v[28:31], v[56:59]
    v_mfma_f32_16x16x32_bf16 v[60:63], a[112:115], v[28:31], v[60:63]
    v_mfma_f32_16x16x32_bf16 v[48:51], a[36:39], v[32:35], v[48:51]
    v_mfma_f32_16x16x32_bf16 v[52:55], a[116:119], v[32:35], v[52:55]
    v_mfma_f32_16x16x32_bf16 v[56:59], a[36:39], v[36:39], v[56:59]
    v_mfma_f32_16x16x32_bf16 v[60:63], a[116:119], v[36:39], v[60:63]
    ds_read_b128 v[24:27], v2 offset:5120
    ds_read_b128 v[28:31], v2 offset:25600
    ds_read_b128 v[32:35], v3 offset:5120
    ds_read_b128 v[36:39], v3 offset:25600
    s_waitcnt lgkmcnt(0)
    v_mfma_f32_16x16x32_bf16 v[48:51], a[40:43], v[24:27], v[48:51]
    v_mfma_f32_16x16x32_bf16 v[52:55], a[120:123], v[24:27], v[52:55]
    v_mfma_f32_16x16x32_bf16 v[56:59], a[40:43], v[28:31], v[56:59]
    v_mfma_f32_16x16x32_bf16 v[60:63], a[120:123], v[28:31], v[60:63]
    v_mfma_f32_16x16x32_bf16 v[48:51], a[44:47], v[32:35], v[48:51]
    v_mfma_f32_16x16x32_bf16 v[52:55], a[124:127], v[32:35], v[52:55]
    v_mfma_f32_16x16x32_bf16 v[56:59], a[44:47], v[36:39], v[56:59]
    v_mfma_f32_16x16x32_bf16 v[60:63], a[124:127], v[36:39], v[60:63]
Lqk_107:
    s_waitcnt lgkmcnt(0)
    s_waitcnt vmcnt(4)
    s_barrier
    v_add_u32 v13, 131072, v12
    s_cmp_ge_u32 s52, 4
    s_cbranch_scc1 Lqk_108
    ds_read_b64_tr_b16 a[48:49], v13 offset:0
    ds_read_b64_tr_b16 a[50:51], v13 offset:1024
    ds_read_b64_tr_b16 a[52:53], v13 offset:8192
    ds_read_b64_tr_b16 a[54:55], v13 offset:9216
    ds_read_b64_tr_b16 a[56:57], v13 offset:16384
    ds_read_b64_tr_b16 a[58:59], v13 offset:17408
    ds_read_b64_tr_b16 a[60:61], v13 offset:24576
    ds_read_b64_tr_b16 a[62:63], v13 offset:25600
    v_xor_b32 v13, 32, v13
    ds_read_b64_tr_b16 a[128:129], v13 offset:0
    ds_read_b64_tr_b16 a[130:131], v13 offset:1024
    ds_read_b64_tr_b16 a[132:133], v13 offset:8192
    ds_read_b64_tr_b16 a[134:135], v13 offset:9216
    ds_read_b64_tr_b16 a[136:137], v13 offset:16384
    ds_read_b64_tr_b16 a[138:139], v13 offset:17408
    ds_read_b64_tr_b16 a[140:141], v13 offset:24576
    ds_read_b64_tr_b16 a[142:143], v13 offset:25600
Lqk_108:
    s_waitcnt lgkmcnt(0)
    s_barrier
    s_mov_b32 s12, s20
    s_and_b32 s13, s21, 0xffff
    s_mov_b32 s14, 5242880
    s_mov_b32 s15, 0x00020000
    s_lshl_b32 s62, s52, 4
    s_add_u32 s62, s62, 0
    s_mul_i32 s62, s62, 8192
    s_mul_i32 s63, s55, 256
    s_add_u32 s62, s62, s63
    s_lshl_b32 s63, s52, 12
    s_add_u32 s63, s63, 131072
    s_mov_b32 m0, s63
    s_nop 0
    buffer_load_dwordx4 v10, s[12:15], s62 offen lds
    s_add_u32 s62, s62, 32768
    s_add_u32 s63, s63, 1024
    s_mov_b32 m0, s63
    s_nop 0
    buffer_load_dwordx4 v10, s[12:15], s62 offen lds
    s_add_u32 s62, s62, 32768
    s_add_u32 s63, s63, 1024
    s_mov_b32 m0, s63
    s_nop 0
    buffer_load_dwordx4 v11, s[12:15], s62 offen lds
    s_add_u32 s62, s62, 32768
    s_add_u32 s63, s63, 1024
    s_mov_b32 m0, s63
    s_nop 0
    buffer_load_dwordx4 v11, s[12:15], s62 offen lds
    s_cmp_ge_u32 s52, 4
    s_cbranch_scc1 Lqk_109
    ds_read_b128 v[24:27], v2 offset:6144
    ds_read_b128 v[28:31], v2 offset:26624
    ds_read_b128 v[32:35], v3 offset:6144
    ds_read_b128 v[36:39], v3 offset:26624
    s_waitcnt lgkmcnt(0)
    v_mfma_f32_16x16x32_bf16 v[48:51], a[48:51], v[24:27], v[48:51]
    v_mfma_f32_16x16x32_bf16 v[52:55], a[128:131], v[24:27], v[52:55]
    v_mfma_f32_16x16x32_bf16 v[56:59], a[48:51], v[28:31], v[56:59]
    v_mfma_f32_16x16x32_bf16 v[60:63], a[128:131], v[28:31], v[60:63]
    v_mfma_f32_16x16x32_bf16 v[48:51], a[52:55], v[32:35], v[48:51]
    v_mfma_f32_16x16x32_bf16 v[52:55], a[132:135], v[32:35], v[52:55]
    v_mfma_f32_16x16x32_bf16 v[56:59], a[52:55], v[36:39], v[56:59]
    v_mfma_f32_16x16x32_bf16 v[60:63], a[132:135], v[36:39], v[60:63]
    ds_read_b128 v[24:27], v2 offset:7168
    ds_read_b128 v[28:31], v2 offset:27648
    ds_read_b128 v[32:35], v3 offset:7168
    ds_read_b128 v[36:39], v3 offset:27648
    s_waitcnt lgkmcnt(0)
    v_mfma_f32_16x16x32_bf16 v[48:51], a[56:59], v[24:27], v[48:51]
    v_mfma_f32_16x16x32_bf16 v[52:55], a[136:139], v[24:27], v[52:55]
    v_mfma_f32_16x16x32_bf16 v[56:59], a[56:59], v[28:31], v[56:59]
    v_mfma_f32_16x16x32_bf16 v[60:63], a[136:139], v[28:31], v[60:63]
    v_mfma_f32_16x16x32_bf16 v[48:51], a[60:63], v[32:35], v[48:51]
    v_mfma_f32_16x16x32_bf16 v[52:55], a[140:143], v[32:35], v[52:55]
    v_mfma_f32_16x16x32_bf16 v[56:59], a[60:63], v[36:39], v[56:59]
    v_mfma_f32_16x16x32_bf16 v[60:63], a[140:143], v[36:39], v[60:63]
Lqk_109:
    s_waitcnt lgkmcnt(0)
    s_waitcnt vmcnt(4)
    s_barrier
    v_add_u32 v13, 98304, v12
    s_cmp_ge_u32 s52, 4
    s_cbranch_scc1 Lqk_110
    ds_read_b64_tr_b16 a[64:65], v13 offset:0
    ds_read_b64_tr_b16 a[66:67], v13 offset:1024
    ds_read_b64_tr_b16 a[68:69], v13 offset:8192
    ds_read_b64_tr_b16 a[70:71], v13 offset:9216
    ds_read_b64_tr_b16 a[72:73], v13 offset:16384
    ds_read_b64_tr_b16 a[74:75], v13 offset:17408
    ds_read_b64_tr_b16 a[76:77], v13 offset:24576
    ds_read_b64_tr_b16 a[78:79], v13 offset:25600
    v_xor_b32 v13, 32, v13
    ds_read_b64_tr_b16 a[144:145], v13 offset:0
    ds_read_b64_tr_b16 a[146:147], v13 offset:1024
    ds_read_b64_tr_b16 a[148:149], v13 offset:8192
    ds_read_b64_tr_b16 a[150:151], v13 offset:9216
    ds_read_b64_tr_b16 a[152:153], v13 offset:16384
    ds_read_b64_tr_b16 a[154:155], v13 offset:17408
    ds_read_b64_tr_b16 a[156:157], v13 offset:24576
    ds_read_b64_tr_b16 a[158:159], v13 offset:25600
Lqk_110:
    s_waitcnt lgkmcnt(0)
    s_barrier
    s_lshl_b32 s62, s52, 4
    s_add_u32 s62, s62, 128
    s_mul_i32 s62, s62, 8192
    s_mul_i32 s63, s55, 256
    s_add_u32 s62, s62, s63
    s_lshl_b32 s63, s52, 12
    s_add_u32 s63, s63, 98304
    s_mov_b32 m0, s63
    s_nop 0
    buffer_load_dwordx4 v10, s[12:15], s62 offen lds
    s_add_u32 s62, s62, 32768
    s_add_u32 s63, s63, 1024
    s_mov_b32 m0, s63
    s_nop 0
    buffer_load_dwordx4 v10, s[12:15], s62 offen lds
    s_add_u32 s62, s62, 32768
    s_add_u32 s63, s63, 1024
    s_mov_b32 m0, s63
    s_nop 0
    buffer_load_dwordx4 v11, s[12:15], s62 offen lds
    s_add_u32 s62, s62, 32768
    s_add_u32 s63, s63, 1024
    s_mov_b32 m0, s63
    s_nop 0
    buffer_load_dwordx4 v11, s[12:15], s62 offen lds
    s_cmp_ge_u32 s52, 4
    s_cbranch_scc1 Lqk_111
    ds_read_b128 v[24:27], v2 offset:8192
    ds_read_b128 v[28:31], v2 offset:28672
    ds_read_b128 v[32:35], v3 offset:8192
    ds_read_b128 v[36:39], v3 offset:28672
    s_waitcnt lgkmcnt(0)
    v_mfma_f32_16x16x32_bf16 v[48:51], a[64:67], v[24:27], v[48:51]
    v_mfma_f32_16x16x32_bf16 v[52:55], a[144:147], v[24:27], v[52:55]
    v_mfma_f32_16x16x32_bf16 v[56:59], a[64:67], v[28:31], v[56:59]
    v_mfma_f32_16x16x32_bf16 v[60:63], a[144:147], v[28:31], v[60:63]
    v_mfma_f32_16x16x32_bf16 v[48:51], a[68:71], v[32:35], v[48:51]
    v_mfma_f32_16x16x32_bf16 v[52:55], a[148:151], v[32:35], v[52:55]
    v_mfma_f32_16x16x32_bf16 v[56:59], a[68:71], v[36:39], v[56:59]
    v_mfma_f32_16x16x32_bf16 v[60:63], a[148:151], v[36:39], v[60:63]
    ds_read_b128 v[24:27], v2 offset:9216
    ds_read_b128 v[28:31], v2 offset:29696
    ds_read_b128 v[32:35], v3 offset:9216
    ds_read_b128 v[36:39], v3 offset:29696
    s_waitcnt lgkmcnt(0)
    v_mfma_f32_16x16x32_bf16 v[48:51], a[72:75], v[24:27], v[48:51]
    v_mfma_f32_16x16x32_bf16 v[52:55], a[152:155], v[24:27], v[52:55]
    v_mfma_f32_16x16x32_bf16 v[56:59], a[72:75], v[28:31], v[56:59]
    v_mfma_f32_16x16x32_bf16 v[60:63], a[152:155], v[28:31], v[60:63]
    v_mfma_f32_16x16x32_bf16 v[48:51], a[76:79], v[32:35], v[48:51]
    v_mfma_f32_16x16x32_bf16 v[52:55], a[156:159], v[32:35], v[52:55]
    v_mfma_f32_16x16x32_bf16 v[56:59], a[76:79], v[36:39], v[56:59]
    v_mfma_f32_16x16x32_bf16 v[60:63], a[156:159], v[36:39], v[60:63]
Lqk_111:
    s_waitcnt lgkmcnt(0)
    s_waitcnt vmcnt(4)
    s_barrier
    v_add_u32 v13, 131072, v12
    s_cmp_ge_u32 s52, 4
    s_cbranch_scc0 Lqk_112
    ds_read_b64_tr_b16 a[0:1], v13 offset:0
    ds_read_b64_tr_b16 a[2:3], v13 offset:1024
    ds_read_b64_tr_b16 a[4:5], v13 offset:8192
    ds_read_b64_tr_b16 a[6:7], v13 offset:9216
    ds_read_b64_tr_b16 a[8:9], v13 offset:16384
    ds_read_b64_tr_b16 a[10:11], v13 offset:17408
    ds_read_b64_tr_b16 a[12:13], v13 offset:24576
    ds_read_b64_tr_b16 a[14:15], v13 offset:25600
    v_xor_b32 v13, 32, v13
    ds_read_b64_tr_b16 a[80:81], v13 offset:0
    ds_read_b64_tr_b16 a[82:83], v13 offset:1024
    ds_read_b64_tr_b16 a[84:85], v13 offset:8192
    ds_read_b64_tr_b16 a[86:87], v13 offset:9216
    ds_read_b64_tr_b16 a[88:89], v13 offset:16384
    ds_read_b64_tr_b16 a[90:91], v13 offset:17408
    ds_read_b64_tr_b16 a[92:93], v13 offset:24576
    ds_read_b64_tr_b16 a[94:95], v13 offset:25600
Lqk_112:
    s_add_u32 m0, s72, 0
    s_nop 0
    buffer_load_dwordx4 v64, s[48:51], s71 offen offset:0 lds
    s_waitcnt lgkmcnt(0)
    s_barrier
    s_lshl_b32 s62, s52, 4
    s_add_u32 s62, s62, 256
    s_mul_i32 s62, s62, 8192
    s_mul_i32 s63, s55, 256
    s_add_u32 s62, s62, s63
    s_lshl_b32 s63, s52, 12
    s_add_u32 s63, s63, 131072
    s_mov_b32 m0, s63
    s_nop 0
    buffer_load_dwordx4 v10, s[12:15], s62 offen lds
    s_add_u32 s62, s62, 32768
    s_add_u32 s63, s63, 1024
    s_mov_b32 m0, s63
    s_nop 0
    buffer_load_dwordx4 v10, s[12:15], s62 offen lds
    s_add_u32 s62, s62, 32768
    s_add_u32 s63, s63, 1024
    s_mov_b32 m0, s63
    s_nop 0
    buffer_load_dwordx4 v11, s[12:15], s62 offen lds
    s_add_u32 s62, s62, 32768
    s_add_u32 s63, s63, 1024
    s_mov_b32 m0, s63
    s_nop 0
    buffer_load_dwordx4 v11, s[12:15], s62 offen lds
    s_cmp_ge_u32 s52, 4
    s_cbranch_scc0 Lqk_113
    ds_read_b128 v[24:27], v2 offset:0
    ds_read_b128 v[28:31], v2 offset:20480
    ds_read_b128 v[32:35], v3 offset:0
    ds_read_b128 v[36:39], v3 offset:20480
    s_waitcnt lgkmcnt(0)
    v_mfma_f32_16x16x32_bf16 v[48:51], a[0:3], v[24:27], 0
    v_mfma_f32_16x16x32_bf16 v[52:55], a[80:83], v[24:27], 0
    v_mfma_f32_16x16x32_bf16 v[56:59], a[0:3], v[28:31], 0
    v_mfma_f32_16x16x32_bf16 v[60:63], a[80:83], v[28:31], 0
    v_mfma_f32_16x16x32_bf16 v[48:51], a[4:7], v[32:35], v[48:51]
    v_mfma_f32_16x16x32_bf16 v[52:55], a[84:87], v[32:35], v[52:55]
    v_mfma_f32_16x16x32_bf16 v[56:59], a[4:7], v[36:39], v[56:59]
    v_mfma_f32_16x16x32_bf16 v[60:63], a[84:87], v[36:39], v[60:63]
    ds_read_b128 v[24:27], v2 offset:1024
    ds_read_b128 v[28:31], v2 offset:21504
    ds_read_b128 v[32:35], v3 offset:1024
    ds_read_b128 v[36:39], v3 offset:21504
    s_waitcnt lgkmcnt(0)
    v_mfma_f32_16x16x32_bf16 v[48:51], a[8:11], v[24:27], v[48:51]
    v_mfma_f32_16x16x32_bf16 v[52:55], a[88:91], v[24:27], v[52:55]
    v_mfma_f32_16x16x32_bf16 v[56:59], a[8:11], v[28:31], v[56:59]
    v_mfma_f32_16x16x32_bf16 v[60:63], a[88:91], v[28:31], v[60:63]
    v_mfma_f32_16x16x32_bf16 v[48:51], a[12:15], v[32:35], v[48:51]
    v_mfma_f32_16x16x32_bf16 v[52:55], a[92:95], v[32:35], v[52:55]
    v_mfma_f32_16x16x32_bf16 v[56:59], a[12:15], v[36:39], v[56:59]
    v_mfma_f32_16x16x32_bf16 v[60:63], a[92:95], v[36:39], v[60:63]
Lqk_113:
    s_waitcnt lgkmcnt(0)
    s_waitcnt vmcnt(4)
    s_barrier
    buffer_load_dword v21, v23, s[8:11], 0 offen sc1
    v_add_u32 v13, 98304, v12
    s_cmp_ge_u32 s52, 4
    s_cbranch_scc0 Lqk_114
    ds_read_b64_tr_b16 a[16:17], v13 offset:0
    ds_read_b64_tr_b16 a[18:19], v13 offset:1024
    ds_read_b64_tr_b16 a[20:21], v13 offset:8192
    ds_read_b64_tr_b16 a[22:23], v13 offset:9216
    ds_read_b64_tr_b16 a[24:25], v13 offset:16384
    ds_read_b64_tr_b16 a[26:27], v13 offset:17408
    ds_read_b64_tr_b16 a[28:29], v13 offset:24576
    ds_read_b64_tr_b16 a[30:31], v13 offset:25600
    v_xor_b32 v13, 32, v13
    ds_read_b64_tr_b16 a[96:97], v13 offset:0
    ds_read_b64_tr_b16 a[98:99], v13 offset:1024
    ds_read_b64_tr_b16 a[100:101], v13 offset:8192
    ds_read_b64_tr_b16 a[102:103], v13 offset:9216
    ds_read_b64_tr_b16 a[104:105], v13 offset:16384
    ds_read_b64_tr_b16 a[106:107], v13 offset:17408
    ds_read_b64_tr_b16 a[108:109], v13 offset:24576
    ds_read_b64_tr_b16 a[110:111], v13 offset:25600
Lqk_114:
    s_add_u32 m0, s72, 896
    s_nop 0
    buffer_load_dwordx4 v64, s[48:51], s71 offen offset:128 lds
    s_waitcnt lgkmcnt(0)
    s_barrier
    s_lshl_b32 s62, s52, 4
    s_add_u32 s62, s62, 384
    s_mul_i32 s62, s62, 8192
    s_mul_i32 s63, s55, 256
    s_add_u32 s62, s62, s63
    s_lshl_b32 s63, s52, 12
    s_add_u32 s63, s63, 98304
    s_mov_b32 m0, s63
    s_nop 0
    buffer_load_dwordx4 v10, s[12:15], s62 offen lds
    s_add_u32 s62, s62, 32768
    s_add_u32 s63, s63, 1024
    s_mov_b32 m0, s63
    s_nop 0
    buffer_load_dwordx4 v10, s[12:15], s62 offen lds
    s_add_u32 s62, s62, 32768
    s_add_u32 s63, s63, 1024
    s_mov_b32 m0, s63
    s_nop 0
    buffer_load_dwordx4 v11, s[12:15], s62 offen lds
    s_add_u32 s62, s62, 32768
    s_add_u32 s63, s63, 1024
    s_mov_b32 m0, s63
    s_nop 0
    buffer_load_dwordx4 v11, s[12:15], s62 offen lds
    s_cmp_ge_u32 s52, 4
    s_cbranch_scc0 Lqk_115
    ds_read_b128 v[24:27], v2 offset:2048
    ds_read_b128 v[28:31], v2 offset:22528
    ds_read_b128 v[32:35], v3 offset:2048
    ds_read_b128 v[36:39], v3 offset:22528
    s_waitcnt lgkmcnt(0)
    v_mfma_f32_16x16x32_bf16 v[48:51], a[16:19], v[24:27], v[48:51]
    v_mfma_f32_16x16x32_bf16 v[52:55], a[96:99], v[24:27], v[52:55]
    v_mfma_f32_16x16x32_bf16 v[56:59], a[16:19], v[28:31], v[56:59]
    v_mfma_f32_16x16x32_bf16 v[60:63], a[96:99], v[28:31], v[60:63]
    v_mfma_f32_16x16x32_bf16 v[48:51], a[20:23], v[32:35], v[48:51]
    v_mfma_f32_16x16x32_bf16 v[52:55], a[100:103], v[32:35], v[52:55]
    v_mfma_f32_16x16x32_bf16 v[56:59], a[20:23], v[36:39], v[56:59]
    v_mfma_f32_16x16x32_bf16 v[60:63], a[100:103], v[36:39], v[60:63]
    ds_read_b128 v[24:27], v2 offset:3072
    ds_read_b128 v[28:31], v2 offset:23552
    ds_read_b128 v[32:35], v3 offset:3072
    ds_read_b128 v[36:39], v3 offset:23552
    s_waitcnt lgkmcnt(0)
    v_mfma_f32_16x16x32_bf16 v[48:51], a[24:27], v[24:27], v[48:51]
    v_mfma_f32_16x16x32_bf16 v[52:55], a[104:107], v[24:27], v[52:55]
    v_mfma_f32_16x16x32_bf16 v[56:59], a[24:27], v[28:31], v[56:59]
    v_mfma_f32_16x16x32_bf16 v[60:63], a[104:107], v[28:31], v[60:63]
    v_mfma_f32_16x16x32_bf16 v[48:51], a[28:31], v[32:35], v[48:51]
    v_mfma_f32_16x16x32_bf16 v[52:55], a[108:111], v[32:35], v[52:55]
    v_mfma_f32_16x16x32_bf16 v[56:59], a[28:31], v[36:39], v[56:59]
    v_mfma_f32_16x16x32_bf16 v[60:63], a[108:111], v[36:39], v[60:63]
Lqk_115:
    s_waitcnt lgkmcnt(0)
    s_waitcnt vmcnt(4)
    s_barrier
    v_add_u32 v13, 131072, v12
    s_cmp_ge_u32 s52, 4
    s_cbranch_scc0 Lqk_116
    ds_read_b64_tr_b16 a[32:33], v13 offset:0
    ds_read_b64_tr_b16 a[34:35], v13 offset:1024
    ds_read_b64_tr_b16 a[36:37], v13 offset:8192
    ds_read_b64_tr_b16 a[38:39], v13 offset:9216
    ds_read_b64_tr_b16 a[40:41], v13 offset:16384
    ds_read_b64_tr_b16 a[42:43], v13 offset:17408
    ds_read_b64_tr_b16 a[44:45], v13 offset:24576
    ds_read_b64_tr_b16 a[46:47], v13 offset:25600
    v_xor_b32 v13, 32, v13
    ds_read_b64_tr_b16 a[112:113], v13 offset:0
    ds_read_b64_tr_b16 a[114:115], v13 offset:1024
    ds_read_b64_tr_b16 a[116:117], v13 offset:8192
    ds_read_b64_tr_b16 a[118:119], v13 offset:9216
    ds_read_b64_tr_b16 a[120:121], v13 offset:16384
    ds_read_b64_tr_b16 a[122:123], v13 offset:17408
    ds_read_b64_tr_b16 a[124:125], v13 offset:24576
    ds_read_b64_tr_b16 a[126:127], v13 offset:25600
Lqk_116:
    s_add_u32 m0, s72, 1792
    s_nop 0
    buffer_load_dwordx4 v64, s[48:51], s71 offen offset:256 lds
    s_waitcnt lgkmcnt(0)
    s_barrier
    s_lshl_b32 s62, s52, 4
    s_add_u32 s62, s62, 512
    s_mul_i32 s62, s62, 8192
    s_mul_i32 s63, s55, 256
    s_add_u32 s62, s62, s63
    s_lshl_b32 s63, s52, 12
    s_add_u32 s63, s63, 131072
    s_mov_b32 m0, s63
    s_nop 0
    buffer_load_dwordx4 v10, s[12:15], s62 offen lds
    s_add_u32 s62, s62, 32768
    s_add_u32 s63, s63, 1024
    s_mov_b32 m0, s63
    s_nop 0
    buffer_load_dwordx4 v10, s[12:15], s62 offen lds
    s_add_u32 s62, s62, 32768
    s_add_u32 s63, s63, 1024
    s_mov_b32 m0, s63
    s_nop 0
    buffer_load_dwordx4 v11, s[12:15], s62 offen lds
    s_add_u32 s62, s62, 32768
    s_add_u32 s63, s63, 1024
    s_mov_b32 m0, s63
    s_nop 0
    buffer_load_dwordx4 v11, s[12:15], s62 offen lds
    s_cmp_ge_u32 s52, 4
    s_cbranch_scc0 Lqk_117
    ds_read_b128 v[24:27], v2 offset:4096
    ds_read_b128 v[28:31], v2 offset:24576
    ds_read_b128 v[32:35], v3 offset:4096
    ds_read_b128 v[36:39], v3 offset:24576
    s_waitcnt lgkmcnt(0)
    v_mfma_f32_16x16x32_bf16 v[48:51], a[32:35], v[24:27], v[48:51]
    v_mfma_f32_16x16x32_bf16 v[52:55], a[112:115], v[24:27], v[52:55]
    v_mfma_f32_16x16x32_bf16 v[56:59], a[32:35], v[28:31], v[56:59]
    v_mfma_f32_16x16x32_bf16 v[60:63], a[112:115], v[28:31], v[60:63]
    v_mfma_f32_16x16x32_bf16 v[48:51], a[36:39], v[32:35], v[48:51]
    v_mfma_f32_16x16x32_bf16 v[52:55], a[116:119], v[32:35], v[52:55]
    v_mfma_f32_16x16x32_bf16 v[56:59], a[36:39], v[36:39], v[56:59]
    v_mfma_f32_16x16x32_bf16 v[60:63], a[116:119], v[36:39], v[60:63]
    ds_read_b128 v[24:27], v2 offset:5120
    ds_read_b128 v[28:31], v2 offset:25600
    ds_read_b128 v[32:35], v3 offset:5120
    ds_read_b128 v[36:39], v3 offset:25600
    s_waitcnt lgkmcnt(0)
    v_mfma_f32_16x16x32_bf16 v[48:51], a[40:43], v[24:27], v[48:51]
    v_mfma_f32_16x16x32_bf16 v[52:55], a[120:123], v[24:27], v[52:55]
    v_mfma_f32_16x16x32_bf16 v[56:59], a[40:43], v[28:31], v[56:59]
    v_mfma_f32_16x16x32_bf16 v[60:63], a[120:123], v[28:31], v[60:63]
    v_mfma_f32_16x16x32_bf16 v[48:51], a[44:47], v[32:35], v[48:51]
    v_mfma_f32_16x16x32_bf16 v[52:55], a[124:127], v[32:35], v[52:55]
    v_mfma_f32_16x16x32_bf16 v[56:59], a[44:47], v[36:39], v[56:59]
    v_mfma_f32_16x16x32_bf16 v[60:63], a[124:127], v[36:39], v[60:63]
Lqk_117:
    s_waitcnt lgkmcnt(0)
    s_waitcnt vmcnt(4)
    s_barrier
    buffer_load_dword v22, v23, s[8:11], 0 offen offset:4 sc1
    v_add_u32 v13, 98304, v12
    s_cmp_ge_u32 s52, 4
    s_cbranch_scc0 Lqk_118
    ds_read_b64_tr_b16 a[48:49], v13 offset:0
    ds_read_b64_tr_b16 a[50:51], v13 offset:1024
    ds_read_b64_tr_b16 a[52:53], v13 offset:8192
    ds_read_b64_tr_b16 a[54:55], v13 offset:9216
    ds_read_b64_tr_b16 a[56:57], v13 offset:16384
    ds_read_b64_tr_b16 a[58:59], v13 offset:17408
    ds_read_b64_tr_b16 a[60:61], v13 offset:24576
    ds_read_b64_tr_b16 a[62:63], v13 offset:25600
    v_xor_b32 v13, 32, v13
    ds_read_b64_tr_b16 a[128:129], v13 offset:0
    ds_read_b64_tr_b16 a[130:131], v13 offset:1024
    ds_read_b64_tr_b16 a[132:133], v13 offset:8192
    ds_read_b64_tr_b16 a[134:135], v13 offset:9216
    ds_read_b64_tr_b16 a[136:137], v13 offset:16384
    ds_read_b64_tr_b16 a[138:139], v13 offset:17408
    ds_read_b64_tr_b16 a[140:141], v13 offset:24576
    ds_read_b64_tr_b16 a[142:143], v13 offset:25600
Lqk_118:
    s_add_u32 m0, s72, 2688
    s_nop 0
    buffer_load_dwordx4 v64, s[48:51], s71 offen offset:384 lds
    s_waitcnt lgkmcnt(0)
    s_cmp_ge_u32 s52, 4
    s_cbranch_scc0 Lqk_119
    ds_read_b128 v[24:27], v2 offset:6144
    ds_read_b128 v[28:31], v2 offset:26624
    ds_read_b128 v[32:35], v3 offset:6144
    ds_read_b128 v[36:39], v3 offset:26624
    s_waitcnt lgkmcnt(0)
    v_mfma_f32_16x16x32_bf16 v[48:51], a[48:51], v[24:27], v[48:51]
    v_mfma_f32_16x16x32_bf16 v[52:55], a[128:131], v[24:27], v[52:55]
    v_mfma_f32_16x16x32_bf16 v[56:59], a[48:51], v[28:31], v[56:59]
    v_mfma_f32_16x16x32_bf16 v[60:63], a[128:131], v[28:31], v[60:63]
    v_mfma_f32_16x16x32_bf16 v[48:51], a[52:55], v[32:35], v[48:51]
    v_mfma_f32_16x16x32_bf16 v[52:55], a[132:135], v[32:35], v[52:55]
    v_mfma_f32_16x16x32_bf16 v[56:59], a[52:55], v[36:39], v[56:59]
    v_mfma_f32_16x16x32_bf16 v[60:63], a[132:135], v[36:39], v[60:63]
    ds_read_b128 v[24:27], v2 offset:7168
    ds_read_b128 v[28:31], v2 offset:27648
    ds_read_b128 v[32:35], v3 offset:7168
    ds_read_b128 v[36:39], v3 offset:27648
    s_waitcnt lgkmcnt(0)
    v_mfma_f32_16x16x32_bf16 v[48:51], a[56:59], v[24:27], v[48:51]
    v_mfma_f32_16x16x32_bf16 v[52:55], a[136:139], v[24:27], v[52:55]
    v_mfma_f32_16x16x32_bf16 v[56:59], a[56:59], v[28:31], v[56:59]
    v_mfma_f32_16x16x32_bf16 v[60:63], a[136:139], v[28:31], v[60:63]
    v_mfma_f32_16x16x32_bf16 v[48:51], a[60:63], v[32:35], v[48:51]
    v_mfma_f32_16x16x32_bf16 v[52:55], a[140:143], v[32:35], v[52:55]
    v_mfma_f32_16x16x32_bf16 v[56:59], a[60:63], v[36:39], v[56:59]
    v_mfma_f32_16x16x32_bf16 v[60:63], a[140:143], v[36:39], v[60:63]
Lqk_119:
    s_waitcnt lgkmcnt(0)
    s_waitcnt vmcnt(0)
    s_barrier
    s_cmp_lg_u32 s52, 0
    s_cbranch_scc1 Llc_120
    v_readfirstlane_b32 s62, v20
    s_nop 0
    s_lshr_b32 s62, s62, s54
    s_andn2_b32 s62, s62, s30
    s_and_b32 s62, s62, 1
    v_cmp_ne_u32 vcc, -1, v21
    s_nop 0
    s_cmp_lg_u64 vcc, 0
    s_cselect_b32 s62, 1, s62
    v_mov_b32 v21, s62
    v_mov_b32 v23, 98304
    ds_write_b32 v23, v21
Llc_120:
    v_add_u32 v13, 131072, v12
    s_cmp_ge_u32 s52, 4
    s_cbranch_scc0 Lqk_121
    ds_read_b64_tr_b16 a[64:65], v13 offset:0
    ds_read_b64_tr_b16 a[66:67], v13 offset:1024
    ds_read_b64_tr_b16 a[68:69], v13 offset:8192
    ds_read_b64_tr_b16 a[70:71], v13 offset:9216
    ds_read_b64_tr_b16 a[72:73], v13 offset:16384
    ds_read_b64_tr_b16 a[74:75], v13 offset:17408
    ds_read_b64_tr_b16 a[76:77], v13 offset:24576
    ds_read_b64_tr_b16 a[78:79], v13 offset:25600
    v_xor_b32 v13, 32, v13
    ds_read_b64_tr_b16 a[144:145], v13 offset:0
    ds_read_b64_tr_b16 a[146:147], v13 offset:1024
    ds_read_b64_tr_b16 a[148:149], v13 offset:8192
    ds_read_b64_tr_b16 a[150:151], v13 offset:9216
    ds_read_b64_tr_b16 a[152:153], v13 offset:16384
    ds_read_b64_tr_b16 a[154:155], v13 offset:17408
    ds_read_b64_tr_b16 a[156:157], v13 offset:24576
    ds_read_b64_tr_b16 a[158:159], v13 offset:25600
Lqk_121:
    s_add_u32 m0, s72, 3584
    s_nop 0
    buffer_load_dwordx4 v64, s[48:51], s71 offen offset:512 lds
    s_add_u32 s71, s71, 81920
    s_add_u32 s62, s72, 40960
    s_sub_u32 s63, s72, 40960
    s_cmp_lt_u32 s72, 40960
    s_cselect_b32 s72, s62, s63
    s_waitcnt lgkmcnt(0)
    s_cmp_ge_u32 s52, 4
    s_cbranch_scc0 Lqk_122
    ds_read_b128 v[24:27], v2 offset:8192
    ds_read_b128 v[28:31], v2 offset:28672
    ds_read_b128 v[32:35], v3 offset:8192
    ds_read_b128 v[36:39], v3 offset:28672
    s_waitcnt lgkmcnt(0)
    v_mfma_f32_16x16x32_bf16 v[48:51], a[64:67], v[24:27], v[48:51]
    v_mfma_f32_16x16x32_bf16 v[52:55], a[144:147], v[24:27], v[52:55]
    v_mfma_f32_16x16x32_bf16 v[56:59], a[64:67], v[28:31], v[56:59]
    v_mfma_f32_16x16x32_bf16 v[60:63], a[144:147], v[28:31], v[60:63]
    v_mfma_f32_16x16x32_bf16 v[48:51], a[68:71], v[32:35], v[48:51]
    v_mfma_f32_16x16x32_bf16 v[52:55], a[148:151], v[32:35], v[52:55]
    v_mfma_f32_16x16x32_bf16 v[56:59], a[68:71], v[36:39], v[56:59]
    v_mfma_f32_16x16x32_bf16 v[60:63], a[148:151], v[36:39], v[60:63]
    ds_read_b128 v[24:27], v2 offset:9216
    ds_read_b128 v[28:31], v2 offset:29696
    ds_read_b128 v[32:35], v3 offset:9216
    ds_read_b128 v[36:39], v3 offset:29696
    s_waitcnt lgkmcnt(0)
    v_mfma_f32_16x16x32_bf16 v[48:51], a[72:75], v[24:27], v[48:51]
    v_mfma_f32_16x16x32_bf16 v[52:55], a[152:155], v[24:27], v[52:55]
    v_mfma_f32_16x16x32_bf16 v[56:59], a[72:75], v[28:31], v[56:59]
    v_mfma_f32_16x16x32_bf16 v[60:63], a[152:155], v[28:31], v[60:63]
    v_mfma_f32_16x16x32_bf16 v[48:51], a[76:79], v[32:35], v[48:51]
    v_mfma_f32_16x16x32_bf16 v[52:55], a[156:159], v[32:35], v[52:55]
    v_mfma_f32_16x16x32_bf16 v[56:59], a[76:79], v[36:39], v[56:59]
    v_mfma_f32_16x16x32_bf16 v[60:63], a[156:159], v[36:39], v[60:63]
Lqk_122:
    s_waitcnt lgkmcnt(0)
    s_barrier
    v_mov_b32 v23, 98304
    ds_read_b32 v23, v23
    v_readlane_b32 s62, v22, 1
    v_readlane_b32 s63, v22, 2
    v_readlane_b32 s61, v22, 3
    s_waitcnt lgkmcnt(0)
    v_cmp_eq_u32 vcc, 0, v23
    s_cbranch_vccnz Llf_123
    v_min_u32 v15, 7, v0
    v_lshlrev_b32 v15, 5, v15
    s_cmp_lg_u32 s52, 0
    s_cbranch_scc1 Lwid_125
    s_mov_b32 s64, 0
    s_cmp_lg_u32 s30, 0
    s_cbranch_scc1 Lwok_126
    s_waitcnt vmcnt(0)
    v_readfirstlane_b32 s62, v20
    s_nop 0
    s_lshr_b32 s62, s62, s54
    s_and_b32 s64, s62, 1
Lwok_126:
    v_mov_b32 v14, 163832
    v_mov_b32 v20, s64
    ds_write_b32 v14, v20
    s_waitcnt lgkmcnt(0)
    s_cmp_lg_u32 s64, 0
    s_cbranch_scc1 Lwid_125
    s_mov_b32 s89, s59
Lwi_124:
    buffer_load_dword v14, v15, s[8:11], 0 offen sc1
    s_waitcnt vmcnt(0)
    v_cmp_ne_u32 vcc, -1, v14
    s_cbranch_vccz Lwid_125
    s_sleep 8
    s_sub_u32 s89, s89, 8
    s_cbranch_scc0 Lwi_124
    s_mov_b32 s59, 0
Lwid_125:
    s_barrier
    buffer_load_dword v14, v15, s[8:11], 0 offen offset:4 sc1
    v_mov_b32 v15, 163832
    ds_read_b32 v15, v15
    s_waitcnt vmcnt(0) lgkmcnt(0)
    v_readfirstlane_b32 s62, v15
    s_nop 0
    s_cmp_lg_u32 s62, 0
    s_cbranch_scc1 L_reclaim
    v_readlane_b32 s62, v14, 1
    v_readlane_b32 s63, v14, 2
    v_readlane_b32 s61, v14, 3
Llf_123:
    s_cmp_gt_u32 s63, s62
    s_cselect_b32 s46, 0x2000, 0
    v_lshlrev_b32 v1, 4, v0
    v_mov_b32 v8, s90
    v_mov_b32 v4, -1
    v_mov_b32 v5, -1
    v_mov_b32 v6, -1
    v_mov_b32 v7, -1
    s_lshr_b32 s62, s52, 2
    s_lshl_b32 s62, s62, 13
    s_and_b32 s63, s52, 3
    s_lshl_b32 s63, s63, 10
    s_add_u32 s62, s62, s63
    s_add_u32 s62, s62, 81920
    v_add_u32 v9, s62, v1
    s_mov_b32 s68, 0
    s_mov_b32 s69, 0
    s_lshl_b32 s78, s55, 19
    s_lshl_b32 s62, s56, 13
    s_add_u32 s78, s78, s62
    s_add_u32 s78, s78, s63
    s_add_u32 s78, s78, 10485760
    s_lshl_b32 s70, s55, 11
    s_lshl_b32 s62, s56, 16
    s_add_u32 s70, s70, s62
    s_add_u32 s70, s70, 27262976
    s_mov_b32 s73, s56
    v_and_b32 v10, 7, v0
    v_lshlrev_b32 v10, 4, v10
    v_lshrrev_b32 v12, 4, v0
    v_lshl_add_u32 v10, v12, 7, v10
    s_lshl_b32 s62, s55, 11
    s_add_u32 s62, s62, 27262976
    v_add_u32 v10, s62, v10
    s_lshl_b32 s62, s52, 2
    s_add_u32 s62, s62, s91
    v_mov_b32 v15, s62
    v_and_b32 v14, 15, v0
    v_lshlrev_b32 v14, 4, v14
    s_lshr_b32 s62, s55, 2
    s_lshl_b32 s62, s62, 11
    s_and_b32 s63, s55, 3
    s_lshl_b32 s63, s63, 8
    s_add_u32 s62, s62, s63
    s_lshl_b32 s63, s52, 10
    s_add_u32 s62, s62, s63
    s_add_u32 s62, s62, 6291456
    v_add_u32 v14, s62, v14
    s_lshl_b32 s62, s52, 4
    v_and_b32 v12, 15, v0
    v_add_u32 v12, s62, v12
    v_lshrrev_b32 v13, 4, v0
    v_lshlrev_b32 v13, 2, v13
    v_sub_u32 v12, v12, v13
    v_mov_b32 v84, 0xff7fffff
    v_mov_b32 v85, 0
    v_cmp_le_i32 vcc, 0, v12
    s_nop 1
    v_cndmask_b32 v72, v84, v85, vcc
    v_cmp_le_i32 vcc, 1, v12
    s_nop 1
    v_cndmask_b32 v73, v84, v85, vcc
    v_cmp_le_i32 vcc, 2, v12
    s_nop 1
    v_cndmask_b32 v74, v84, v85, vcc
    v_cmp_le_i32 vcc, 3, v12
    s_nop 1
    v_cndmask_b32 v75, v84, v85, vcc
    v_cmp_le_i32 vcc, 16, v12
    s_nop 1
    v_cndmask_b32 v76, v84, v85, vcc
    v_cmp_le_i32 vcc, 17, v12
    s_nop 1
    v_cndmask_b32 v77, v84, v85, vcc
    v_cmp_le_i32 vcc, 18, v12
    s_nop 1
    v_cndmask_b32 v78, v84, v85, vcc
    v_cmp_le_i32 vcc, 19, v12
    s_nop 1
    v_cndmask_b32 v79, v84, v85, vcc
    v_cmp_le_u32 vcc, 32, v0
    s_nop 1
    v_cndmask_b32 v80, v84, v85, vcc
    v_cndmask_b32 v81, v84, v85, vcc
    v_cndmask_b32 v82, v84, v85, vcc
    v_cndmask_b32 v83, v84, v85, vcc
    s_mov_b32 s88, 1040356334
    s_mov_b32 s80, 0
    s_mov_b32 s81, 0xffff
    s_cmp_lt_u32 s52, 4
    s_cbranch_scc1 Lup_127
    v_and_b32 v10, 15, v0
    v_lshlrev_b32 v10, 4, v10
    s_lshl_b32 s62, s55, 8
    s_and_b32 s63, s52, 3
    s_lshl_b32 s63, s63, 16
    s_add_u32 s62, s62, s63
    v_add_u32 v10, s62, v10
    v_lshrrev_b32 v12, 4, v0
    v_lshl_add_u32 v10, v12, 14, v10
Lup_127:
    s_add_u32 s79, s56, 1
    v_mov_b32 v0, v64
    s_mov_b32 s60, 0
L_QKX_loop:
    s_cmp_ge_u32 s60, 32
    s_cbranch_scc1 L_QKX_att
    s_waitcnt vmcnt(0)
    s_barrier
    s_cmp_lt_u32 s52, 4
    s_cbranch_scc1 Lkp_128
    s_cmp_ge_u32 s79, 64
    s_cbranch_scc1 Lkp_129
    s_mul_i32 s62, s79, 43
    s_lshr_b32 s62, s62, 7
    s_and_b32 s64, s62, 1
    s_lshl_b32 s64, s64, 13
    s_xor_b32 s64, s64, s46
    s_lshl_b32 s62, s62, 17
    s_add_u32 s64, s64, s62
    s_mul_i32 s62, s79, 655360
    s_add_u32 s64, s64, s62
    s_add_u32 s64, s64, 37748736
    s_add_u32 s62, s64, 262144
    buffer_store_dwordx4 v[4:7], v10, s[4:7], s64 offen sc1
    buffer_store_dwordx4 v[4:7], v10, s[4:7], s62 offen sc1
    s_cmp_ge_u32 s52, 6
    s_cbranch_scc1 Lkp_129
    s_add_u32 s62, s64, 524288
    buffer_store_dwordx4 v[4:7], v10, s[4:7], s62 offen sc1
Lkp_129:
    s_cmp_lg_u32 s52, 7
    s_cbranch_scc1 Lkp_128
    buffer_store_dwordx4 v[4:7], v1, s[4:7], s70 offen sc1
    buffer_store_dwordx4 v[4:7], v1, s[4:7], s70 offen offset:1024 sc1
Lkp_128:
    s_add_u32 s79, s79, 2
    s_add_u32 s70, s70, 131072
    s_cmp_eq_u32 s60, 0
    s_cbranch_scc1 L_QKX_skip
    ds_read_b128 v[16:19], v2 offset:0
    ds_read_b128 v[20:23], v2 offset:20480
    ds_read_b128 v[24:27], v3 offset:0
    ds_read_b128 v[28:31], v3 offset:20480
    ds_read_b128 v[32:35], v2 offset:1024
    ds_read_b128 v[36:39], v2 offset:21504
    ds_read_b128 v[40:43], v3 offset:1024
    ds_read_b128 v[44:47], v3 offset:21504
    s_waitcnt lgkmcnt(6)
    v_mfma_f32_16x16x32_bf16 v[48:51], a[0:3], v[16:19], 0
    v_mfma_f32_16x16x32_bf16 v[52:55], a[80:83], v[16:19], 0
    v_mfma_f32_16x16x32_bf16 v[56:59], a[0:3], v[20:23], 0
    v_mfma_f32_16x16x32_bf16 v[60:63], a[80:83], v[20:23], 0
    ds_read_b128 v[16:19], v2 offset:2048
    ds_read_b128 v[20:23], v2 offset:22528
    s_waitcnt lgkmcnt(6)
    v_mfma_f32_16x16x32_bf16 v[48:51], a[4:7], v[24:27], v[48:51]
    v_mfma_f32_16x16x32_bf16 v[52:55], a[84:87], v[24:27], v[52:55]
    v_mfma_f32_16x16x32_bf16 v[56:59], a[4:7], v[28:31], v[56:59]
    v_mfma_f32_16x16x32_bf16 v[60:63], a[84:87], v[28:31], v[60:63]
    s_add_u32 m0, s72, 0
    s_nop 0
    buffer_load_dwordx4 v0, s[48:51], s71 offen offset:0 lds
    ds_read_b128 v[24:27], v3 offset:2048
    ds_read_b128 v[28:31], v3 offset:22528
    s_waitcnt lgkmcnt(6)
    v_mfma_f32_16x16x32_bf16 v[48:51], a[8:11], v[32:35], v[48:51]
    v_mfma_f32_16x16x32_bf16 v[52:55], a[88:91], v[32:35], v[52:55]
    v_mfma_f32_16x16x32_bf16 v[56:59], a[8:11], v[36:39], v[56:59]
    v_mfma_f32_16x16x32_bf16 v[60:63], a[88:91], v[36:39], v[60:63]
    ds_read_b128 v[32:35], v2 offset:3072
    ds_read_b128 v[36:39], v2 offset:23552
    s_waitcnt lgkmcnt(6)
    v_mfma_f32_16x16x32_bf16 v[48:51], a[12:15], v[40:43], v[48:51]
    v_mfma_f32_16x16x32_bf16 v[52:55], a[92:95], v[40:43], v[52:55]
    v_mfma_f32_16x16x32_bf16 v[56:59], a[12:15], v[44:47], v[56:59]
    v_mfma_f32_16x16x32_bf16 v[60:63], a[92:95], v[44:47], v[60:63]
    ds_read_b128 v[40:43], v3 offset:3072
    ds_read_b128 v[44:47], v3 offset:23552
    s_waitcnt lgkmcnt(6)
    v_mfma_f32_16x16x32_bf16 v[48:51], a[16:19], v[16:19], v[48:51]
    v_mfma_f32_16x16x32_bf16 v[52:55], a[96:99], v[16:19], v[52:55]
    v_mfma_f32_16x16x32_bf16 v[56:59], a[16:19], v[20:23], v[56:59]
    v_mfma_f32_16x16x32_bf16 v[60:63], a[96:99], v[20:23], v[60:63]
    s_add_u32 m0, s72, 896
    s_nop 0
    buffer_load_dwordx4 v0, s[48:51], s71 offen offset:128 lds
    ds_read_b128 v[16:19], v2 offset:4096
    ds_read_b128 v[20:23], v2 offset:24576
    s_waitcnt lgkmcnt(6)
    v_mfma_f32_16x16x32_bf16 v[48:51], a[20:23], v[24:27], v[48:51]
    v_mfma_f32_16x16x32_bf16 v[52:55], a[100:103], v[24:27], v[52:55]
    v_mfma_f32_16x16x32_bf16 v[56:59], a[20:23], v[28:31], v[56:59]
    v_mfma_f32_16x16x32_bf16 v[60:63], a[100:103], v[28:31], v[60:63]
    ds_read_b128 v[24:27], v3 offset:4096
    ds_read_b128 v[28:31], v3 offset:24576
    s_waitcnt lgkmcnt(6)
    v_mfma_f32_16x16x32_bf16 v[48:51], a[24:27], v[32:35], v[48:51]
    v_mfma_f32_16x16x32_bf16 v[52:55], a[104:107], v[32:35], v[52:55]
    v_mfma_f32_16x16x32_bf16 v[56:59], a[24:27], v[36:39], v[56:59]
    v_mfma_f32_16x16x32_bf16 v[60:63], a[104:107], v[36:39], v[60:63]
    ds_read_b128 v[32:35], v2 offset:5120
    ds_read_b128 v[36:39], v2 offset:25600
    s_waitcnt lgkmcnt(6)
    v_mfma_f32_16x16x32_bf16 v[48:51], a[28:31], v[40:43], v[48:51]
    v_mfma_f32_16x16x32_bf16 v[52:55], a[108:111], v[40:43], v[52:55]
    v_mfma_f32_16x16x32_bf16 v[56:59], a[28:31], v[44:47], v[56:59]
    v_mfma_f32_16x16x32_bf16 v[60:63], a[108:111], v[44:47], v[60:63]
    s_add_u32 m0, s72, 1792
    s_nop 0
    buffer_load_dwordx4 v0, s[48:51], s71 offen offset:256 lds
    ds_read_b128 v[40:43], v3 offset:5120
    ds_read_b128 v[44:47], v3 offset:25600
    s_waitcnt lgkmcnt(6)
    v_mfma_f32_16x16x32_bf16 v[48:51], a[32:35], v[16:19], v[48:51]
    v_mfma_f32_16x16x32_bf16 v[52:55], a[112:115], v[16:19], v[52:55]
    v_mfma_f32_16x16x32_bf16 v[56:59], a[32:35], v[20:23], v[56:59]
    v_mfma_f32_16x16x32_bf16 v[60:63], a[112:115], v[20:23], v[60:63]
    ds_read_b128 v[16:19], v2 offset:6144
    ds_read_b128 v[20:23], v2 offset:26624
    s_waitcnt lgkmcnt(6)
    v_mfma_f32_16x16x32_bf16 v[48:51], a[36:39], v[24:27], v[48:51]
    v_mfma_f32_16x16x32_bf16 v[52:55], a[116:119], v[24:27], v[52:55]
    v_mfma_f32_16x16x32_bf16 v[56:59], a[36:39], v[28:31], v[56:59]
    v_mfma_f32_16x16x32_bf16 v[60:63], a[116:119], v[28:31], v[60:63]
    ds_read_b128 v[24:27], v3 offset:6144
    ds_read_b128 v[28:31], v3 offset:26624
    s_waitcnt lgkmcnt(6)
    v_mfma_f32_16x16x32_bf16 v[48:51], a[40:43], v[32:35], v[48:51]
    v_mfma_f32_16x16x32_bf16 v[52:55], a[120:123], v[32:35], v[52:55]
    v_mfma_f32_16x16x32_bf16 v[56:59], a[40:43], v[36:39], v[56:59]
    v_mfma_f32_16x16x32_bf16 v[60:63], a[120:123], v[36:39], v[60:63]
    s_add_u32 m0, s72, 2688
    s_nop 0
    buffer_load_dwordx4 v0, s[48:51], s71 offen offset:384 lds
    ds_read_b128 v[32:35], v2 offset:7168
    ds_read_b128 v[36:39], v2 offset:27648
    s_waitcnt lgkmcnt(6)
    v_mfma_f32_16x16x32_bf16 v[48:51], a[44:47], v[40:43], v[48:51]
    v_mfma_f32_16x16x32_bf16 v[52:55], a[124:127], v[40:43], v[52:55]
    v_mfma_f32_16x16x32_bf16 v[56:59], a[44:47], v[44:47], v[56:59]
    v_mfma_f32_16x16x32_bf16 v[60:63], a[124:127], v[44:47], v[60:63]
    ds_read_b128 v[40:43], v3 offset:7168
    ds_read_b128 v[44:47], v3 offset:27648
    s_waitcnt lgkmcnt(6)
    v_mfma_f32_16x16x32_bf16 v[48:51], a[48:51], v[16:19], v[48:51]
    v_mfma_f32_16x16x32_bf16 v[52:55], a[128:131], v[16:19], v[52:55]
    v_mfma_f32_16x16x32_bf16 v[56:59], a[48:51], v[20:23], v[56:59]
    v_mfma_f32_16x16x32_bf16 v[60:63], a[128:131], v[20:23], v[60:63]
    ds_read_b128 v[16:19], v2 offset:8192
    ds_read_b128 v[20:23], v2 offset:28672
    s_waitcnt lgkmcnt(6)
    v_mfma_f32_16x16x32_bf16 v[48:51], a[52:55], v[24:27], v[48:51]
    v_mfma_f32_16x16x32_bf16 v[52:55], a[132:135], v[24:27], v[52:55]
    v_mfma_f32_16x16x32_bf16 v[56:59], a[52:55], v[28:31], v[56:59]
    v_mfma_f32_16x16x32_bf16 v[60:63], a[132:135], v[28:31], v[60:63]
    s_add_u32 m0, s72, 3584
    s_nop 0
    buffer_load_dwordx4 v0, s[48:51], s71 offen offset:512 lds
    s_add_u32 s71, s71, 81920
    s_add_u32 s62, s72, 40960
    s_sub_u32 s63, s72, 40960
    s_cmp_lt_u32 s72, 40960
    s_cselect_b32 s72, s62, s63
    ds_read_b128 v[24:27], v3 offset:8192
    ds_read_b128 v[28:31], v3 offset:28672
    s_waitcnt lgkmcnt(6)
    v_mfma_f32_16x16x32_bf16 v[48:51], a[56:59], v[32:35], v[48:51]
    v_mfma_f32_16x16x32_bf16 v[52:55], a[136:139], v[32:35], v[52:55]
    v_mfma_f32_16x16x32_bf16 v[56:59], a[56:59], v[36:39], v[56:59]
    v_mfma_f32_16x16x32_bf16 v[60:63], a[136:139], v[36:39], v[60:63]
    ds_read_b128 v[32:35], v2 offset:9216
    ds_read_b128 v[36:39], v2 offset:29696
    s_waitcnt lgkmcnt(6)
    v_mfma_f32_16x16x32_bf16 v[48:51], a[60:63], v[40:43], v[48:51]
    v_mfma_f32_16x16x32_bf16 v[52:55], a[140:143], v[40:43], v[52:55]
    v_mfma_f32_16x16x32_bf16 v[56:59], a[60:63], v[44:47], v[56:59]
    v_mfma_f32_16x16x32_bf16 v[60:63], a[140:143], v[44:47], v[60:63]
    ds_read_b128 v[40:43], v3 offset:9216
    ds_read_b128 v[44:47], v3 offset:29696
    s_waitcnt lgkmcnt(6)
    v_mfma_f32_16x16x32_bf16 v[48:51], a[64:67], v[16:19], v[48:51]
    v_mfma_f32_16x16x32_bf16 v[52:55], a[144:147], v[16:19], v[52:55]
    v_mfma_f32_16x16x32_bf16 v[56:59], a[64:67], v[20:23], v[56:59]
    v_mfma_f32_16x16x32_bf16 v[60:63], a[144:147], v[20:23], v[60:63]
    s_waitcnt lgkmcnt(4)
    v_mfma_f32_16x16x32_bf16 v[48:51], a[68:71], v[24:27], v[48:51]
    v_mfma_f32_16x16x32_bf16 v[52:55], a[148:151], v[24:27], v[52:55]
    v_mfma_f32_16x16x32_bf16 v[56:59], a[68:71], v[28:31], v[56:59]
    v_mfma_f32_16x16x32_bf16 v[60:63], a[148:151], v[28:31], v[60:63]
    s_waitcnt lgkmcnt(2)
    v_mfma_f32_16x16x32_bf16 v[48:51], a[72:75], v[32:35], v[48:51]
    v_mfma_f32_16x16x32_bf16 v[52:55], a[152:155], v[32:35], v[52:55]
    v_mfma_f32_16x16x32_bf16 v[56:59], a[72:75], v[36:39], v[56:59]
    v_mfma_f32_16x16x32_bf16 v[60:63], a[152:155], v[36:39], v[60:63]
    s_waitcnt lgkmcnt(0)
    v_mfma_f32_16x16x32_bf16 v[48:51], a[76:79], v[40:43], v[48:51]
    v_mfma_f32_16x16x32_bf16 v[52:55], a[156:159], v[40:43], v[52:55]
    v_mfma_f32_16x16x32_bf16 v[56:59], a[76:79], v[44:47], v[56:59]
    v_mfma_f32_16x16x32_bf16 v[60:63], a[156:159], v[44:47], v[60:63]
L_QKX_skip:
    v_add_u32 v12, 40960, v2
    v_subrev_u32 v2, 40960, v2
    v_min_u32 v2, v2, v12
    v_xor_b32 v3, 64, v2
    v_add_u32 v12, s68, v9
    v_cvt_pk_bf16_f32 v64, v48, v49
    v_cvt_pk_bf16_f32 v65, v50, v51
    v_cvt_pk_bf16_f32 v66, v52, v53
    v_cvt_pk_bf16_f32 v67, v54, v55
    v_cvt_pk_bf16_f32 v68, v56, v57
    v_cvt_pk_bf16_f32 v69, v58, v59
    v_cvt_pk_bf16_f32 v70, v60, v61
    v_cvt_pk_bf16_f32 v71, v62, v63
    ds_write_b128 v12, v[64:67]
    ds_write_b128 v12, v[68:71] offset:4096
    s_cmp_ge_u32 s52, 4
    s_cbranch_scc1 Lks_130
    s_add_u32 s62, s78, 4096
    buffer_store_dwordx4 v[64:67], v1, s[4:7], s78 offen sc1
    buffer_store_dwordx4 v[68:71], v1, s[4:7], s62 offen sc1
Lks_130:
    s_add_u32 s78, s78, 16384
    s_add_u32 s68, s68, 16384
    s_cmp_ge_u32 s68, 32768
    s_cselect_b32 s68, 0, s68
    s_add_u32 s65, s60, 1
    s_waitcnt vmcnt(0) lgkmcnt(0)
    s_barrier
    s_cmp_lg_u32 s52, 7
    s_cbranch_scc1 Lfs_131
    v_mov_b32 v13, s65
    s_mov_b64 exec, 1
    buffer_store_dword v13, v8, s[4:7], 0 offen sc1
    s_mov_b64 exec, -1
Lfs_131:
L_QKX_att:
    s_cmp_lt_u32 s60, 1
    s_cbranch_scc1 L_QKX_next
    s_cmp_ge_u32 s52, 2
    s_cbranch_scc1 L_QKX_next
    s_cmp_lg_u32 s60, 1
    s_cbranch_scc1 Lgw_132
    v_bfe_u32 v11, v1, 4, 5
    v_lshlrev_b32 v11, 7, v11
    v_add_u32 v11, 2387968, v11
    s_mov_b32 s64, 1
    s_mov_b32 s89, s59
Lsp_133:
    buffer_load_dword v12, v11, s[4:7], 0 offen sc1
    s_waitcnt vmcnt(0)
    v_cmp_gt_u32 vcc, s64, v12
    s_cbranch_vccz Lspd_134
    s_sleep 4
    s_sub_u32 s89, s89, 1
    s_cbranch_scc0 Lsp_133
    s_mov_b32 s59, 0
Lspd_134:
    v_bfe_u32 v11, v1, 4, 4
    v_lshlrev_b32 v11, 2, v11
    s_lshl_b32 s62, s52, 6
    s_add_u32 s62, s62, 2293760
    v_add_u32 v11, s62, v11
Lgw_132:
    s_lshl_b32 s62, s73, 7
    buffer_load_dword v64, v11, s[4:7], s62 offen sc1
    s_add_u32 s62, s69, 81920
    v_add_u32 v12, s62, v1
    s_lshl_b32 s63, s52, 12
    v_add_u32 v13, s63, v12
    ds_read_b128 v[16:19], v13 offset:8192
    ds_read_b128 v[32:35], v12 offset:0
    ds_read_b128 v[48:51], v12 offset:4096
    ds_read_b128 v[20:23], v13 offset:9216
    ds_read_b128 v[36:39], v12 offset:1024
    ds_read_b128 v[52:55], v12 offset:5120
    ds_read_b128 v[24:27], v13 offset:10240
    ds_read_b128 v[40:43], v12 offset:2048
    ds_read_b128 v[56:59], v12 offset:6144
    ds_read_b128 v[28:31], v13 offset:11264
    ds_read_b128 v[44:47], v12 offset:3072
    ds_read_b128 v[60:63], v12 offset:7168
    s_waitcnt lgkmcnt(9)
    v_mfma_f32_16x16x32_bf16 v[84:87], v[32:35], v[16:19], v[72:75]
    v_mfma_f32_16x16x32_bf16 v[88:91], v[48:51], v[16:19], v[76:79]
    s_waitcnt lgkmcnt(6)
    v_mfma_f32_16x16x32_bf16 v[84:87], v[36:39], v[20:23], v[84:87]
    v_mfma_f32_16x16x32_bf16 v[88:91], v[52:55], v[20:23], v[88:91]
    s_waitcnt lgkmcnt(3)
    v_mfma_f32_16x16x32_bf16 v[84:87], v[40:43], v[24:27], v[84:87]
    v_mfma_f32_16x16x32_bf16 v[88:91], v[56:59], v[24:27], v[88:91]
    s_waitcnt lgkmcnt(0)
    v_mfma_f32_16x16x32_bf16 v[84:87], v[44:47], v[28:31], v[84:87]
    v_mfma_f32_16x16x32_bf16 v[88:91], v[60:63], v[28:31], v[88:91]
    s_lshl_b32 s64, s73, 16
    s_nop 7
    s_mov_b32 s89, s59
Lpoll_135:
    buffer_load_dwordx4 v[32:35], v10, s[4:7], s64 offen offset:0 sc1
    buffer_load_dwordx4 v[36:39], v10, s[4:7], s64 offen offset:512 sc1
    buffer_load_dwordx4 v[40:43], v10, s[4:7], s64 offen offset:1024 sc1
    buffer_load_dwordx4 v[44:47], v10, s[4:7], s64 offen offset:1536 sc1
    s_waitcnt vmcnt(0)
Lchk_136:
    v_max_u32 v12, v32, v33
    v_max3_u32 v12, v12, v34, v35
    v_max3_u32 v12, v12, v36, v37
    v_max3_u32 v12, v12, v38, v39
    v_max3_u32 v12, v12, v40, v41
    v_max3_u32 v12, v12, v42, v43
    v_max3_u32 v12, v12, v44, v45
    v_max3_u32 v12, v12, v46, v47
    v_cmp_eq_u32 vcc, -1, v12
    s_cbranch_vccz Lpdone_137
    s_sleep 2
    s_sub_u32 s89, s89, 1
    s_cbranch_scc0 Lpoll_135
    s_mov_b32 s59, 0
Lpdone_137:
    v_mfma_f32_16x16x32_bf16 v[92:95], v[32:35], v[16:19], v[80:83]
    v_mfma_f32_16x16x32_bf16 v[92:95], v[36:39], v[20:23], v[92:95]
    v_mfma_f32_16x16x32_bf16 v[92:95], v[40:43], v[24:27], v[92:95]
    v_mfma_f32_16x16x32_bf16 v[92:95], v[44:47], v[28:31], v[92:95]
    v_max_f32 v12, v84, v85
    v_max3_f32 v12, v12, v86, v87
    v_max3_f32 v12, v12, v88, v89
    v_max3_f32 v12, v12, v90, v91
    s_nop 3
    v_max3_f32 v12, v12, v92, v93
    v_max3_f32 v12, v12, v94, v95
    v_mov_b32 v13, v12
    s_nop 1
    v_permlane32_swap_b32 v12, v13
    v_max_f32 v12, v12, v13
    v_mov_b32 v13, v12
    s_nop 1
    v_permlane16_swap_b32 v12, v13
    v_max_f32 v12, v12, v13
    v_mul_f32 v12, s88, v12
    v_fma_f32 v84, v84, s88, -v12
    v_fma_f32 v85, v85, s88, -v12
    v_fma_f32 v86, v86, s88, -v12
    v_fma_f32 v87, v87, s88, -v12
    v_fma_f32 v88, v88, s88, -v12
    v_fma_f32 v89, v89, s88, -v12
    v_fma_f32 v90, v90, s88, -v12
    v_fma_f32 v91, v91, s88, -v12
    v_fma_f32 v92, v92, s88, -v12
    v_fma_f32 v93, v93, s88, -v12
    v_fma_f32 v94, v94, s88, -v12
    v_fma_f32 v95, v95, s88, -v12
    v_exp_f32 v84, v84
    v_exp_f32 v85, v85
    v_exp_f32 v86, v86
    v_exp_f32 v87, v87
    v_exp_f32 v88, v88
    v_exp_f32 v89, v89
    v_exp_f32 v90, v90
    v_exp_f32 v91, v91
    v_exp_f32 v92, v92
    v_exp_f32 v93, v93
    v_exp_f32 v94, v94
    v_exp_f32 v95, v95
    v_add_f32 v12, v84, v85
    v_add_f32 v12, v12, v86
    v_add_f32 v12, v12, v87
    v_add_f32 v12, v12, v88
    v_add_f32 v12, v12, v89
    v_add_f32 v12, v12, v90
    v_add_f32 v12, v12, v91
    v_add_f32 v12, v12, v92
    v_add_f32 v12, v12, v93
    v_add_f32 v12, v12, v94
    v_add_f32 v12, v12, v95
    v_mov_b32 v13, v12
    s_nop 1
    v_permlane32_swap_b32 v12, v13
    v_add_f32 v12, v12, v13
    v_mov_b32 v13, v12
    s_nop 1
    v_permlane16_swap_b32 v12, v13
    v_add_f32 v12, v12, v13
    v_rcp_f32 v12, v12
    s_nop 0
    v_mul_f32 v12, v12, v64
    v_mul_f32 v84, v84, v12
    v_mul_f32 v85, v85, v12
    v_mul_f32 v86, v86, v12
    v_mul_f32 v87, v87, v12
    v_mul_f32 v88, v88, v12
    v_mul_f32 v89, v89, v12
    v_mul_f32 v90, v90, v12
    v_mul_f32 v91, v91, v12
    v_mul_f32 v92, v92, v12
    v_mul_f32 v93, v93, v12
    v_mul_f32 v94, v94, v12
    v_mul_f32 v95, v95, v12
    v_cvt_pk_bf16_f32 v84, v84, v85
    v_cvt_pk_bf16_f32 v85, v86, v87
    v_cvt_pk_bf16_f32 v86, v88, v89
    v_cvt_pk_bf16_f32 v87, v90, v91
    v_cvt_pk_bf16_f32 v88, v92, v93
    v_cvt_pk_bf16_f32 v89, v94, v95
    s_nop 0
    v_permlane16_swap_b32 v88, v90
    v_permlane16_swap_b32 v89, v91
    s_lshl_b32 s62, s55, 1
    s_add_u32 s62, s62, s52
    s_lshl_b32 s62, s62, 10
    s_add_u32 s62, s62, s64
    s_add_u32 s62, s62, 31457280
    s_lshl_b32 s63, s73, 14
    buffer_store_dwordx4 v[84:87], v1, s[4:7], s62 offen sc1
    s_mov_b64 exec, s[80:81]
    buffer_store_dwordx4 v[88:91], v14, s[4:7], s63 offen sc1
    s_sub_u32 s62, s60, 0
    s_mov_b64 exec, 1
    v_mov_b32 v12, s62
    s_waitcnt vmcnt(0)
    buffer_store_dword v12, v15, s[4:7], 0 offen sc1
    s_mov_b64 exec, -1
    s_add_u32 s73, s73, 2
    s_add_u32 s69, s69, 16384
    s_cmp_ge_u32 s69, 32768
    s_cselect_b32 s69, 0, s69
L_QKX_next:
    s_add_u32 s60, s60, 1
    s_cmp_lt_u32 s60, 33
    s_cbranch_scc1 L_QKX_loop
    s_branch L_end
L_VOX:
    s_lshl_b32 s62, s55, 1
    s_add_u32 s62, s62, s56
    s_lshl_b32 s62, s62, 7
    s_add_u32 s90, s62, 2375680
    s_mov_b32 s48, s16
    s_and_b32 s49, s17, 0xffff
    s_mov_b32 s50, 2621440
    s_mov_b32 s51, 0x00020000
    v_lshrrev_b32 v6, 3, v0
    v_and_b32 v5, 7, v0
    v_xor_b32 v5, v5, v6
    v_lshlrev_b32 v5, 4, v5
    v_mul_u32_u24 v6, 1280, v6
    v_add_u32 v5, v5, v6
    s_lshr_b32 s62, s52, 1
    s_mul_i32 s62, s62, 10240
    s_and_b32 s63, s52, 1
    s_mul_i32 s63, s63, 640
    s_add_u32 s71, s62, s63
    s_mul_i32 s62, s56, 40960
    s_add_u32 s71, s71, s62
    s_mul_i32 s72, s52, 5120
    s_add_u32 s72, s72, 0
    v_lshrrev_b32 v2, 4, v0
    v_and_b32 v6, 7, v0
    v_xor_b32 v2, v2, v6
    v_lshlrev_b32 v2, 4, v2
    v_lshl_add_u32 v2, v6, 7, v2
    v_bfe_u32 v6, v0, 3, 1
    v_mul_u32_u24 v6, 10240, v6
    v_add_u32 v2, v2, v6
    v_add_u32 v2, 0, v2
    v_xor_b32 v3, 64, v2
    v_lshrrev_b32 v14, 4, v0
    v_bfe_u32 v10, v0, 1, 3
    v_xor_b32 v10, v10, v14
    v_lshlrev_b32 v10, 5, v10
    v_and_b32 v14, 1, v0
    v_lshl_add_u32 v10, v14, 4, v10
    v_lshrrev_b32 v14, 4, v0
    v_mul_u32_u24 v14, 8192, v14
    v_add_u32 v10, v10, v14
    v_lshrrev_b32 v14, 4, v0
    v_or_b32 v14, 4, v14
    v_bfe_u32 v11, v0, 1, 3
    v_xor_b32 v11, v11, v14
    v_lshlrev_b32 v11, 5, v11
    v_and_b32 v14, 1, v0
    v_lshl_add_u32 v11, v14, 4, v11
    v_lshrrev_b32 v14, 4, v0
    v_mul_u32_u24 v14, 8192, v14
    v_add_u32 v11, v11, v14
    s_and_b32 s64, s52, 3
    s_lshl_b32 s64, s64, 1
    v_bfe_u32 v12, v0, 2, 3
    v_xor_b32 v12, s64, v12
    v_lshlrev_b32 v12, 5, v12
    v_and_b32 v14, 3, v0
    v_lshl_add_u32 v12, v14, 3, v12
    v_bfe_u32 v14, v0, 2, 2
    v_lshl_add_u32 v12, v14, 8, v12
    v_lshrrev_b32 v14, 4, v0
    v_lshl_add_u32 v12, v14, 11, v12
    v_lshrrev_b32 v14, 4, v0
    v_lshlrev_b32 v14, 10, v14
    v_sub_u32 v16, v12, v14
    s_lshr_b32 s62, s55, 4
    s_mul_i32 s79, s62, 2138112
    s_bfe_u32 s62, s55, 0x10003
    s_mul_i32 s62, s62, 24576
    s_xor_b32 s79, s79, s62
    s_and_b32 s62, s55, 7
    s_lshl_b32 s62, s62, 10
    s_add_u32 s79, s79, s62
    s_and_b32 s62, s64, 31
    s_lshl_b32 s62, s62, 16
    s_add_u32 s79, s79, s62
    s_lshl_b32 s62, s64, 22
    s_add_u32 s79, s79, s62
    s_add_u32 s79, s79, 83886080
    s_mov_b32 s78, s79
    v_lshlrev_b32 v1, 4, v0
    v_mov_b32 v9, s90
    s_lshl_b32 s62, s52, 10
    s_cmp_ge_u32 s52, 4
    s_cselect_b32 s62, 0, s62
    s_add_u32 s62, s62, 81920
    v_add_u32 v8, s62, v1
    s_mov_b32 s12, s24
    s_and_b32 s13, s25, 0xffff
    s_mov_b32 s14, 5242880
    s_mov_b32 s15, 0x00020000
    s_lshl_b32 s62, s52, 4
    s_add_u32 s62, s62, 0
    s_mul_i32 s62, s62, 8192
    s_mul_i32 s63, s55, 256
    s_add_u32 s62, s62, s63
    s_lshl_b32 s63, s52, 12
    s_add_u32 s63, s63, 98304
    s_mov_b32 m0, s63
    s_nop 0
    buffer_load_dwordx4 v10, s[12:15], s62 offen lds
    s_add_u32 s62, s62, 32768
    s_add_u32 s63, s63, 1024
    s_mov_b32 m0, s63
    s_nop 0
    buffer_load_dwordx4 v10, s[12:15], s62 offen lds
    s_add_u32 s62, s62, 32768
    s_add_u32 s63, s63, 1024
    s_mov_b32 m0, s63
    s_nop 0
    buffer_load_dwordx4 v11, s[12:15], s62 offen lds
    s_add_u32 s62, s62, 32768
    s_add_u32 s63, s63, 1024
    s_mov_b32 m0, s63
    s_nop 0
    buffer_load_dwordx4 v11, s[12:15], s62 offen lds
    s_waitcnt vmcnt(4)
    s_barrier
    s_or_b32 s62, s52, s30
    s_cbranch_scc1 Lci_138
    s_lshl_b32 s62, 1, s54
    s_lshl_b32 s63, s53, 5
    v_mov_b32 v20, s62
    v_mov_b32 v14, s63
    s_mov_b64 exec, 1
    buffer_atomic_or v20, v14, s[8:11], 0 offen sc0
    s_mov_b64 exec, -1
Lci_138:
    v_min_u32 v23, 7, v0
    v_lshlrev_b32 v23, 5, v23
    s_add_u32 m0, s72, 0
    s_nop 0
    buffer_load_dwordx4 v5, s[48:51], s71 offen offset:0 lds
    s_add_u32 m0, s72, 896
    s_nop 0
    buffer_load_dwordx4 v5, s[48:51], s71 offen offset:128 lds
    s_add_u32 m0, s72, 1792
    s_nop 0
    buffer_load_dwordx4 v5, s[48:51], s71 offen offset:256 lds
    s_add_u32 m0, s72, 2688
    s_nop 0
    buffer_load_dwordx4 v5, s[48:51], s71 offen offset:384 lds
    s_add_u32 m0, s72, 3584
    s_nop 0
    buffer_load_dwordx4 v5, s[48:51], s71 offen offset:512 lds
    s_add_u32 s71, s71, 40960
    s_add_u32 s62, s72, 40960
    s_sub_u32 s63, s72, 40960
    s_cmp_lt_u32 s72, 40960
    s_cselect_b32 s72, s62, s63
    s_lshl_b32 s62, s52, 4
    s_add_u32 s62, s62, 128
    s_mul_i32 s62, s62, 8192
    s_mul_i32 s63, s55, 256
    s_add_u32 s62, s62, s63
    s_lshl_b32 s63, s52, 12
    s_add_u32 s63, s63, 131072
    s_mov_b32 m0, s63
    s_nop 0
    buffer_load_dwordx4 v10, s[12:15], s62 offen lds
    s_add_u32 s62, s62, 32768
    s_add_u32 s63, s63, 1024
    s_mov_b32 m0, s63
    s_nop 0
    buffer_load_dwordx4 v10, s[12:15], s62 offen lds
    s_add_u32 s62, s62, 32768
    s_add_u32 s63, s63, 1024
    s_mov_b32 m0, s63
    s_nop 0
    buffer_load_dwordx4 v11, s[12:15], s62 offen lds
    s_add_u32 s62, s62, 32768
    s_add_u32 s63, s63, 1024
    s_mov_b32 m0, s63
    s_nop 0
    buffer_load_dwordx4 v11, s[12:15], s62 offen lds
    s_waitcnt vmcnt(4)
    s_barrier
    v_add_u32 v13, 98304, v12
    s_add_u32 m0, s72, 0
    s_nop 0
    buffer_load_dwordx4 v5, s[48:51], s71 offen offset:0 lds
    s_cmp_ge_u32 s52, 4
    s_cbranch_scc1 Lvv_139
    ds_read_b64_tr_b16 a[0:1], v13 offset:0
    ds_read_b64_tr_b16 a[2:3], v13 offset:1024
    ds_read_b64_tr_b16 a[4:5], v13 offset:8192
    ds_read_b64_tr_b16 a[6:7], v13 offset:9216
    ds_read_b64_tr_b16 a[8:9], v13 offset:16384
    ds_read_b64_tr_b16 a[10:11], v13 offset:17408
    ds_read_b64_tr_b16 a[12:13], v13 offset:24576
    ds_read_b64_tr_b16 a[14:15], v13 offset:25600
    v_xor_b32 v13, 32, v13
    ds_read_b64_tr_b16 a[80:81], v13 offset:0
    ds_read_b64_tr_b16 a[82:83], v13 offset:1024
    ds_read_b64_tr_b16 a[84:85], v13 offset:8192
    ds_read_b64_tr_b16 a[86:87], v13 offset:9216
    ds_read_b64_tr_b16 a[88:89], v13 offset:16384
    ds_read_b64_tr_b16 a[90:91], v13 offset:17408
    ds_read_b64_tr_b16 a[92:93], v13 offset:24576
    ds_read_b64_tr_b16 a[94:95], v13 offset:25600
Lvv_139:
    s_waitcnt lgkmcnt(0)
    s_barrier
    s_lshl_b32 s62, s52, 4
    s_add_u32 s62, s62, 256
    s_mul_i32 s62, s62, 8192
    s_mul_i32 s63, s55, 256
    s_add_u32 s62, s62, s63
    s_lshl_b32 s63, s52, 12
    s_add_u32 s63, s63, 98304
    s_mov_b32 m0, s63
    s_nop 0
    buffer_load_dwordx4 v10, s[12:15], s62 offen lds
    s_add_u32 s62, s62, 32768
    s_add_u32 s63, s63, 1024
    s_mov_b32 m0, s63
    s_nop 0
    buffer_load_dwordx4 v10, s[12:15], s62 offen lds
    s_add_u32 s62, s62, 32768
    s_add_u32 s63, s63, 1024
    s_mov_b32 m0, s63
    s_nop 0
    buffer_load_dwordx4 v11, s[12:15], s62 offen lds
    s_add_u32 s62, s62, 32768
    s_add_u32 s63, s63, 1024
    s_mov_b32 m0, s63
    s_nop 0
    buffer_load_dwordx4 v11, s[12:15], s62 offen lds
    s_cmp_ge_u32 s52, 4
    s_cbranch_scc1 Lvv_140
    ds_read_b128 v[24:27], v2 offset:0
    ds_read_b128 v[28:31], v2 offset:20480
    ds_read_b128 v[32:35], v3 offset:0
    ds_read_b128 v[36:39], v3 offset:20480
    s_waitcnt lgkmcnt(0)
    v_mfma_f32_16x16x32_bf16 v[56:59], a[0:3], v[24:27], 0
    v_mfma_f32_16x16x32_bf16 v[60:63], a[80:83], v[24:27], 0
    v_mfma_f32_16x16x32_bf16 v[64:67], a[0:3], v[28:31], 0
    v_mfma_f32_16x16x32_bf16 v[68:71], a[80:83], v[28:31], 0
    v_mfma_f32_16x16x32_bf16 v[56:59], a[4:7], v[32:35], v[56:59]
    v_mfma_f32_16x16x32_bf16 v[60:63], a[84:87], v[32:35], v[60:63]
    v_mfma_f32_16x16x32_bf16 v[64:67], a[4:7], v[36:39], v[64:67]
    v_mfma_f32_16x16x32_bf16 v[68:71], a[84:87], v[36:39], v[68:71]
    ds_read_b128 v[24:27], v2 offset:1024
    ds_read_b128 v[28:31], v2 offset:21504
    ds_read_b128 v[32:35], v3 offset:1024
    ds_read_b128 v[36:39], v3 offset:21504
    s_waitcnt lgkmcnt(0)
    v_mfma_f32_16x16x32_bf16 v[56:59], a[8:11], v[24:27], v[56:59]
    v_mfma_f32_16x16x32_bf16 v[60:63], a[88:91], v[24:27], v[60:63]
    v_mfma_f32_16x16x32_bf16 v[64:67], a[8:11], v[28:31], v[64:67]
    v_mfma_f32_16x16x32_bf16 v[68:71], a[88:91], v[28:31], v[68:71]
    v_mfma_f32_16x16x32_bf16 v[56:59], a[12:15], v[32:35], v[56:59]
    v_mfma_f32_16x16x32_bf16 v[60:63], a[92:95], v[32:35], v[60:63]
    v_mfma_f32_16x16x32_bf16 v[64:67], a[12:15], v[36:39], v[64:67]
    v_mfma_f32_16x16x32_bf16 v[68:71], a[92:95], v[36:39], v[68:71]
Lvv_140:
    s_waitcnt lgkmcnt(0)
    s_waitcnt vmcnt(4)
    s_barrier
    v_add_u32 v13, 131072, v12
    s_add_u32 m0, s72, 896
    s_nop 0
    buffer_load_dwordx4 v5, s[48:51], s71 offen offset:128 lds
    s_cmp_ge_u32 s52, 4
    s_cbranch_scc1 Lvv_141
    ds_read_b64_tr_b16 a[16:17], v13 offset:0
    ds_read_b64_tr_b16 a[18:19], v13 offset:1024
    ds_read_b64_tr_b16 a[20:21], v13 offset:8192
    ds_read_b64_tr_b16 a[22:23], v13 offset:9216
    ds_read_b64_tr_b16 a[24:25], v13 offset:16384
    ds_read_b64_tr_b16 a[26:27], v13 offset:17408
    ds_read_b64_tr_b16 a[28:29], v13 offset:24576
    ds_read_b64_tr_b16 a[30:31], v13 offset:25600
    v_xor_b32 v13, 32, v13
    ds_read_b64_tr_b16 a[96:97], v13 offset:0
    ds_read_b64_tr_b16 a[98:99], v13 offset:1024
    ds_read_b64_tr_b16 a[100:101], v13 offset:8192
    ds_read_b64_tr_b16 a[102:103], v13 offset:9216
    ds_read_b64_tr_b16 a[104:105], v13 offset:16384
    ds_read_b64_tr_b16 a[106:107], v13 offset:17408
    ds_read_b64_tr_b16 a[108:109], v13 offset:24576
    ds_read_b64_tr_b16 a[110:111], v13 offset:25600
Lvv_141:
    s_waitcnt lgkmcnt(0)
    s_barrier
    s_lshl_b32 s62, s52, 4
    s_add_u32 s62, s62, 384
    s_mul_i32 s62, s62, 8192
    s_mul_i32 s63, s55, 256
    s_add_u32 s62, s62, s63
    s_lshl_b32 s63, s52, 12
    s_add_u32 s63, s63, 131072
    s_mov_b32 m0, s63
    s_nop 0
    buffer_load_dwordx4 v10, s[12:15], s62 offen lds
    s_add_u32 s62, s62, 32768
    s_add_u32 s63, s63, 1024
    s_mov_b32 m0, s63
    s_nop 0
    buffer_load_dwordx4 v10, s[12:15], s62 offen lds
    s_add_u32 s62, s62, 32768
    s_add_u32 s63, s63, 1024
    s_mov_b32 m0, s63
    s_nop 0
    buffer_load_dwordx4 v11, s[12:15], s62 offen lds
    s_add_u32 s62, s62, 32768
    s_add_u32 s63, s63, 1024
    s_mov_b32 m0, s63
    s_nop 0
    buffer_load_dwordx4 v11, s[12:15], s62 offen lds
    s_cmp_ge_u32 s52, 4
    s_cbranch_scc1 Lvv_142
    ds_read_b128 v[24:27], v2 offset:2048
    ds_read_b128 v[28:31], v2 offset:22528
    ds_read_b128 v[32:35], v3 offset:2048
    ds_read_b128 v[36:39], v3 offset:22528
    s_waitcnt lgkmcnt(0)
    v_mfma_f32_16x16x32_bf16 v[56:59], a[16:19], v[24:27], v[56:59]
    v_mfma_f32_16x16x32_bf16 v[60:63], a[96:99], v[24:27], v[60:63]
    v_mfma_f32_16x16x32_bf16 v[64:67], a[16:19], v[28:31], v[64:67]
    v_mfma_f32_16x16x32_bf16 v[68:71], a[96:99], v[28:31], v[68:71]
    v_mfma_f32_16x16x32_bf16 v[56:59], a[20:23], v[32:35], v[56:59]
    v_mfma_f32_16x16x32_bf16 v[60:63], a[100:103], v[32:35], v[60:63]
    v_mfma_f32_16x16x32_bf16 v[64:67], a[20:23], v[36:39], v[64:67]
    v_mfma_f32_16x16x32_bf16 v[68:71], a[100:103], v[36:39], v[68:71]
    ds_read_b128 v[24:27], v2 offset:3072
    ds_read_b128 v[28:31], v2 offset:23552
    ds_read_b128 v[32:35], v3 offset:3072
    ds_read_b128 v[36:39], v3 offset:23552
    s_waitcnt lgkmcnt(0)
    v_mfma_f32_16x16x32_bf16 v[56:59], a[24:27], v[24:27], v[56:59]
    v_mfma_f32_16x16x32_bf16 v[60:63], a[104:107], v[24:27], v[60:63]
    v_mfma_f32_16x16x32_bf16 v[64:67], a[24:27], v[28:31], v[64:67]
    v_mfma_f32_16x16x32_bf16 v[68:71], a[104:107], v[28:31], v[68:71]
    v_mfma_f32_16x16x32_bf16 v[56:59], a[28:31], v[32:35], v[56:59]
    v_mfma_f32_16x16x32_bf16 v[60:63], a[108:111], v[32:35], v[60:63]
    v_mfma_f32_16x16x32_bf16 v[64:67], a[28:31], v[36:39], v[64:67]
    v_mfma_f32_16x16x32_bf16 v[68:71], a[108:111], v[36:39], v[68:71]
Lvv_142:
    s_waitcnt lgkmcnt(0)
    s_waitcnt vmcnt(4)
    s_barrier
    v_add_u32 v13, 98304, v12
    s_add_u32 m0, s72, 1792
    s_nop 0
    buffer_load_dwordx4 v5, s[48:51], s71 offen offset:256 lds
    s_cmp_ge_u32 s52, 4
    s_cbranch_scc1 Lvv_143
    ds_read_b64_tr_b16 a[32:33], v13 offset:0
    ds_read_b64_tr_b16 a[34:35], v13 offset:1024
    ds_read_b64_tr_b16 a[36:37], v13 offset:8192
    ds_read_b64_tr_b16 a[38:39], v13 offset:9216
    ds_read_b64_tr_b16 a[40:41], v13 offset:16384
    ds_read_b64_tr_b16 a[42:43], v13 offset:17408
    ds_read_b64_tr_b16 a[44:45], v13 offset:24576
    ds_read_b64_tr_b16 a[46:47], v13 offset:25600
    v_xor_b32 v13, 32, v13
    ds_read_b64_tr_b16 a[112:113], v13 offset:0
    ds_read_b64_tr_b16 a[114:115], v13 offset:1024
    ds_read_b64_tr_b16 a[116:117], v13 offset:8192
    ds_read_b64_tr_b16 a[118:119], v13 offset:9216
    ds_read_b64_tr_b16 a[120:121], v13 offset:16384
    ds_read_b64_tr_b16 a[122:123], v13 offset:17408
    ds_read_b64_tr_b16 a[124:125], v13 offset:24576
    ds_read_b64_tr_b16 a[126:127], v13 offset:25600
Lvv_143:
    s_waitcnt lgkmcnt(0)
    s_barrier
    s_lshl_b32 s62, s52, 4
    s_add_u32 s62, s62, 512
    s_mul_i32 s62, s62, 8192
    s_mul_i32 s63, s55, 256
    s_add_u32 s62, s62, s63
    s_lshl_b32 s63, s52, 12
    s_add_u32 s63, s63, 98304
    s_mov_b32 m0, s63
    s_nop 0
    buffer_load_dwordx4 v10, s[12:15], s62 offen lds
    s_add_u32 s62, s62, 32768
    s_add_u32 s63, s63, 1024
    s_mov_b32 m0, s63
    s_nop 0
    buffer_load_dwordx4 v10, s[12:15], s62 offen lds
    s_add_u32 s62, s62, 32768
    s_add_u32 s63, s63, 1024
    s_mov_b32 m0, s63
    s_nop 0
    buffer_load_dwordx4 v11, s[12:15], s62 offen lds
    s_add_u32 s62, s62, 32768
    s_add_u32 s63, s63, 1024
    s_mov_b32 m0, s63
    s_nop 0
    buffer_load_dwordx4 v11, s[12:15], s62 offen lds
    s_cmp_ge_u32 s52, 4
    s_cbranch_scc1 Lvv_144
    ds_read_b128 v[24:27], v2 offset:4096
    ds_read_b128 v[28:31], v2 offset:24576
    ds_read_b128 v[32:35], v3 offset:4096
    ds_read_b128 v[36:39], v3 offset:24576
    s_waitcnt lgkmcnt(0)
    v_mfma_f32_16x16x32_bf16 v[56:59], a[32:35], v[24:27], v[56:59]
    v_mfma_f32_16x16x32_bf16 v[60:63], a[112:115], v[24:27], v[60:63]
    v_mfma_f32_16x16x32_bf16 v[64:67], a[32:35], v[28:31], v[64:67]
    v_mfma_f32_16x16x32_bf16 v[68:71], a[112:115], v[28:31], v[68:71]
    v_mfma_f32_16x16x32_bf16 v[56:59], a[36:39], v[32:35], v[56:59]
    v_mfma_f32_16x16x32_bf16 v[60:63], a[116:119], v[32:35], v[60:63]
    v_mfma_f32_16x16x32_bf16 v[64:67], a[36:39], v[36:39], v[64:67]
    v_mfma_f32_16x16x32_bf16 v[68:71], a[116:119], v[36:39], v[68:71]
    ds_read_b128 v[24:27], v2 offset:5120
    ds_read_b128 v[28:31], v2 offset:25600
    ds_read_b128 v[32:35], v3 offset:5120
    ds_read_b128 v[36:39], v3 offset:25600
    s_waitcnt lgkmcnt(0)
    v_mfma_f32_16x16x32_bf16 v[56:59], a[40:43], v[24:27], v[56:59]
    v_mfma_f32_16x16x32_bf16 v[60:63], a[120:123], v[24:27], v[60:63]
    v_mfma_f32_16x16x32_bf16 v[64:67], a[40:43], v[28:31], v[64:67]
    v_mfma_f32_16x16x32_bf16 v[68:71], a[120:123], v[28:31], v[68:71]
    v_mfma_f32_16x16x32_bf16 v[56:59], a[44:47], v[32:35], v[56:59]
    v_mfma_f32_16x16x32_bf16 v[60:63], a[124:127], v[32:35], v[60:63]
    v_mfma_f32_16x16x32_bf16 v[64:67], a[44:47], v[36:39], v[64:67]
    v_mfma_f32_16x16x32_bf16 v[68:71], a[124:127], v[36:39], v[68:71]
Lvv_144:
    s_waitcnt lgkmcnt(0)
    s_waitcnt vmcnt(4)
    s_barrier
    v_add_u32 v13, 131072, v12
    s_add_u32 m0, s72, 2688
    s_nop 0
    buffer_load_dwordx4 v5, s[48:51], s71 offen offset:384 lds
    s_cmp_ge_u32 s52, 4
    s_cbranch_scc1 Lvv_145
    ds_read_b64_tr_b16 a[48:49], v13 offset:0
    ds_read_b64_tr_b16 a[50:51], v13 offset:1024
    ds_read_b64_tr_b16 a[52:53], v13 offset:8192
    ds_read_b64_tr_b16 a[54:55], v13 offset:9216
    ds_read_b64_tr_b16 a[56:57], v13 offset:16384
    ds_read_b64_tr_b16 a[58:59], v13 offset:17408
    ds_read_b64_tr_b16 a[60:61], v13 offset:24576
    ds_read_b64_tr_b16 a[62:63], v13 offset:25600
    v_xor_b32 v13, 32, v13
    ds_read_b64_tr_b16 a[128:129], v13 offset:0
    ds_read_b64_tr_b16 a[130:131], v13 offset:1024
    ds_read_b64_tr_b16 a[132:133], v13 offset:8192
    ds_read_b64_tr_b16 a[134:135], v13 offset:9216
    ds_read_b64_tr_b16 a[136:137], v13 offset:16384
    ds_read_b64_tr_b16 a[138:139], v13 offset:17408
    ds_read_b64_tr_b16 a[140:141], v13 offset:24576
    ds_read_b64_tr_b16 a[142:143], v13 offset:25600
Lvv_145:
    s_waitcnt lgkmcnt(0)
    s_barrier
    s_mov_b32 s12, s26
    s_and_b32 s13, s27, 0xffff
    s_mov_b32 s14, 5242880
    s_mov_b32 s15, 0x00020000
    v_lshrrev_b32 v14, 4, v0
    v_bfe_u32 v10, v0, 1, 3
    v_xor_b32 v10, v10, v14
    v_lshlrev_b32 v10, 5, v10
    v_and_b32 v14, 1, v0
    v_lshl_add_u32 v10, v14, 4, v10
    v_lshrrev_b32 v14, 4, v0
    v_mul_u32_u24 v14, 1280, v14
    v_add_u32 v10, v10, v14
    v_lshrrev_b32 v14, 4, v0
    v_or_b32 v14, 4, v14
    v_bfe_u32 v11, v0, 1, 3
    v_xor_b32 v11, v11, v14
    v_lshlrev_b32 v11, 5, v11
    v_and_b32 v14, 1, v0
    v_lshl_add_u32 v11, v14, 4, v11
    v_lshrrev_b32 v14, 4, v0
    v_mul_u32_u24 v14, 1280, v14
    v_add_u32 v11, v11, v14
    s_lshl_b32 s62, s55, 7
    s_lshl_b32 s63, s52, 4
    s_add_u32 s62, s62, s63
    s_mul_i32 s62, s62, 1280
    s_add_u32 s62, s62, 0
    s_lshl_b32 s63, s52, 12
    s_add_u32 s63, s63, 131072
    s_mov_b32 m0, s63
    s_nop 0
    buffer_load_dwordx4 v10, s[12:15], s62 offen lds
    s_add_u32 s62, s62, 5120
    s_add_u32 s63, s63, 1024
    s_mov_b32 m0, s63
    s_nop 0
    buffer_load_dwordx4 v11, s[12:15], s62 offen lds
    s_add_u32 s62, s62, 5120
    s_add_u32 s63, s63, 1024
    s_mov_b32 m0, s63
    s_nop 0
    buffer_load_dwordx4 v10, s[12:15], s62 offen lds
    s_add_u32 s62, s62, 5120
    s_add_u32 s63, s63, 1024
    s_mov_b32 m0, s63
    s_nop 0
    buffer_load_dwordx4 v11, s[12:15], s62 offen lds
    s_cmp_ge_u32 s52, 4
    s_cbranch_scc1 Lvv_146
    ds_read_b128 v[24:27], v2 offset:6144
    ds_read_b128 v[28:31], v2 offset:26624
    ds_read_b128 v[32:35], v3 offset:6144
    ds_read_b128 v[36:39], v3 offset:26624
    s_waitcnt lgkmcnt(0)
    v_mfma_f32_16x16x32_bf16 v[56:59], a[48:51], v[24:27], v[56:59]
    v_mfma_f32_16x16x32_bf16 v[60:63], a[128:131], v[24:27], v[60:63]
    v_mfma_f32_16x16x32_bf16 v[64:67], a[48:51], v[28:31], v[64:67]
    v_mfma_f32_16x16x32_bf16 v[68:71], a[128:131], v[28:31], v[68:71]
    v_mfma_f32_16x16x32_bf16 v[56:59], a[52:55], v[32:35], v[56:59]
    v_mfma_f32_16x16x32_bf16 v[60:63], a[132:135], v[32:35], v[60:63]
    v_mfma_f32_16x16x32_bf16 v[64:67], a[52:55], v[36:39], v[64:67]
    v_mfma_f32_16x16x32_bf16 v[68:71], a[132:135], v[36:39], v[68:71]
    ds_read_b128 v[24:27], v2 offset:7168
    ds_read_b128 v[28:31], v2 offset:27648
    ds_read_b128 v[32:35], v3 offset:7168
    ds_read_b128 v[36:39], v3 offset:27648
    s_waitcnt lgkmcnt(0)
    v_mfma_f32_16x16x32_bf16 v[56:59], a[56:59], v[24:27], v[56:59]
    v_mfma_f32_16x16x32_bf16 v[60:63], a[136:139], v[24:27], v[60:63]
    v_mfma_f32_16x16x32_bf16 v[64:67], a[56:59], v[28:31], v[64:67]
    v_mfma_f32_16x16x32_bf16 v[68:71], a[136:139], v[28:31], v[68:71]
    v_mfma_f32_16x16x32_bf16 v[56:59], a[60:63], v[32:35], v[56:59]
    v_mfma_f32_16x16x32_bf16 v[60:63], a[140:143], v[32:35], v[60:63]
    v_mfma_f32_16x16x32_bf16 v[64:67], a[60:63], v[36:39], v[64:67]
    v_mfma_f32_16x16x32_bf16 v[68:71], a[140:143], v[36:39], v[68:71]
Lvv_146:
    s_waitcnt lgkmcnt(0)
    s_waitcnt vmcnt(4)
    s_barrier
    v_add_u32 v13, 98304, v12
    s_add_u32 m0, s72, 3584
    s_nop 0
    buffer_load_dwordx4 v5, s[48:51], s71 offen offset:512 lds
    s_add_u32 s71, s71, 40960
    s_add_u32 s62, s72, 40960
    s_sub_u32 s63, s72, 40960
    s_cmp_lt_u32 s72, 40960
    s_cselect_b32 s72, s62, s63
    s_cmp_ge_u32 s52, 4
    s_cbranch_scc1 Lvv_147
    ds_read_b64_tr_b16 a[64:65], v13 offset:0
    ds_read_b64_tr_b16 a[66:67], v13 offset:1024
    ds_read_b64_tr_b16 a[68:69], v13 offset:8192
    ds_read_b64_tr_b16 a[70:71], v13 offset:9216
    ds_read_b64_tr_b16 a[72:73], v13 offset:16384
    ds_read_b64_tr_b16 a[74:75], v13 offset:17408
    ds_read_b64_tr_b16 a[76:77], v13 offset:24576
    ds_read_b64_tr_b16 a[78:79], v13 offset:25600
    v_xor_b32 v13, 32, v13
    ds_read_b64_tr_b16 a[144:145], v13 offset:0
    ds_read_b64_tr_b16 a[146:147], v13 offset:1024
    ds_read_b64_tr_b16 a[148:149], v13 offset:8192
    ds_read_b64_tr_b16 a[150:151], v13 offset:9216
    ds_read_b64_tr_b16 a[152:153], v13 offset:16384
    ds_read_b64_tr_b16 a[154:155], v13 offset:17408
    ds_read_b64_tr_b16 a[156:157], v13 offset:24576
    ds_read_b64_tr_b16 a[158:159], v13 offset:25600
Lvv_147:
    s_waitcnt lgkmcnt(0)
    s_barrier
    s_lshl_b32 s62, s55, 7
    s_lshl_b32 s63, s52, 4
    s_add_u32 s62, s62, s63
    s_mul_i32 s62, s62, 1280
    s_add_u32 s62, s62, 256
    s_lshl_b32 s63, s52, 12
    s_add_u32 s63, s63, 98304
    s_mov_b32 m0, s63
    s_nop 0
    buffer_load_dwordx4 v10, s[12:15], s62 offen lds
    s_add_u32 s62, s62, 5120
    s_add_u32 s63, s63, 1024
    s_mov_b32 m0, s63
    s_nop 0
    buffer_load_dwordx4 v11, s[12:15], s62 offen lds
    s_add_u32 s62, s62, 5120
    s_add_u32 s63, s63, 1024
    s_mov_b32 m0, s63
    s_nop 0
    buffer_load_dwordx4 v10, s[12:15], s62 offen lds
    s_add_u32 s62, s62, 5120
    s_add_u32 s63, s63, 1024
    s_mov_b32 m0, s63
    s_nop 0
    buffer_load_dwordx4 v11, s[12:15], s62 offen lds
    s_cmp_ge_u32 s52, 4
    s_cbranch_scc1 Lvv_148
    ds_read_b128 v[24:27], v2 offset:8192
    ds_read_b128 v[28:31], v2 offset:28672
    ds_read_b128 v[32:35], v3 offset:8192
    ds_read_b128 v[36:39], v3 offset:28672
    s_waitcnt lgkmcnt(0)
    v_mfma_f32_16x16x32_bf16 v[56:59], a[64:67], v[24:27], v[56:59]
    v_mfma_f32_16x16x32_bf16 v[60:63], a[144:147], v[24:27], v[60:63]
    v_mfma_f32_16x16x32_bf16 v[64:67], a[64:67], v[28:31], v[64:67]
    v_mfma_f32_16x16x32_bf16 v[68:71], a[144:147], v[28:31], v[68:71]
    v_mfma_f32_16x16x32_bf16 v[56:59], a[68:71], v[32:35], v[56:59]
    v_mfma_f32_16x16x32_bf16 v[60:63], a[148:151], v[32:35], v[60:63]
    v_mfma_f32_16x16x32_bf16 v[64:67], a[68:71], v[36:39], v[64:67]
    v_mfma_f32_16x16x32_bf16 v[68:71], a[148:151], v[36:39], v[68:71]
    ds_read_b128 v[24:27], v2 offset:9216
    ds_read_b128 v[28:31], v2 offset:29696
    ds_read_b128 v[32:35], v3 offset:9216
    ds_read_b128 v[36:39], v3 offset:29696
    s_waitcnt lgkmcnt(0)
    v_mfma_f32_16x16x32_bf16 v[56:59], a[72:75], v[24:27], v[56:59]
    v_mfma_f32_16x16x32_bf16 v[60:63], a[152:155], v[24:27], v[60:63]
    v_mfma_f32_16x16x32_bf16 v[64:67], a[72:75], v[28:31], v[64:67]
    v_mfma_f32_16x16x32_bf16 v[68:71], a[152:155], v[28:31], v[68:71]
    v_mfma_f32_16x16x32_bf16 v[56:59], a[76:79], v[32:35], v[56:59]
    v_mfma_f32_16x16x32_bf16 v[60:63], a[156:159], v[32:35], v[60:63]
    v_mfma_f32_16x16x32_bf16 v[64:67], a[76:79], v[36:39], v[64:67]
    v_mfma_f32_16x16x32_bf16 v[68:71], a[156:159], v[36:39], v[68:71]
    v_add_u32 v6, 40960, v2
    v_subrev_u32 v2, 40960, v2
    v_min_u32 v2, v2, v6
    v_xor_b32 v3, 64, v2
    s_nop 0
    v_cvt_pk_bf16_f32 v80, v56, v57
    v_cvt_pk_bf16_f32 v81, v58, v59
    v_cvt_pk_bf16_f32 v82, v60, v61
    v_cvt_pk_bf16_f32 v83, v62, v63
    v_cvt_pk_bf16_f32 v84, v64, v65
    v_cvt_pk_bf16_f32 v85, v66, v67
    v_cvt_pk_bf16_f32 v86, v68, v69
    v_cvt_pk_bf16_f32 v87, v70, v71
    ds_write_b128 v8, v[80:83]
    ds_write_b128 v8, v[84:87] offset:4096
    v_xor_b32 v8, 0x2000, v8
Lvv_148:
    s_waitcnt lgkmcnt(0)
    s_waitcnt vmcnt(4)
    s_barrier
    v_add_u32 v13, 131072, v16
    s_add_u32 m0, s72, 0
    s_nop 0
    buffer_load_dwordx4 v5, s[48:51], s71 offen offset:0 lds
    s_cmp_ge_u32 s52, 4
    s_cbranch_scc0 Lvo_149
    ds_read_b64_tr_b16 a[0:1], v13 offset:0
    ds_read_b64_tr_b16 a[2:3], v13 offset:4096
    ds_read_b64_tr_b16 a[4:5], v13 offset:8192
    ds_read_b64_tr_b16 a[6:7], v13 offset:12288
    ds_read_b64_tr_b16 a[8:9], v13 offset:16384
    ds_read_b64_tr_b16 a[10:11], v13 offset:20480
    ds_read_b64_tr_b16 a[12:13], v13 offset:24576
    ds_read_b64_tr_b16 a[14:15], v13 offset:28672
    v_xor_b32 v13, 32, v13
    ds_read_b64_tr_b16 a[16:17], v13 offset:0
    ds_read_b64_tr_b16 a[18:19], v13 offset:4096
    ds_read_b64_tr_b16 a[20:21], v13 offset:8192
    ds_read_b64_tr_b16 a[22:23], v13 offset:12288
    ds_read_b64_tr_b16 a[24:25], v13 offset:16384
    ds_read_b64_tr_b16 a[26:27], v13 offset:20480
    ds_read_b64_tr_b16 a[28:29], v13 offset:24576
    ds_read_b64_tr_b16 a[30:31], v13 offset:28672
    ds_read_b128 v[24:27], v8 offset:0
    ds_read_b128 v[28:31], v8 offset:1024
    ds_read_b128 v[32:35], v8 offset:2048
    ds_read_b128 v[36:39], v8 offset:3072
    ds_read_b128 v[40:43], v8 offset:4096
    ds_read_b128 v[44:47], v8 offset:5120
    ds_read_b128 v[48:51], v8 offset:6144
    ds_read_b128 v[52:55], v8 offset:7168
    v_xor_b32 v8, 0x2000, v8
Lvo_149:
    s_waitcnt lgkmcnt(0)
    s_barrier
    s_lshl_b32 s62, s55, 7
    s_lshl_b32 s63, s52, 4
    s_add_u32 s62, s62, s63
    s_mul_i32 s62, s62, 1280
    s_add_u32 s62, s62, 512
    s_lshl_b32 s63, s52, 12
    s_add_u32 s63, s63, 131072
    s_mov_b32 m0, s63
    s_nop 0
    buffer_load_dwordx4 v10, s[12:15], s62 offen lds
    s_add_u32 s62, s62, 5120
    s_add_u32 s63, s63, 1024
    s_mov_b32 m0, s63
    s_nop 0
    buffer_load_dwordx4 v11, s[12:15], s62 offen lds
    s_add_u32 s62, s62, 5120
    s_add_u32 s63, s63, 1024
    s_mov_b32 m0, s63
    s_nop 0
    buffer_load_dwordx4 v10, s[12:15], s62 offen lds
    s_add_u32 s62, s62, 5120
    s_add_u32 s63, s63, 1024
    s_mov_b32 m0, s63
    s_nop 0
    buffer_load_dwordx4 v11, s[12:15], s62 offen lds
    s_cmp_ge_u32 s52, 4
    s_cbranch_scc0 Lvo_151
    v_mfma_f32_16x16x32_bf16 v[56:59], v[24:27], a[0:3], 0
    v_mfma_f32_16x16x32_bf16 v[60:63], v[40:43], a[0:3], 0
    v_mfma_f32_16x16x32_bf16 v[56:59], v[28:31], a[4:7], v[56:59]
    v_mfma_f32_16x16x32_bf16 v[60:63], v[44:47], a[4:7], v[60:63]
    v_mfma_f32_16x16x32_bf16 v[56:59], v[32:35], a[8:11], v[56:59]
    v_mfma_f32_16x16x32_bf16 v[60:63], v[48:51], a[8:11], v[60:63]
    v_mfma_f32_16x16x32_bf16 v[56:59], v[36:39], a[12:15], v[56:59]
    v_mfma_f32_16x16x32_bf16 v[60:63], v[52:55], a[12:15], v[60:63]
    v_mfma_f32_16x16x32_bf16 v[64:67], v[24:27], a[16:19], 0
    v_mfma_f32_16x16x32_bf16 v[68:71], v[40:43], a[16:19], 0
    v_mfma_f32_16x16x32_bf16 v[64:67], v[28:31], a[20:23], v[64:67]
    v_mfma_f32_16x16x32_bf16 v[68:71], v[44:47], a[20:23], v[68:71]
    v_mfma_f32_16x16x32_bf16 v[64:67], v[32:35], a[24:27], v[64:67]
    v_mfma_f32_16x16x32_bf16 v[68:71], v[48:51], a[24:27], v[68:71]
    v_mfma_f32_16x16x32_bf16 v[64:67], v[36:39], a[28:31], v[64:67]
    v_mfma_f32_16x16x32_bf16 v[68:71], v[52:55], a[28:31], v[68:71]
    v_cvt_pk_bf16_f32 v80, v56, v57
    v_cvt_pk_bf16_f32 v81, v58, v59
    v_cvt_pk_bf16_f32 v82, v60, v61
    v_cvt_pk_bf16_f32 v83, v62, v63
    s_xor_b32 s64, s78, 0
    s_add_u32 s64, s64, 0
    buffer_store_dwordx4 v[80:83], v1, s[4:7], s64 offen sc1
    v_cvt_pk_bf16_f32 v84, v64, v65
    v_cvt_pk_bf16_f32 v85, v66, v67
    v_cvt_pk_bf16_f32 v86, v68, v69
    v_cvt_pk_bf16_f32 v87, v70, v71
    s_xor_b32 s64, s78, 65536
    s_add_u32 s64, s64, 4194304
    buffer_store_dwordx4 v[84:87], v1, s[4:7], s64 offen sc1
    s_branch Lvo_152
Lvo_151:
    ds_read_b128 v[24:27], v2 offset:0
    ds_read_b128 v[28:31], v2 offset:20480
    ds_read_b128 v[32:35], v3 offset:0
    ds_read_b128 v[36:39], v3 offset:20480
    s_waitcnt lgkmcnt(0)
    v_mfma_f32_16x16x32_bf16 v[56:59], a[0:3], v[24:27], 0
    v_mfma_f32_16x16x32_bf16 v[60:63], a[80:83], v[24:27], 0
    v_mfma_f32_16x16x32_bf16 v[64:67], a[0:3], v[28:31], 0
    v_mfma_f32_16x16x32_bf16 v[68:71], a[80:83], v[28:31], 0
    v_mfma_f32_16x16x32_bf16 v[56:59], a[4:7], v[32:35], v[56:59]
    v_mfma_f32_16x16x32_bf16 v[60:63], a[84:87], v[32:35], v[60:63]
    v_mfma_f32_16x16x32_bf16 v[64:67], a[4:7], v[36:39], v[64:67]
    v_mfma_f32_16x16x32_bf16 v[68:71], a[84:87], v[36:39], v[68:71]
    ds_read_b128 v[24:27], v2 offset:1024
    ds_read_b128 v[28:31], v2 offset:21504
    ds_read_b128 v[32:35], v3 offset:1024
    ds_read_b128 v[36:39], v3 offset:21504
    s_waitcnt lgkmcnt(0)
    v_mfma_f32_16x16x32_bf16 v[56:59], a[8:11], v[24:27], v[56:59]
    v_mfma_f32_16x16x32_bf16 v[60:63], a[88:91], v[24:27], v[60:63]
    v_mfma_f32_16x16x32_bf16 v[64:67], a[8:11], v[28:31], v[64:67]
    v_mfma_f32_16x16x32_bf16 v[68:71], a[88:91], v[28:31], v[68:71]
    v_mfma_f32_16x16x32_bf16 v[56:59], a[12:15], v[32:35], v[56:59]
    v_mfma_f32_16x16x32_bf16 v[60:63], a[92:95], v[32:35], v[60:63]
    v_mfma_f32_16x16x32_bf16 v[64:67], a[12:15], v[36:39], v[64:67]
    v_mfma_f32_16x16x32_bf16 v[68:71], a[92:95], v[36:39], v[68:71]
Lvo_152:
    s_waitcnt lgkmcnt(0)
    s_waitcnt vmcnt(6)
    s_cmp_ge_u32 s52, 4
    s_cbranch_scc1 Llw_153
    s_waitcnt vmcnt(4)
Llw_153:
    s_barrier
    buffer_load_dword v21, v23, s[8:11], 0 offen sc1
    v_add_u32 v13, 98304, v16
    s_add_u32 m0, s72, 896
    s_nop 0
    buffer_load_dwordx4 v5, s[48:51], s71 offen offset:128 lds
    s_cmp_ge_u32 s52, 4
    s_cbranch_scc0 Lvo_154
    ds_read_b64_tr_b16 a[32:33], v13 offset:0
    ds_read_b64_tr_b16 a[34:35], v13 offset:4096
    ds_read_b64_tr_b16 a[36:37], v13 offset:8192
    ds_read_b64_tr_b16 a[38:39], v13 offset:12288
    ds_read_b64_tr_b16 a[40:41], v13 offset:16384
    ds_read_b64_tr_b16 a[42:43], v13 offset:20480
    ds_read_b64_tr_b16 a[44:45], v13 offset:24576
    ds_read_b64_tr_b16 a[46:47], v13 offset:28672
    v_xor_b32 v13, 32, v13
    ds_read_b64_tr_b16 a[48:49], v13 offset:0
    ds_read_b64_tr_b16 a[50:51], v13 offset:4096
    ds_read_b64_tr_b16 a[52:53], v13 offset:8192
    ds_read_b64_tr_b16 a[54:55], v13 offset:12288
    ds_read_b64_tr_b16 a[56:57], v13 offset:16384
    ds_read_b64_tr_b16 a[58:59], v13 offset:20480
    ds_read_b64_tr_b16 a[60:61], v13 offset:24576
    ds_read_b64_tr_b16 a[62:63], v13 offset:28672
Lvo_154:
    s_waitcnt lgkmcnt(0)
    s_barrier
    s_lshl_b32 s62, s55, 7
    s_lshl_b32 s63, s52, 4
    s_add_u32 s62, s62, s63
    s_mul_i32 s62, s62, 1280
    s_add_u32 s62, s62, 768
    s_lshl_b32 s63, s52, 12
    s_add_u32 s63, s63, 98304
    s_mov_b32 m0, s63
    s_nop 0
    buffer_load_dwordx4 v10, s[12:15], s62 offen lds
    s_add_u32 s62, s62, 5120
    s_add_u32 s63, s63, 1024
    s_mov_b32 m0, s63
    s_nop 0
    buffer_load_dwordx4 v11, s[12:15], s62 offen lds
    s_add_u32 s62, s62, 5120
    s_add_u32 s63, s63, 1024
    s_mov_b32 m0, s63
    s_nop 0
    buffer_load_dwordx4 v10, s[12:15], s62 offen lds
    s_add_u32 s62, s62, 5120
    s_add_u32 s63, s63, 1024
    s_mov_b32 m0, s63
    s_nop 0
    buffer_load_dwordx4 v11, s[12:15], s62 offen lds
    s_cmp_ge_u32 s52, 4
    s_cbranch_scc0 Lvo_156
    v_mfma_f32_16x16x32_bf16 v[72:75], v[24:27], a[32:35], 0
    v_mfma_f32_16x16x32_bf16 v[76:79], v[40:43], a[32:35], 0
    v_mfma_f32_16x16x32_bf16 v[72:75], v[28:31], a[36:39], v[72:75]
    v_mfma_f32_16x16x32_bf16 v[76:79], v[44:47], a[36:39], v[76:79]
    v_mfma_f32_16x16x32_bf16 v[72:75], v[32:35], a[40:43], v[72:75]
    v_mfma_f32_16x16x32_bf16 v[76:79], v[48:51], a[40:43], v[76:79]
    v_mfma_f32_16x16x32_bf16 v[72:75], v[36:39], a[44:47], v[72:75]
    v_mfma_f32_16x16x32_bf16 v[76:79], v[52:55], a[44:47], v[76:79]
    v_mfma_f32_16x16x32_bf16 v[56:59], v[24:27], a[48:51], 0
    v_mfma_f32_16x16x32_bf16 v[60:63], v[40:43], a[48:51], 0
    v_mfma_f32_16x16x32_bf16 v[56:59], v[28:31], a[52:55], v[56:59]
    v_mfma_f32_16x16x32_bf16 v[60:63], v[44:47], a[52:55], v[60:63]
    v_mfma_f32_16x16x32_bf16 v[56:59], v[32:35], a[56:59], v[56:59]
    v_mfma_f32_16x16x32_bf16 v[60:63], v[48:51], a[56:59], v[60:63]
    v_mfma_f32_16x16x32_bf16 v[56:59], v[36:39], a[60:63], v[56:59]
    v_mfma_f32_16x16x32_bf16 v[60:63], v[52:55], a[60:63], v[60:63]
    v_cvt_pk_bf16_f32 v80, v72, v73
    v_cvt_pk_bf16_f32 v81, v74, v75
    v_cvt_pk_bf16_f32 v82, v76, v77
    v_cvt_pk_bf16_f32 v83, v78, v79
    s_xor_b32 s64, s78, 524288
    s_add_u32 s64, s64, 33554432
    buffer_store_dwordx4 v[80:83], v1, s[4:7], s64 offen sc1
    v_cvt_pk_bf16_f32 v84, v56, v57
    v_cvt_pk_bf16_f32 v85, v58, v59
    v_cvt_pk_bf16_f32 v86, v60, v61
    v_cvt_pk_bf16_f32 v87, v62, v63
    s_xor_b32 s64, s78, 589824
    s_add_u32 s64, s64, 37748736
    buffer_store_dwordx4 v[84:87], v1, s[4:7], s64 offen sc1
    s_branch Lvo_157
Lvo_156:
    ds_read_b128 v[24:27], v2 offset:2048
    ds_read_b128 v[28:31], v2 offset:22528
    ds_read_b128 v[32:35], v3 offset:2048
    ds_read_b128 v[36:39], v3 offset:22528
    s_waitcnt lgkmcnt(0)
    v_mfma_f32_16x16x32_bf16 v[56:59], a[16:19], v[24:27], v[56:59]
    v_mfma_f32_16x16x32_bf16 v[60:63], a[96:99], v[24:27], v[60:63]
    v_mfma_f32_16x16x32_bf16 v[64:67], a[16:19], v[28:31], v[64:67]
    v_mfma_f32_16x16x32_bf16 v[68:71], a[96:99], v[28:31], v[68:71]
    v_mfma_f32_16x16x32_bf16 v[56:59], a[20:23], v[32:35], v[56:59]
    v_mfma_f32_16x16x32_bf16 v[60:63], a[100:103], v[32:35], v[60:63]
    v_mfma_f32_16x16x32_bf16 v[64:67], a[20:23], v[36:39], v[64:67]
    v_mfma_f32_16x16x32_bf16 v[68:71], a[100:103], v[36:39], v[68:71]
    ds_read_b128 v[24:27], v2 offset:3072
    ds_read_b128 v[28:31], v2 offset:23552
    ds_read_b128 v[32:35], v3 offset:3072
    ds_read_b128 v[36:39], v3 offset:23552
    s_waitcnt lgkmcnt(0)
    v_mfma_f32_16x16x32_bf16 v[56:59], a[24:27], v[24:27], v[56:59]
    v_mfma_f32_16x16x32_bf16 v[60:63], a[104:107], v[24:27], v[60:63]
    v_mfma_f32_16x16x32_bf16 v[64:67], a[24:27], v[28:31], v[64:67]
    v_mfma_f32_16x16x32_bf16 v[68:71], a[104:107], v[28:31], v[68:71]
    v_mfma_f32_16x16x32_bf16 v[56:59], a[28:31], v[32:35], v[56:59]
    v_mfma_f32_16x16x32_bf16 v[60:63], a[108:111], v[32:35], v[60:63]
    v_mfma_f32_16x16x32_bf16 v[64:67], a[28:31], v[36:39], v[64:67]
    v_mfma_f32_16x16x32_bf16 v[68:71], a[108:111], v[36:39], v[68:71]
Lvo_157:
    s_waitcnt lgkmcnt(0)
    s_waitcnt vmcnt(6)
    s_cmp_ge_u32 s52, 4
    s_cbranch_scc1 Llw_158
    s_waitcnt vmcnt(4)
Llw_158:
    s_barrier
    v_add_u32 v13, 131072, v16
    s_add_u32 m0, s72, 1792
    s_nop 0
    buffer_load_dwordx4 v5, s[48:51], s71 offen offset:256 lds
    s_cmp_ge_u32 s52, 4
    s_cbranch_scc0 Lvo_159
    ds_read_b64_tr_b16 a[64:65], v13 offset:0
    ds_read_b64_tr_b16 a[66:67], v13 offset:4096
    ds_read_b64_tr_b16 a[68:69], v13 offset:8192
    ds_read_b64_tr_b16 a[70:71], v13 offset:12288
    ds_read_b64_tr_b16 a[72:73], v13 offset:16384
    ds_read_b64_tr_b16 a[74:75], v13 offset:20480
    ds_read_b64_tr_b16 a[76:77], v13 offset:24576
    ds_read_b64_tr_b16 a[78:79], v13 offset:28672
    v_xor_b32 v13, 32, v13
    ds_read_b64_tr_b16 a[80:81], v13 offset:0
    ds_read_b64_tr_b16 a[82:83], v13 offset:4096
    ds_read_b64_tr_b16 a[84:85], v13 offset:8192
    ds_read_b64_tr_b16 a[86:87], v13 offset:12288
    ds_read_b64_tr_b16 a[88:89], v13 offset:16384
    ds_read_b64_tr_b16 a[90:91], v13 offset:20480
    ds_read_b64_tr_b16 a[92:93], v13 offset:24576
    ds_read_b64_tr_b16 a[94:95], v13 offset:28672
Lvo_159:
    s_waitcnt lgkmcnt(0)
    s_barrier
    s_lshl_b32 s62, s55, 7
    s_lshl_b32 s63, s52, 4
    s_add_u32 s62, s62, s63
    s_mul_i32 s62, s62, 1280
    s_add_u32 s62, s62, 1024
    s_lshl_b32 s63, s52, 12
    s_add_u32 s63, s63, 131072
    s_mov_b32 m0, s63
    s_nop 0
    buffer_load_dwordx4 v10, s[12:15], s62 offen lds
    s_add_u32 s62, s62, 5120
    s_add_u32 s63, s63, 1024
    s_mov_b32 m0, s63
    s_nop 0
    buffer_load_dwordx4 v11, s[12:15], s62 offen lds
    s_add_u32 s62, s62, 5120
    s_add_u32 s63, s63, 1024
    s_mov_b32 m0, s63
    s_nop 0
    buffer_load_dwordx4 v10, s[12:15], s62 offen lds
    s_add_u32 s62, s62, 5120
    s_add_u32 s63, s63, 1024
    s_mov_b32 m0, s63
    s_nop 0
    buffer_load_dwordx4 v11, s[12:15], s62 offen lds
    s_cmp_ge_u32 s52, 4
    s_cbranch_scc0 Lvo_161
    v_mfma_f32_16x16x32_bf16 v[64:67], v[24:27], a[64:67], 0
    v_mfma_f32_16x16x32_bf16 v[68:71], v[40:43], a[64:67], 0
    v_mfma_f32_16x16x32_bf16 v[64:67], v[28:31], a[68:71], v[64:67]
    v_mfma_f32_16x16x32_bf16 v[68:71], v[44:47], a[68:71], v[68:71]
    v_mfma_f32_16x16x32_bf16 v[64:67], v[32:35], a[72:75], v[64:67]
    v_mfma_f32_16x16x32_bf16 v[68:71], v[48:51], a[72:75], v[68:71]
    v_mfma_f32_16x16x32_bf16 v[64:67], v[36:39], a[76:79], v[64:67]
    v_mfma_f32_16x16x32_bf16 v[68:71], v[52:55], a[76:79], v[68:71]
    v_mfma_f32_16x16x32_bf16 v[72:75], v[24:27], a[80:83], 0
    v_mfma_f32_16x16x32_bf16 v[76:79], v[40:43], a[80:83], 0
    v_mfma_f32_16x16x32_bf16 v[72:75], v[28:31], a[84:87], v[72:75]
    v_mfma_f32_16x16x32_bf16 v[76:79], v[44:47], a[84:87], v[76:79]
    v_mfma_f32_16x16x32_bf16 v[72:75], v[32:35], a[88:91], v[72:75]
    v_mfma_f32_16x16x32_bf16 v[76:79], v[48:51], a[88:91], v[76:79]
    v_mfma_f32_16x16x32_bf16 v[72:75], v[36:39], a[92:95], v[72:75]
    v_mfma_f32_16x16x32_bf16 v[76:79], v[52:55], a[92:95], v[76:79]
    v_cvt_pk_bf16_f32 v80, v64, v65
    v_cvt_pk_bf16_f32 v81, v66, v67
    v_cvt_pk_bf16_f32 v82, v68, v69
    v_cvt_pk_bf16_f32 v83, v70, v71
    s_xor_b32 s64, s78, 1048576
    s_add_u32 s64, s64, 67108864
    buffer_store_dwordx4 v[80:83], v1, s[4:7], s64 offen sc1
    v_cvt_pk_bf16_f32 v84, v72, v73
    v_cvt_pk_bf16_f32 v85, v74, v75
    v_cvt_pk_bf16_f32 v86, v76, v77
    v_cvt_pk_bf16_f32 v87, v78, v79
    s_xor_b32 s64, s78, 1114112
    s_add_u32 s64, s64, 71303168
    buffer_store_dwordx4 v[84:87], v1, s[4:7], s64 offen sc1
    s_branch Lvo_162
Lvo_161:
    ds_read_b128 v[24:27], v2 offset:4096
    ds_read_b128 v[28:31], v2 offset:24576
    ds_read_b128 v[32:35], v3 offset:4096
    ds_read_b128 v[36:39], v3 offset:24576
    s_waitcnt lgkmcnt(0)
    v_mfma_f32_16x16x32_bf16 v[56:59], a[32:35], v[24:27], v[56:59]
    v_mfma_f32_16x16x32_bf16 v[60:63], a[112:115], v[24:27], v[60:63]
    v_mfma_f32_16x16x32_bf16 v[64:67], a[32:35], v[28:31], v[64:67]
    v_mfma_f32_16x16x32_bf16 v[68:71], a[112:115], v[28:31], v[68:71]
    v_mfma_f32_16x16x32_bf16 v[56:59], a[36:39], v[32:35], v[56:59]
    v_mfma_f32_16x16x32_bf16 v[60:63], a[116:119], v[32:35], v[60:63]
    v_mfma_f32_16x16x32_bf16 v[64:67], a[36:39], v[36:39], v[64:67]
    v_mfma_f32_16x16x32_bf16 v[68:71], a[116:119], v[36:39], v[68:71]
    ds_read_b128 v[24:27], v2 offset:5120
    ds_read_b128 v[28:31], v2 offset:25600
    ds_read_b128 v[32:35], v3 offset:5120
    ds_read_b128 v[36:39], v3 offset:25600
    s_waitcnt lgkmcnt(0)
    v_mfma_f32_16x16x32_bf16 v[56:59], a[40:43], v[24:27], v[56:59]
    v_mfma_f32_16x16x32_bf16 v[60:63], a[120:123], v[24:27], v[60:63]
    v_mfma_f32_16x16x32_bf16 v[64:67], a[40:43], v[28:31], v[64:67]
    v_mfma_f32_16x16x32_bf16 v[68:71], a[120:123], v[28:31], v[68:71]
    v_mfma_f32_16x16x32_bf16 v[56:59], a[44:47], v[32:35], v[56:59]
    v_mfma_f32_16x16x32_bf16 v[60:63], a[124:127], v[32:35], v[60:63]
    v_mfma_f32_16x16x32_bf16 v[64:67], a[44:47], v[36:39], v[64:67]
    v_mfma_f32_16x16x32_bf16 v[68:71], a[124:127], v[36:39], v[68:71]
Lvo_162:
    s_waitcnt lgkmcnt(0)
    s_waitcnt vmcnt(6)
    s_cmp_ge_u32 s52, 4
    s_cbranch_scc1 Llw_163
    s_waitcnt vmcnt(4)
Llw_163:
    s_barrier
    buffer_load_dword v22, v23, s[8:11], 0 offen offset:4 sc1
    v_add_u32 v13, 98304, v16
    s_add_u32 m0, s72, 2688
    s_nop 0
    buffer_load_dwordx4 v5, s[48:51], s71 offen offset:384 lds
    s_cmp_ge_u32 s52, 4
    s_cbranch_scc0 Lvo_164
    ds_read_b64_tr_b16 a[96:97], v13 offset:0
    ds_read_b64_tr_b16 a[98:99], v13 offset:4096
    ds_read_b64_tr_b16 a[100:101], v13 offset:8192
    ds_read_b64_tr_b16 a[102:103], v13 offset:12288
    ds_read_b64_tr_b16 a[104:105], v13 offset:16384
    ds_read_b64_tr_b16 a[106:107], v13 offset:20480
    ds_read_b64_tr_b16 a[108:109], v13 offset:24576
    ds_read_b64_tr_b16 a[110:111], v13 offset:28672
    v_xor_b32 v13, 32, v13
    ds_read_b64_tr_b16 a[112:113], v13 offset:0
    ds_read_b64_tr_b16 a[114:115], v13 offset:4096
    ds_read_b64_tr_b16 a[116:117], v13 offset:8192
    ds_read_b64_tr_b16 a[118:119], v13 offset:12288
    ds_read_b64_tr_b16 a[120:121], v13 offset:16384
    ds_read_b64_tr_b16 a[122:123], v13 offset:20480
    ds_read_b64_tr_b16 a[124:125], v13 offset:24576
    ds_read_b64_tr_b16 a[126:127], v13 offset:28672
Lvo_164:
    s_waitcnt lgkmcnt(0)
    s_cmp_ge_u32 s52, 4
    s_cbranch_scc0 Lvo_166
    v_mfma_f32_16x16x32_bf16 v[56:59], v[24:27], a[96:99], 0
    v_mfma_f32_16x16x32_bf16 v[60:63], v[40:43], a[96:99], 0
    v_mfma_f32_16x16x32_bf16 v[56:59], v[28:31], a[100:103], v[56:59]
    v_mfma_f32_16x16x32_bf16 v[60:63], v[44:47], a[100:103], v[60:63]
    v_mfma_f32_16x16x32_bf16 v[56:59], v[32:35], a[104:107], v[56:59]
    v_mfma_f32_16x16x32_bf16 v[60:63], v[48:51], a[104:107], v[60:63]
    v_mfma_f32_16x16x32_bf16 v[56:59], v[36:39], a[108:111], v[56:59]
    v_mfma_f32_16x16x32_bf16 v[60:63], v[52:55], a[108:111], v[60:63]
    v_mfma_f32_16x16x32_bf16 v[64:67], v[24:27], a[112:115], 0
    v_mfma_f32_16x16x32_bf16 v[68:71], v[40:43], a[112:115], 0
    v_mfma_f32_16x16x32_bf16 v[64:67], v[28:31], a[116:119], v[64:67]
    v_mfma_f32_16x16x32_bf16 v[68:71], v[44:47], a[116:119], v[68:71]
    v_mfma_f32_16x16x32_bf16 v[64:67], v[32:35], a[120:123], v[64:67]
    v_mfma_f32_16x16x32_bf16 v[68:71], v[48:51], a[120:123], v[68:71]
    v_mfma_f32_16x16x32_bf16 v[64:67], v[36:39], a[124:127], v[64:67]
    v_mfma_f32_16x16x32_bf16 v[68:71], v[52:55], a[124:127], v[68:71]
    v_cvt_pk_bf16_f32 v80, v56, v57
    v_cvt_pk_bf16_f32 v81, v58, v59
    v_cvt_pk_bf16_f32 v82, v60, v61
    v_cvt_pk_bf16_f32 v83, v62, v63
    s_xor_b32 s64, s78, 1572864
    s_add_u32 s64, s64, 100663296
    buffer_store_dwordx4 v[80:83], v1, s[4:7], s64 offen sc1
    v_cvt_pk_bf16_f32 v84, v64, v65
    v_cvt_pk_bf16_f32 v85, v66, v67
    v_cvt_pk_bf16_f32 v86, v68, v69
    v_cvt_pk_bf16_f32 v87, v70, v71
    s_xor_b32 s64, s78, 1638400
    s_add_u32 s64, s64, 104857600
    buffer_store_dwordx4 v[84:87], v1, s[4:7], s64 offen sc1
    s_branch Lvo_167
Lvo_166:
    ds_read_b128 v[24:27], v2 offset:6144
    ds_read_b128 v[28:31], v2 offset:26624
    ds_read_b128 v[32:35], v3 offset:6144
    ds_read_b128 v[36:39], v3 offset:26624
    s_waitcnt lgkmcnt(0)
    v_mfma_f32_16x16x32_bf16 v[56:59], a[48:51], v[24:27], v[56:59]
    v_mfma_f32_16x16x32_bf16 v[60:63], a[128:131], v[24:27], v[60:63]
    v_mfma_f32_16x16x32_bf16 v[64:67], a[48:51], v[28:31], v[64:67]
    v_mfma_f32_16x16x32_bf16 v[68:71], a[128:131], v[28:31], v[68:71]
    v_mfma_f32_16x16x32_bf16 v[56:59], a[52:55], v[32:35], v[56:59]
    v_mfma_f32_16x16x32_bf16 v[60:63], a[132:135], v[32:35], v[60:63]
    v_mfma_f32_16x16x32_bf16 v[64:67], a[52:55], v[36:39], v[64:67]
    v_mfma_f32_16x16x32_bf16 v[68:71], a[132:135], v[36:39], v[68:71]
    ds_read_b128 v[24:27], v2 offset:7168
    ds_read_b128 v[28:31], v2 offset:27648
    ds_read_b128 v[32:35], v3 offset:7168
    ds_read_b128 v[36:39], v3 offset:27648
    s_waitcnt lgkmcnt(0)
    v_mfma_f32_16x16x32_bf16 v[56:59], a[56:59], v[24:27], v[56:59]
    v_mfma_f32_16x16x32_bf16 v[60:63], a[136:139], v[24:27], v[60:63]
    v_mfma_f32_16x16x32_bf16 v[64:67], a[56:59], v[28:31], v[64:67]
    v_mfma_f32_16x16x32_bf16 v[68:71], a[136:139], v[28:31], v[68:71]
    v_mfma_f32_16x16x32_bf16 v[56:59], a[60:63], v[32:35], v[56:59]
    v_mfma_f32_16x16x32_bf16 v[60:63], a[140:143], v[32:35], v[60:63]
    v_mfma_f32_16x16x32_bf16 v[64:67], a[60:63], v[36:39], v[64:67]
    v_mfma_f32_16x16x32_bf16 v[68:71], a[140:143], v[36:39], v[68:71]
Lvo_167:
    s_waitcnt lgkmcnt(0)
    s_waitcnt vmcnt(2)
    s_cmp_ge_u32 s52, 4
    s_cbranch_scc1 Llw_168
    s_waitcnt vmcnt(0)
Llw_168:
    s_barrier
    s_cmp_lg_u32 s52, 0
    s_cbranch_scc1 Llc_169
    v_readfirstlane_b32 s62, v20
    s_nop 0
    s_lshr_b32 s62, s62, s54
    s_andn2_b32 s62, s62, s30
    s_and_b32 s62, s62, 1
    v_cmp_ne_u32 vcc, -1, v21
    s_nop 0
    s_cmp_lg_u64 vcc, 0
    s_cselect_b32 s62, 1, s62
    v_mov_b32 v21, s62
    v_mov_b32 v23, 98304
    ds_write_b32 v23, v21
Llc_169:
    v_add_u32 v13, 131072, v16
    s_add_u32 m0, s72, 3584
    s_nop 0
    buffer_load_dwordx4 v5, s[48:51], s71 offen offset:512 lds
    s_add_u32 s71, s71, 40960
    s_add_u32 s62, s72, 40960
    s_sub_u32 s63, s72, 40960
    s_cmp_lt_u32 s72, 40960
    s_cselect_b32 s72, s62, s63
    s_cmp_ge_u32 s52, 4
    s_cbranch_scc0 Lvo_170
    ds_read_b64_tr_b16 a[128:129], v13 offset:0
    ds_read_b64_tr_b16 a[130:131], v13 offset:4096
    ds_read_b64_tr_b16 a[132:133], v13 offset:8192
    ds_read_b64_tr_b16 a[134:135], v13 offset:12288
    ds_read_b64_tr_b16 a[136:137], v13 offset:16384
    ds_read_b64_tr_b16 a[138:139], v13 offset:20480
    ds_read_b64_tr_b16 a[140:141], v13 offset:24576
    ds_read_b64_tr_b16 a[142:143], v13 offset:28672
    v_xor_b32 v13, 32, v13
    ds_read_b64_tr_b16 a[144:145], v13 offset:0
    ds_read_b64_tr_b16 a[146:147], v13 offset:4096
    ds_read_b64_tr_b16 a[148:149], v13 offset:8192
    ds_read_b64_tr_b16 a[150:151], v13 offset:12288
    ds_read_b64_tr_b16 a[152:153], v13 offset:16384
    ds_read_b64_tr_b16 a[154:155], v13 offset:20480
    ds_read_b64_tr_b16 a[156:157], v13 offset:24576
    ds_read_b64_tr_b16 a[158:159], v13 offset:28672
Lvo_170:
    s_waitcnt lgkmcnt(0)
    s_cmp_ge_u32 s52, 4
    s_cbranch_scc0 Lvo_172
    v_mfma_f32_16x16x32_bf16 v[72:75], v[24:27], a[128:131], 0
    v_mfma_f32_16x16x32_bf16 v[76:79], v[40:43], a[128:131], 0
    v_mfma_f32_16x16x32_bf16 v[72:75], v[28:31], a[132:135], v[72:75]
    v_mfma_f32_16x16x32_bf16 v[76:79], v[44:47], a[132:135], v[76:79]
    v_mfma_f32_16x16x32_bf16 v[72:75], v[32:35], a[136:139], v[72:75]
    v_mfma_f32_16x16x32_bf16 v[76:79], v[48:51], a[136:139], v[76:79]
    v_mfma_f32_16x16x32_bf16 v[72:75], v[36:39], a[140:143], v[72:75]
    v_mfma_f32_16x16x32_bf16 v[76:79], v[52:55], a[140:143], v[76:79]
    v_mfma_f32_16x16x32_bf16 v[56:59], v[24:27], a[144:147], 0
    v_mfma_f32_16x16x32_bf16 v[60:63], v[40:43], a[144:147], 0
    v_mfma_f32_16x16x32_bf16 v[56:59], v[28:31], a[148:151], v[56:59]
    v_mfma_f32_16x16x32_bf16 v[60:63], v[44:47], a[148:151], v[60:63]
    v_mfma_f32_16x16x32_bf16 v[56:59], v[32:35], a[152:155], v[56:59]
    v_mfma_f32_16x16x32_bf16 v[60:63], v[48:51], a[152:155], v[60:63]
    v_mfma_f32_16x16x32_bf16 v[56:59], v[36:39], a[156:159], v[56:59]
    v_mfma_f32_16x16x32_bf16 v[60:63], v[52:55], a[156:159], v[60:63]
    v_cvt_pk_bf16_f32 v80, v72, v73
    v_cvt_pk_bf16_f32 v81, v74, v75
    v_cvt_pk_bf16_f32 v82, v76, v77
    v_cvt_pk_bf16_f32 v83, v78, v79
    s_xor_b32 s64, s78, 0
    s_add_u32 s64, s64, 134217728
    buffer_store_dwordx4 v[80:83], v1, s[4:7], s64 offen sc1
    v_cvt_pk_bf16_f32 v84, v56, v57
    v_cvt_pk_bf16_f32 v85, v58, v59
    v_cvt_pk_bf16_f32 v86, v60, v61
    v_cvt_pk_bf16_f32 v87, v62, v63
    s_xor_b32 s64, s78, 65536
    s_add_u32 s64, s64, 138412032
    buffer_store_dwordx4 v[84:87], v1, s[4:7], s64 offen sc1
    s_branch Lvo_173
Lvo_172:
    ds_read_b128 v[24:27], v2 offset:8192
    ds_read_b128 v[28:31], v2 offset:28672
    ds_read_b128 v[32:35], v3 offset:8192
    ds_read_b128 v[36:39], v3 offset:28672
    s_waitcnt lgkmcnt(0)
    v_mfma_f32_16x16x32_bf16 v[56:59], a[64:67], v[24:27], v[56:59]
    v_mfma_f32_16x16x32_bf16 v[60:63], a[144:147], v[24:27], v[60:63]
    v_mfma_f32_16x16x32_bf16 v[64:67], a[64:67], v[28:31], v[64:67]
    v_mfma_f32_16x16x32_bf16 v[68:71], a[144:147], v[28:31], v[68:71]
    v_mfma_f32_16x16x32_bf16 v[56:59], a[68:71], v[32:35], v[56:59]
    v_mfma_f32_16x16x32_bf16 v[60:63], a[148:151], v[32:35], v[60:63]
    v_mfma_f32_16x16x32_bf16 v[64:67], a[68:71], v[36:39], v[64:67]
    v_mfma_f32_16x16x32_bf16 v[68:71], a[148:151], v[36:39], v[68:71]
    ds_read_b128 v[24:27], v2 offset:9216
    ds_read_b128 v[28:31], v2 offset:29696
    ds_read_b128 v[32:35], v3 offset:9216
    ds_read_b128 v[36:39], v3 offset:29696
    s_waitcnt lgkmcnt(0)
    v_mfma_f32_16x16x32_bf16 v[56:59], a[72:75], v[24:27], v[56:59]
    v_mfma_f32_16x16x32_bf16 v[60:63], a[152:155], v[24:27], v[60:63]
    v_mfma_f32_16x16x32_bf16 v[64:67], a[72:75], v[28:31], v[64:67]
    v_mfma_f32_16x16x32_bf16 v[68:71], a[152:155], v[28:31], v[68:71]
    v_mfma_f32_16x16x32_bf16 v[56:59], a[76:79], v[32:35], v[56:59]
    v_mfma_f32_16x16x32_bf16 v[60:63], a[156:159], v[32:35], v[60:63]
    v_mfma_f32_16x16x32_bf16 v[64:67], a[76:79], v[36:39], v[64:67]
    v_mfma_f32_16x16x32_bf16 v[68:71], a[156:159], v[36:39], v[68:71]
    v_add_u32 v6, 40960, v2
    v_subrev_u32 v2, 40960, v2
    v_min_u32 v2, v2, v6
    v_xor_b32 v3, 64, v2
    s_nop 0
    v_cvt_pk_bf16_f32 v80, v56, v57
    v_cvt_pk_bf16_f32 v81, v58, v59
    v_cvt_pk_bf16_f32 v82, v60, v61
    v_cvt_pk_bf16_f32 v83, v62, v63
    v_cvt_pk_bf16_f32 v84, v64, v65
    v_cvt_pk_bf16_f32 v85, v66, v67
    v_cvt_pk_bf16_f32 v86, v68, v69
    v_cvt_pk_bf16_f32 v87, v70, v71
    ds_write_b128 v8, v[80:83]
    ds_write_b128 v8, v[84:87] offset:4096
    v_xor_b32 v8, 0x2000, v8
Lvo_173:
    s_waitcnt lgkmcnt(0)
    s_barrier
    v_mov_b32 v23, 98304
    ds_read_b32 v23, v23
    v_readlane_b32 s62, v22, 1
    v_readlane_b32 s63, v22, 2
    v_readlane_b32 s61, v22, 3
    s_waitcnt lgkmcnt(0)
    v_cmp_eq_u32 vcc, 0, v23
    s_cbranch_vccnz Llf_174
    v_min_u32 v15, 7, v0
    v_lshlrev_b32 v15, 5, v15
    s_cmp_lg_u32 s52, 0
    s_cbranch_scc1 Lwid_176
    s_mov_b32 s64, 0
    s_cmp_lg_u32 s30, 0
    s_cbranch_scc1 Lwok_177
    s_waitcnt vmcnt(0)
    v_readfirstlane_b32 s62, v20
    s_nop 0
    s_lshr_b32 s62, s62, s54
    s_and_b32 s64, s62, 1
Lwok_177:
    v_mov_b32 v14, 163832
    v_mov_b32 v20, s64
    ds_write_b32 v14, v20
    s_waitcnt lgkmcnt(0)
    s_cmp_lg_u32 s64, 0
    s_cbranch_scc1 Lwid_176
    s_mov_b32 s89, s59
Lwi_175:
    buffer_load_dword v14, v15, s[8:11], 0 offen sc1
    s_waitcnt vmcnt(0)
    v_cmp_ne_u32 vcc, -1, v14
    s_cbranch_vccz Lwid_176
    s_sleep 8
    s_sub_u32 s89, s89, 8
    s_cbranch_scc0 Lwi_175
    s_mov_b32 s59, 0
Lwid_176:
    s_barrier
    buffer_load_dword v14, v15, s[8:11], 0 offen offset:4 sc1
    v_mov_b32 v15, 163832
    ds_read_b32 v15, v15
    s_waitcnt vmcnt(0) lgkmcnt(0)
    v_readfirstlane_b32 s62, v15
    s_nop 0
    s_cmp_lg_u32 s62, 0
    s_cbranch_scc1 L_reclaim
    v_readlane_b32 s62, v14, 1
    v_readlane_b32 s63, v14, 2
    v_readlane_b32 s61, v14, 3
Llf_174:
    s_mov_b32 s60, 2
    s_cmp_ge_u32 s52, 4
    s_cbranch_scc1 L_VOX_hi
L_VOX_lo:
    s_waitcnt vmcnt(0) lgkmcnt(0)
    s_barrier
    s_sub_u32 s64, s60, 1
    s_sub_u32 s65, s60, 2
    s_cmp_le_u32 s60, 6
    s_cselect_b32 s64, s64, s65
    s_max_i32 s64, s64, 0
    s_cmp_lg_u32 s52, 3
    s_cbranch_scc1 Lfs_178
    v_mov_b32 v7, s64
    s_mov_b64 exec, 1
    buffer_store_dword v7, v9, s[4:7], 0 offen sc1
    s_mov_b64 exec, -1
Lfs_178:
    s_cmp_ge_u32 s60, 64
    s_cbranch_scc1 L_VOX_fin
    ds_read_b128 v[24:27], v2 offset:0
    ds_read_b128 v[28:31], v2 offset:20480
    ds_read_b128 v[32:35], v3 offset:0
    ds_read_b128 v[36:39], v3 offset:20480
    ds_read_b128 v[40:43], v2 offset:1024
    ds_read_b128 v[44:47], v2 offset:21504
    ds_read_b128 v[48:51], v3 offset:1024
    ds_read_b128 v[52:55], v3 offset:21504
    s_waitcnt lgkmcnt(6)
    v_mfma_f32_16x16x32_bf16 v[56:59], a[0:3], v[24:27], 0
    v_mfma_f32_16x16x32_bf16 v[60:63], a[80:83], v[24:27], 0
    v_mfma_f32_16x16x32_bf16 v[64:67], a[0:3], v[28:31], 0
    v_mfma_f32_16x16x32_bf16 v[68:71], a[80:83], v[28:31], 0
    ds_read_b128 v[24:27], v2 offset:2048
    ds_read_b128 v[28:31], v2 offset:22528
    s_waitcnt lgkmcnt(6)
    v_mfma_f32_16x16x32_bf16 v[56:59], a[4:7], v[32:35], v[56:59]
    v_mfma_f32_16x16x32_bf16 v[60:63], a[84:87], v[32:35], v[60:63]
    v_mfma_f32_16x16x32_bf16 v[64:67], a[4:7], v[36:39], v[64:67]
    v_mfma_f32_16x16x32_bf16 v[68:71], a[84:87], v[36:39], v[68:71]
    s_add_u32 m0, s72, 0
    s_nop 0
    buffer_load_dwordx4 v5, s[48:51], s71 offen offset:0 lds
    ds_read_b128 v[32:35], v3 offset:2048
    ds_read_b128 v[36:39], v3 offset:22528
    s_waitcnt lgkmcnt(6)
    v_mfma_f32_16x16x32_bf16 v[56:59], a[8:11], v[40:43], v[56:59]
    v_mfma_f32_16x16x32_bf16 v[60:63], a[88:91], v[40:43], v[60:63]
    v_mfma_f32_16x16x32_bf16 v[64:67], a[8:11], v[44:47], v[64:67]
    v_mfma_f32_16x16x32_bf16 v[68:71], a[88:91], v[44:47], v[68:71]
    ds_read_b128 v[40:43], v2 offset:3072
    ds_read_b128 v[44:47], v2 offset:23552
    s_waitcnt lgkmcnt(6)
    v_mfma_f32_16x16x32_bf16 v[56:59], a[12:15], v[48:51], v[56:59]
    v_mfma_f32_16x16x32_bf16 v[60:63], a[92:95], v[48:51], v[60:63]
    v_mfma_f32_16x16x32_bf16 v[64:67], a[12:15], v[52:55], v[64:67]
    v_mfma_f32_16x16x32_bf16 v[68:71], a[92:95], v[52:55], v[68:71]
    ds_read_b128 v[48:51], v3 offset:3072
    ds_read_b128 v[52:55], v3 offset:23552
    s_waitcnt lgkmcnt(6)
    v_mfma_f32_16x16x32_bf16 v[56:59], a[16:19], v[24:27], v[56:59]
    v_mfma_f32_16x16x32_bf16 v[60:63], a[96:99], v[24:27], v[60:63]
    v_mfma_f32_16x16x32_bf16 v[64:67], a[16:19], v[28:31], v[64:67]
    v_mfma_f32_16x16x32_bf16 v[68:71], a[96:99], v[28:31], v[68:71]
    s_add_u32 m0, s72, 896
    s_nop 0
    buffer_load_dwordx4 v5, s[48:51], s71 offen offset:128 lds
    ds_read_b128 v[24:27], v2 offset:4096
    ds_read_b128 v[28:31], v2 offset:24576
    s_waitcnt lgkmcnt(6)
    v_mfma_f32_16x16x32_bf16 v[56:59], a[20:23], v[32:35], v[56:59]
    v_mfma_f32_16x16x32_bf16 v[60:63], a[100:103], v[32:35], v[60:63]
    v_mfma_f32_16x16x32_bf16 v[64:67], a[20:23], v[36:39], v[64:67]
    v_mfma_f32_16x16x32_bf16 v[68:71], a[100:103], v[36:39], v[68:71]
    ds_read_b128 v[32:35], v3 offset:4096
    ds_read_b128 v[36:39], v3 offset:24576
    s_waitcnt lgkmcnt(6)
    v_mfma_f32_16x16x32_bf16 v[56:59], a[24:27], v[40:43], v[56:59]
    v_mfma_f32_16x16x32_bf16 v[60:63], a[104:107], v[40:43], v[60:63]
    v_mfma_f32_16x16x32_bf16 v[64:67], a[24:27], v[44:47], v[64:67]
    v_mfma_f32_16x16x32_bf16 v[68:71], a[104:107], v[44:47], v[68:71]
    ds_read_b128 v[40:43], v2 offset:5120
    ds_read_b128 v[44:47], v2 offset:25600
    s_waitcnt lgkmcnt(6)
    v_mfma_f32_16x16x32_bf16 v[56:59], a[28:31], v[48:51], v[56:59]
    v_mfma_f32_16x16x32_bf16 v[60:63], a[108:111], v[48:51], v[60:63]
    v_mfma_f32_16x16x32_bf16 v[64:67], a[28:31], v[52:55], v[64:67]
    v_mfma_f32_16x16x32_bf16 v[68:71], a[108:111], v[52:55], v[68:71]
    s_add_u32 m0, s72, 1792
    s_nop 0
    buffer_load_dwordx4 v5, s[48:51], s71 offen offset:256 lds
    ds_read_b128 v[48:51], v3 offset:5120
    ds_read_b128 v[52:55], v3 offset:25600
    s_waitcnt lgkmcnt(6)
    v_mfma_f32_16x16x32_bf16 v[56:59], a[32:35], v[24:27], v[56:59]
    v_mfma_f32_16x16x32_bf16 v[60:63], a[112:115], v[24:27], v[60:63]
    v_mfma_f32_16x16x32_bf16 v[64:67], a[32:35], v[28:31], v[64:67]
    v_mfma_f32_16x16x32_bf16 v[68:71], a[112:115], v[28:31], v[68:71]
    ds_read_b128 v[24:27], v2 offset:6144
    ds_read_b128 v[28:31], v2 offset:26624
    s_waitcnt lgkmcnt(6)
    v_mfma_f32_16x16x32_bf16 v[56:59], a[36:39], v[32:35], v[56:59]
    v_mfma_f32_16x16x32_bf16 v[60:63], a[116:119], v[32:35], v[60:63]
    v_mfma_f32_16x16x32_bf16 v[64:67], a[36:39], v[36:39], v[64:67]
    v_mfma_f32_16x16x32_bf16 v[68:71], a[116:119], v[36:39], v[68:71]
    ds_read_b128 v[32:35], v3 offset:6144
    ds_read_b128 v[36:39], v3 offset:26624
    s_waitcnt lgkmcnt(6)
    v_mfma_f32_16x16x32_bf16 v[56:59], a[40:43], v[40:43], v[56:59]
    v_mfma_f32_16x16x32_bf16 v[60:63], a[120:123], v[40:43], v[60:63]
    v_mfma_f32_16x16x32_bf16 v[64:67], a[40:43], v[44:47], v[64:67]
    v_mfma_f32_16x16x32_bf16 v[68:71], a[120:123], v[44:47], v[68:71]
    s_add_u32 m0, s72, 2688
    s_nop 0
    buffer_load_dwordx4 v5, s[48:51], s71 offen offset:384 lds
    ds_read_b128 v[40:43], v2 offset:7168
    ds_read_b128 v[44:47], v2 offset:27648
    s_waitcnt lgkmcnt(6)
    v_mfma_f32_16x16x32_bf16 v[56:59], a[44:47], v[48:51], v[56:59]
    v_mfma_f32_16x16x32_bf16 v[60:63], a[124:127], v[48:51], v[60:63]
    v_mfma_f32_16x16x32_bf16 v[64:67], a[44:47], v[52:55], v[64:67]
    v_mfma_f32_16x16x32_bf16 v[68:71], a[124:127], v[52:55], v[68:71]
    ds_read_b128 v[48:51], v3 offset:7168
    ds_read_b128 v[52:55], v3 offset:27648
    s_waitcnt lgkmcnt(6)
    v_mfma_f32_16x16x32_bf16 v[56:59], a[48:51], v[24:27], v[56:59]
    v_mfma_f32_16x16x32_bf16 v[60:63], a[128:131], v[24:27], v[60:63]
    v_mfma_f32_16x16x32_bf16 v[64:67], a[48:51], v[28:31], v[64:67]
    v_mfma_f32_16x16x32_bf16 v[68:71], a[128:131], v[28:31], v[68:71]
    ds_read_b128 v[24:27], v2 offset:8192
    ds_read_b128 v[28:31], v2 offset:28672
    s_waitcnt lgkmcnt(6)
    v_mfma_f32_16x16x32_bf16 v[56:59], a[52:55], v[32:35], v[56:59]
    v_mfma_f32_16x16x32_bf16 v[60:63], a[132:135], v[32:35], v[60:63]
    v_mfma_f32_16x16x32_bf16 v[64:67], a[52:55], v[36:39], v[64:67]
    v_mfma_f32_16x16x32_bf16 v[68:71], a[132:135], v[36:39], v[68:71]
    s_add_u32 m0, s72, 3584
    s_nop 0
    buffer_load_dwordx4 v5, s[48:51], s71 offen offset:512 lds
    s_add_u32 s71, s71, 40960
    s_add_u32 s62, s72, 40960
    s_sub_u32 s63, s72, 40960
    s_cmp_lt_u32 s72, 40960
    s_cselect_b32 s72, s62, s63
    ds_read_b128 v[32:35], v3 offset:8192
    ds_read_b128 v[36:39], v3 offset:28672
    s_waitcnt lgkmcnt(6)
    v_mfma_f32_16x16x32_bf16 v[56:59], a[56:59], v[40:43], v[56:59]
    v_mfma_f32_16x16x32_bf16 v[60:63], a[136:139], v[40:43], v[60:63]
    v_mfma_f32_16x16x32_bf16 v[64:67], a[56:59], v[44:47], v[64:67]
    v_mfma_f32_16x16x32_bf16 v[68:71], a[136:139], v[44:47], v[68:71]
    ds_read_b128 v[40:43], v2 offset:9216
    ds_read_b128 v[44:47], v2 offset:29696
    s_waitcnt lgkmcnt(6)
    v_mfma_f32_16x16x32_bf16 v[56:59], a[60:63], v[48:51], v[56:59]
    v_mfma_f32_16x16x32_bf16 v[60:63], a[140:143], v[48:51], v[60:63]
    v_mfma_f32_16x16x32_bf16 v[64:67], a[60:63], v[52:55], v[64:67]
    v_mfma_f32_16x16x32_bf16 v[68:71], a[140:143], v[52:55], v[68:71]
    ds_read_b128 v[48:51], v3 offset:9216
    ds_read_b128 v[52:55], v3 offset:29696
    s_waitcnt lgkmcnt(6)
    v_mfma_f32_16x16x32_bf16 v[56:59], a[64:67], v[24:27], v[56:59]
    v_mfma_f32_16x16x32_bf16 v[60:63], a[144:147], v[24:27], v[60:63]
    v_mfma_f32_16x16x32_bf16 v[64:67], a[64:67], v[28:31], v[64:67]
    v_mfma_f32_16x16x32_bf16 v[68:71], a[144:147], v[28:31], v[68:71]
    s_waitcnt lgkmcnt(4)
    v_mfma_f32_16x16x32_bf16 v[56:59], a[68:71], v[32:35], v[56:59]
    v_mfma_f32_16x16x32_bf16 v[60:63], a[148:151], v[32:35], v[60:63]
    v_mfma_f32_16x16x32_bf16 v[64:67], a[68:71], v[36:39], v[64:67]
    v_mfma_f32_16x16x32_bf16 v[68:71], a[148:151], v[36:39], v[68:71]
    s_waitcnt lgkmcnt(2)
    v_mfma_f32_16x16x32_bf16 v[56:59], a[72:75], v[40:43], v[56:59]
    v_mfma_f32_16x16x32_bf16 v[60:63], a[152:155], v[40:43], v[60:63]
    v_mfma_f32_16x16x32_bf16 v[64:67], a[72:75], v[44:47], v[64:67]
    v_mfma_f32_16x16x32_bf16 v[68:71], a[152:155], v[44:47], v[68:71]
    s_waitcnt lgkmcnt(0)
    v_mfma_f32_16x16x32_bf16 v[56:59], a[76:79], v[48:51], v[56:59]
    v_mfma_f32_16x16x32_bf16 v[60:63], a[156:159], v[48:51], v[60:63]
    v_mfma_f32_16x16x32_bf16 v[64:67], a[76:79], v[52:55], v[64:67]
    v_mfma_f32_16x16x32_bf16 v[68:71], a[156:159], v[52:55], v[68:71]
    v_add_u32 v6, 40960, v2
    v_subrev_u32 v2, 40960, v2
    v_min_u32 v2, v2, v6
    v_xor_b32 v3, 64, v2
    s_nop 0
    v_cvt_pk_bf16_f32 v80, v56, v57
    v_cvt_pk_bf16_f32 v81, v58, v59
    v_cvt_pk_bf16_f32 v82, v60, v61
    v_cvt_pk_bf16_f32 v83, v62, v63
    v_cvt_pk_bf16_f32 v84, v64, v65
    v_cvt_pk_bf16_f32 v85, v66, v67
    v_cvt_pk_bf16_f32 v86, v68, v69
    v_cvt_pk_bf16_f32 v87, v70, v71
    ds_write_b128 v8, v[80:83]
    ds_write_b128 v8, v[84:87] offset:4096
    v_xor_b32 v8, 0x2000, v8
    s_add_u32 s60, s60, 1
    s_branch L_VOX_lo
L_VOX_fin:
    s_barrier
    s_cmp_lg_u32 s52, 3
    s_cbranch_scc1 Lfs_179
    v_mov_b32 v7, s60
    s_mov_b64 exec, 1
    buffer_store_dword v7, v9, s[4:7], 0 offen sc1
    s_mov_b64 exec, -1
Lfs_179:
    s_branch L_end
L_VOX_hi:
    s_setprio 1
L_VOX_hi_loop:
    s_waitcnt vmcnt(5)
    s_cmp_gt_u32 s60, 6
    s_cbranch_scc1 Lve_180
    s_waitcnt vmcnt(0)
Lve_180:
    s_barrier
    ds_read_b128 v[24:27], v8 offset:0
    ds_read_b128 v[28:31], v8 offset:1024
    ds_read_b128 v[32:35], v8 offset:2048
    ds_read_b128 v[36:39], v8 offset:3072
    ds_read_b128 v[40:43], v8 offset:4096
    ds_read_b128 v[44:47], v8 offset:5120
    ds_read_b128 v[48:51], v8 offset:6144
    ds_read_b128 v[52:55], v8 offset:7168
    v_xor_b32 v8, 0x2000, v8
    s_sub_u32 s78, s60, 1
    s_lshl_b32 s78, s78, 15
    s_xor_b32 s78, s78, s79
    s_waitcnt lgkmcnt(0)
    v_mfma_f32_16x16x32_bf16 v[56:59], v[24:27], a[0:3], 0
    v_mfma_f32_16x16x32_bf16 v[60:63], v[40:43], a[0:3], 0
    v_mfma_f32_16x16x32_bf16 v[56:59], v[28:31], a[4:7], v[56:59]
    v_mfma_f32_16x16x32_bf16 v[60:63], v[44:47], a[4:7], v[60:63]
    v_mfma_f32_16x16x32_bf16 v[56:59], v[32:35], a[8:11], v[56:59]
    v_mfma_f32_16x16x32_bf16 v[60:63], v[48:51], a[8:11], v[60:63]
    v_mfma_f32_16x16x32_bf16 v[56:59], v[36:39], a[12:15], v[56:59]
    v_mfma_f32_16x16x32_bf16 v[60:63], v[52:55], a[12:15], v[60:63]
    v_mfma_f32_16x16x32_bf16 v[64:67], v[24:27], a[16:19], 0
    v_mfma_f32_16x16x32_bf16 v[68:71], v[40:43], a[16:19], 0
    v_mfma_f32_16x16x32_bf16 v[64:67], v[28:31], a[20:23], v[64:67]
    v_mfma_f32_16x16x32_bf16 v[68:71], v[44:47], a[20:23], v[68:71]
    v_mfma_f32_16x16x32_bf16 v[64:67], v[32:35], a[24:27], v[64:67]
    v_mfma_f32_16x16x32_bf16 v[68:71], v[48:51], a[24:27], v[68:71]
    v_mfma_f32_16x16x32_bf16 v[64:67], v[36:39], a[28:31], v[64:67]
    v_mfma_f32_16x16x32_bf16 v[68:71], v[52:55], a[28:31], v[68:71]
    v_cvt_pk_bf16_f32 v80, v56, v57
    v_cvt_pk_bf16_f32 v81, v58, v59
    v_cvt_pk_bf16_f32 v82, v60, v61
    v_cvt_pk_bf16_f32 v83, v62, v63
    s_xor_b32 s64, s78, 0
    s_add_u32 s64, s64, 0
    buffer_store_dwordx4 v[80:83], v1, s[4:7], s64 offen sc1
    s_add_u32 m0, s72, 0
    s_nop 0
    buffer_load_dwordx4 v5, s[48:51], s71 offen offset:0 lds
    v_mfma_f32_16x16x32_bf16 v[72:75], v[24:27], a[32:35], 0
    v_mfma_f32_16x16x32_bf16 v[76:79], v[40:43], a[32:35], 0
    v_mfma_f32_16x16x32_bf16 v[72:75], v[28:31], a[36:39], v[72:75]
    v_mfma_f32_16x16x32_bf16 v[76:79], v[44:47], a[36:39], v[76:79]
    v_mfma_f32_16x16x32_bf16 v[72:75], v[32:35], a[40:43], v[72:75]
    v_mfma_f32_16x16x32_bf16 v[76:79], v[48:51], a[40:43], v[76:79]
    v_mfma_f32_16x16x32_bf16 v[72:75], v[36:39], a[44:47], v[72:75]
    v_mfma_f32_16x16x32_bf16 v[76:79], v[52:55], a[44:47], v[76:79]
    v_cvt_pk_bf16_f32 v84, v64, v65
    v_cvt_pk_bf16_f32 v85, v66, v67
    v_cvt_pk_bf16_f32 v86, v68, v69
    v_cvt_pk_bf16_f32 v87, v70, v71
    s_xor_b32 s64, s78, 65536
    s_add_u32 s64, s64, 4194304
    buffer_store_dwordx4 v[84:87], v1, s[4:7], s64 offen sc1
    s_add_u32 m0, s72, 896
    s_nop 0
    buffer_load_dwordx4 v5, s[48:51], s71 offen offset:128 lds
    v_mfma_f32_16x16x32_bf16 v[56:59], v[24:27], a[48:51], 0
    v_mfma_f32_16x16x32_bf16 v[60:63], v[40:43], a[48:51], 0
    v_mfma_f32_16x16x32_bf16 v[56:59], v[28:31], a[52:55], v[56:59]
    v_mfma_f32_16x16x32_bf16 v[60:63], v[44:47], a[52:55], v[60:63]
    v_mfma_f32_16x16x32_bf16 v[56:59], v[32:35], a[56:59], v[56:59]
    v_mfma_f32_16x16x32_bf16 v[60:63], v[48:51], a[56:59], v[60:63]
    v_mfma_f32_16x16x32_bf16 v[56:59], v[36:39], a[60:63], v[56:59]
    v_mfma_f32_16x16x32_bf16 v[60:63], v[52:55], a[60:63], v[60:63]
    v_cvt_pk_bf16_f32 v80, v72, v73
    v_cvt_pk_bf16_f32 v81, v74, v75
    v_cvt_pk_bf16_f32 v82, v76, v77
    v_cvt_pk_bf16_f32 v83, v78, v79
    s_xor_b32 s64, s78, 524288
    s_add_u32 s64, s64, 33554432
    buffer_store_dwordx4 v[80:83], v1, s[4:7], s64 offen sc1
    s_add_u32 m0, s72, 1792
    s_nop 0
    buffer_load_dwordx4 v5, s[48:51], s71 offen offset:256 lds
    v_mfma_f32_16x16x32_bf16 v[64:67], v[24:27], a[64:67], 0
    v_mfma_f32_16x16x32_bf16 v[68:71], v[40:43], a[64:67], 0
    v_mfma_f32_16x16x32_bf16 v[64:67], v[28:31], a[68:71], v[64:67]
    v_mfma_f32_16x16x32_bf16 v[68:71], v[44:47], a[68:71], v[68:71]
    v_mfma_f32_16x16x32_bf16 v[64:67], v[32:35], a[72:75], v[64:67]
    v_mfma_f32_16x16x32_bf16 v[68:71], v[48:51], a[72:75], v[68:71]
    v_mfma_f32_16x16x32_bf16 v[64:67], v[36:39], a[76:79], v[64:67]
    v_mfma_f32_16x16x32_bf16 v[68:71], v[52:55], a[76:79], v[68:71]
    v_cvt_pk_bf16_f32 v84, v56, v57
    v_cvt_pk_bf16_f32 v85, v58, v59
    v_cvt_pk_bf16_f32 v86, v60, v61
    v_cvt_pk_bf16_f32 v87, v62, v63
    s_xor_b32 s64, s78, 589824
    s_add_u32 s64, s64, 37748736
    buffer_store_dwordx4 v[84:87], v1, s[4:7], s64 offen sc1
    s_add_u32 m0, s72, 2688
    s_nop 0
    buffer_load_dwordx4 v5, s[48:51], s71 offen offset:384 lds
    v_mfma_f32_16x16x32_bf16 v[72:75], v[24:27], a[80:83], 0
    v_mfma_f32_16x16x32_bf16 v[76:79], v[40:43], a[80:83], 0
    v_mfma_f32_16x16x32_bf16 v[72:75], v[28:31], a[84:87], v[72:75]
    v_mfma_f32_16x16x32_bf16 v[76:79], v[44:47], a[84:87], v[76:79]
    v_mfma_f32_16x16x32_bf16 v[72:75], v[32:35], a[88:91], v[72:75]
    v_mfma_f32_16x16x32_bf16 v[76:79], v[48:51], a[88:91], v[76:79]
    v_mfma_f32_16x16x32_bf16 v[72:75], v[36:39], a[92:95], v[72:75]
    v_mfma_f32_16x16x32_bf16 v[76:79], v[52:55], a[92:95], v[76:79]
    v_cvt_pk_bf16_f32 v80, v64, v65
    v_cvt_pk_bf16_f32 v81, v66, v67
    v_cvt_pk_bf16_f32 v82, v68, v69
    v_cvt_pk_bf16_f32 v83, v70, v71
    s_xor_b32 s64, s78, 1048576
    s_add_u32 s64, s64, 67108864
    buffer_store_dwordx4 v[80:83], v1, s[4:7], s64 offen sc1
    s_add_u32 m0, s72, 3584
    s_nop 0
    buffer_load_dwordx4 v5, s[48:51], s71 offen offset:512 lds
    s_add_u32 s71, s71, 40960
    s_add_u32 s62, s72, 40960
    s_sub_u32 s63, s72, 40960
    s_cmp_lt_u32 s72, 40960
    s_cselect_b32 s72, s62, s63
    v_mfma_f32_16x16x32_bf16 v[56:59], v[24:27], a[96:99], 0
    v_mfma_f32_16x16x32_bf16 v[60:63], v[40:43], a[96:99], 0
    v_mfma_f32_16x16x32_bf16 v[56:59], v[28:31], a[100:103], v[56:59]
    v_mfma_f32_16x16x32_bf16 v[60:63], v[44:47], a[100:103], v[60:63]
    v_mfma_f32_16x16x32_bf16 v[56:59], v[32:35], a[104:107], v[56:59]
    v_mfma_f32_16x16x32_bf16 v[60:63], v[48:51], a[104:107], v[60:63]
    v_mfma_f32_16x16x32_bf16 v[56:59], v[36:39], a[108:111], v[56:59]
    v_mfma_f32_16x16x32_bf16 v[60:63], v[52:55], a[108:111], v[60:63]
    v_cvt_pk_bf16_f32 v84, v72, v73
    v_cvt_pk_bf16_f32 v85, v74, v75
    v_cvt_pk_bf16_f32 v86, v76, v77
    v_cvt_pk_bf16_f32 v87, v78, v79
    s_xor_b32 s64, s78, 1114112
    s_add_u32 s64, s64, 71303168
    buffer_store_dwordx4 v[84:87], v1, s[4:7], s64 offen sc1
    v_mfma_f32_16x16x32_bf16 v[64:67], v[24:27], a[112:115], 0
    v_mfma_f32_16x16x32_bf16 v[68:71], v[40:43], a[112:115], 0
    v_mfma_f32_16x16x32_bf16 v[64:67], v[28:31], a[116:119], v[64:67]
    v_mfma_f32_16x16x32_bf16 v[68:71], v[44:47], a[116:119], v[68:71]
    v_mfma_f32_16x16x32_bf16 v[64:67], v[32:35], a[120:123], v[64:67]
    v_mfma_f32_16x16x32_bf16 v[68:71], v[48:51], a[120:123], v[68:71]
    v_mfma_f32_16x16x32_bf16 v[64:67], v[36:39], a[124:127], v[64:67]
    v_mfma_f32_16x16x32_bf16 v[68:71], v[52:55], a[124:127], v[68:71]
    v_cvt_pk_bf16_f32 v80, v56, v57
    v_cvt_pk_bf16_f32 v81, v58, v59
    v_cvt_pk_bf16_f32 v82, v60, v61
    v_cvt_pk_bf16_f32 v83, v62, v63
    s_xor_b32 s64, s78, 1572864
    s_add_u32 s64, s64, 100663296
    buffer_store_dwordx4 v[80:83], v1, s[4:7], s64 offen sc1
    v_mfma_f32_16x16x32_bf16 v[72:75], v[24:27], a[128:131], 0
    v_mfma_f32_16x16x32_bf16 v[76:79], v[40:43], a[128:131], 0
    v_mfma_f32_16x16x32_bf16 v[72:75], v[28:31], a[132:135], v[72:75]
    v_mfma_f32_16x16x32_bf16 v[76:79], v[44:47], a[132:135], v[76:79]
    v_mfma_f32_16x16x32_bf16 v[72:75], v[32:35], a[136:139], v[72:75]
    v_mfma_f32_16x16x32_bf16 v[76:79], v[48:51], a[136:139], v[76:79]
    v_mfma_f32_16x16x32_bf16 v[72:75], v[36:39], a[140:143], v[72:75]
    v_mfma_f32_16x16x32_bf16 v[76:79], v[52:55], a[140:143], v[76:79]
    v_cvt_pk_bf16_f32 v84, v64, v65
    v_cvt_pk_bf16_f32 v85, v66, v67
    v_cvt_pk_bf16_f32 v86, v68, v69
    v_cvt_pk_bf16_f32 v87, v70, v71
    s_xor_b32 s64, s78, 1638400
    s_add_u32 s64, s64, 104857600
    buffer_store_dwordx4 v[84:87], v1, s[4:7], s64 offen sc1
    v_mfma_f32_16x16x32_bf16 v[56:59], v[24:27], a[144:147], 0
    v_mfma_f32_16x16x32_bf16 v[60:63], v[40:43], a[144:147], 0
    v_mfma_f32_16x16x32_bf16 v[56:59], v[28:31], a[148:151], v[56:59]
    v_mfma_f32_16x16x32_bf16 v[60:63], v[44:47], a[148:151], v[60:63]
    v_mfma_f32_16x16x32_bf16 v[56:59], v[32:35], a[152:155], v[56:59]
    v_mfma_f32_16x16x32_bf16 v[60:63], v[48:51], a[152:155], v[60:63]
    v_mfma_f32_16x16x32_bf16 v[56:59], v[36:39], a[156:159], v[56:59]
    v_mfma_f32_16x16x32_bf16 v[60:63], v[52:55], a[156:159], v[60:63]
    v_cvt_pk_bf16_f32 v80, v72, v73
    v_cvt_pk_bf16_f32 v81, v74, v75
    v_cvt_pk_bf16_f32 v82, v76, v77
    v_cvt_pk_bf16_f32 v83, v78, v79
    s_xor_b32 s64, s78, 0
    s_add_u32 s64, s64, 134217728
    buffer_store_dwordx4 v[80:83], v1, s[4:7], s64 offen sc1
    v_cvt_pk_bf16_f32 v84, v56, v57
    v_cvt_pk_bf16_f32 v85, v58, v59
    v_cvt_pk_bf16_f32 v86, v60, v61
    v_cvt_pk_bf16_f32 v87, v62, v63
    s_xor_b32 s64, s78, 65536
    s_add_u32 s64, s64, 138412032
    buffer_store_dwordx4 v[84:87], v1, s[4:7], s64 offen sc1
    s_add_u32 s60, s60, 1
    s_cmp_le_u32 s60, 64
    s_cbranch_scc1 L_VOX_hi_loop
    s_waitcnt vmcnt(0)
    s_barrier
    s_branch L_end
L_FF1:
    s_lshl_b32 s62, s55, 1
    s_add_u32 s62, s62, s56
    s_lshl_b32 s62, s62, 7
    s_add_u32 s90, s62, 2383872
    s_waitcnt vmcnt(0)
    s_barrier
    s_or_b32 s62, s52, s30
    s_cbranch_scc1 Lci_181
    s_lshl_b32 s62, 1, s54
    s_lshl_b32 s63, s53, 5
    v_mov_b32 v20, s62
    v_mov_b32 v14, s63
    s_mov_b64 exec, 1
    buffer_atomic_or v20, v14, s[8:11], 0 offen sc0
    s_mov_b64 exec, -1
Lci_181:
    s_waitcnt vmcnt(0)
    v_min_u32 v15, 7, v0
    v_lshlrev_b32 v15, 5, v15
    s_cmp_lg_u32 s52, 0
    s_cbranch_scc1 Lwid_183
    s_mov_b32 s64, 0
    s_cmp_lg_u32 s30, 0
    s_cbranch_scc1 Lwok_184
    s_waitcnt vmcnt(0)
    v_readfirstlane_b32 s62, v20
    s_nop 0
    s_lshr_b32 s62, s62, s54
    s_and_b32 s64, s62, 1
Lwok_184:
    v_mov_b32 v14, 163832
    v_mov_b32 v20, s64
    ds_write_b32 v14, v20
    s_waitcnt lgkmcnt(0)
    s_cmp_lg_u32 s64, 0
    s_cbranch_scc1 Lwid_183
    s_mov_b32 s89, s59
Lwi_182:
    s_sleep 64
    buffer_load_dword v14, v15, s[8:11], 0 offen sc1
    s_waitcnt vmcnt(0)
    v_cmp_ne_u32 vcc, -1, v14
    s_cbranch_vccz Lwid_183
    s_sub_u32 s89, s89, 8
    s_cbranch_scc0 Lwi_182
    s_mov_b32 s59, 0
Lwid_183:
    s_barrier
    buffer_load_dword v14, v15, s[8:11], 0 offen offset:4 sc1
    v_mov_b32 v15, 163832
    ds_read_b32 v15, v15
    s_waitcnt vmcnt(0) lgkmcnt(0)
    v_readfirstlane_b32 s62, v15
    s_nop 0
    s_cmp_lg_u32 s62, 0
    s_cbranch_scc1 L_reclaim
    v_readlane_b32 s62, v14, 1
    v_readlane_b32 s63, v14, 2
    v_readlane_b32 s61, v14, 3
    s_cmp_gt_u32 s63, s62
    s_cselect_b32 s46, 0x2000, 0
    s_cmp_lg_u32 s52, 0
    s_cbranch_scc1 Lls_185
    v_mov_b32 v15, 2359296
    s_mov_b32 s64, 1
    s_mov_b32 s89, s59
Lsp_186:
    buffer_load_dword v14, v15, s[4:7], 0 offen sc1
    s_waitcnt vmcnt(0)
    v_cmp_gt_u32 vcc, s64, v14
    s_cbranch_vccz Lspd_187
    s_sleep 16
    s_sub_u32 s89, s89, 1
    s_cbranch_scc0 Lsp_186
    s_mov_b32 s59, 0
Lspd_187:
Lls_185:
    s_barrier
    v_lshrrev_b32 v14, 4, v0
    v_bfe_u32 v10, v0, 1, 3
    v_xor_b32 v10, v10, v14
    v_lshlrev_b32 v10, 5, v10
    v_and_b32 v14, 1, v0
    v_lshl_add_u32 v10, v14, 4, v10
    v_lshrrev_b32 v14, 4, v0
    v_mul_u32_u24 v14, 3456, v14
    v_add_u32 v10, v10, v14
    v_lshrrev_b32 v14, 4, v0
    v_or_b32 v14, 4, v14
    v_bfe_u32 v11, v0, 1, 3
    v_xor_b32 v11, v11, v14
    v_lshlrev_b32 v11, 5, v11
    v_and_b32 v14, 1, v0
    v_lshl_add_u32 v11, v14, 4, v11
    v_lshrrev_b32 v14, 4, v0
    v_mul_u32_u24 v14, 3456, v14
    v_add_u32 v11, v11, v14
    v_bfe_u32 v12, v0, 2, 3
    v_xor_b32 v12, s52, v12
    v_lshlrev_b32 v12, 5, v12
    v_and_b32 v14, 3, v0
    v_lshl_add_u32 v12, v14, 3, v12
    v_bfe_u32 v14, v0, 2, 2
    v_lshl_add_u32 v12, v14, 8, v12
    v_lshrrev_b32 v14, 4, v0
    v_lshl_add_u32 v12, v14, 11, v12
    s_mov_b32 s12, s32
    s_and_b32 s13, s33, 0xffff
    s_mov_b32 s14, 2211840
    s_mov_b32 s15, 0x00020000
    s_lshl_b32 s62, s52, 4
    s_add_u32 s62, s62, 0
    s_mul_i32 s62, s62, 3456
    s_mul_i32 s63, s55, 256
    s_add_u32 s62, s62, s63
    s_lshl_b32 s63, s52, 12
    s_add_u32 s63, s63, 65536
    s_mov_b32 m0, s63
    s_nop 0
    buffer_load_dwordx4 v10, s[12:15], s62 offen lds
    s_add_u32 s62, s62, 13824
    s_add_u32 s63, s63, 1024
    s_mov_b32 m0, s63
    s_nop 0
    buffer_load_dwordx4 v10, s[12:15], s62 offen lds
    s_add_u32 s62, s62, 13824
    s_add_u32 s63, s63, 1024
    s_mov_b32 m0, s63
    s_nop 0
    buffer_load_dwordx4 v11, s[12:15], s62 offen lds
    s_add_u32 s62, s62, 13824
    s_add_u32 s63, s63, 1024
    s_mov_b32 m0, s63
    s_nop 0
    buffer_load_dwordx4 v11, s[12:15], s62 offen lds
    s_lshl_b32 s62, s52, 4
    s_add_u32 s62, s62, 128
    s_mul_i32 s62, s62, 3456
    s_mul_i32 s63, s55, 256
    s_add_u32 s62, s62, s63
    s_lshl_b32 s63, s52, 12
    s_add_u32 s63, s63, 98304
    s_mov_b32 m0, s63
    s_nop 0
    buffer_load_dwordx4 v10, s[12:15], s62 offen lds
    s_add_u32 s62, s62, 13824
    s_add_u32 s63, s63, 1024
    s_mov_b32 m0, s63
    s_nop 0
    buffer_load_dwordx4 v10, s[12:15], s62 offen lds
    s_add_u32 s62, s62, 13824
    s_add_u32 s63, s63, 1024
    s_mov_b32 m0, s63
    s_nop 0
    buffer_load_dwordx4 v11, s[12:15], s62 offen lds
    s_add_u32 s62, s62, 13824
    s_add_u32 s63, s63, 1024
    s_mov_b32 m0, s63
    s_nop 0
    buffer_load_dwordx4 v11, s[12:15], s62 offen lds
    s_lshl_b32 s62, s52, 4
    s_add_u32 s62, s62, 256
    s_mul_i32 s62, s62, 3456
    s_mul_i32 s63, s55, 256
    s_add_u32 s62, s62, s63
    s_lshl_b32 s63, s52, 12
    s_add_u32 s63, s63, 131072
    s_mov_b32 m0, s63
    s_nop 0
    buffer_load_dwordx4 v10, s[12:15], s62 offen lds
    s_add_u32 s62, s62, 13824
    s_add_u32 s63, s63, 1024
    s_mov_b32 m0, s63
    s_nop 0
    buffer_load_dwordx4 v10, s[12:15], s62 offen lds
    s_add_u32 s62, s62, 13824
    s_add_u32 s63, s63, 1024
    s_mov_b32 m0, s63
    s_nop 0
    buffer_load_dwordx4 v11, s[12:15], s62 offen lds
    s_add_u32 s62, s62, 13824
    s_add_u32 s63, s63, 1024
    s_mov_b32 m0, s63
    s_nop 0
    buffer_load_dwordx4 v11, s[12:15], s62 offen lds
    s_waitcnt vmcnt(8)
    s_barrier
    v_add_u32 v13, 65536, v12
    ds_read_b64_tr_b16 a[0:1], v13 offset:0
    ds_read_b64_tr_b16 a[2:3], v13 offset:1024
    ds_read_b64_tr_b16 a[4:5], v13 offset:8192
    ds_read_b64_tr_b16 a[6:7], v13 offset:9216
    ds_read_b64_tr_b16 a[8:9], v13 offset:16384
    ds_read_b64_tr_b16 a[10:11], v13 offset:17408
    ds_read_b64_tr_b16 a[12:13], v13 offset:24576
    ds_read_b64_tr_b16 a[14:15], v13 offset:25600
    s_waitcnt lgkmcnt(0)
    s_barrier
    s_lshl_b32 s62, s52, 4
    s_add_u32 s62, s62, 384
    s_mul_i32 s62, s62, 3456
    s_mul_i32 s63, s55, 256
    s_add_u32 s62, s62, s63
    s_lshl_b32 s63, s52, 12
    s_add_u32 s63, s63, 65536
    s_mov_b32 m0, s63
    s_nop 0
    buffer_load_dwordx4 v10, s[12:15], s62 offen lds
    s_add_u32 s62, s62, 13824
    s_add_u32 s63, s63, 1024
    s_mov_b32 m0, s63
    s_nop 0
    buffer_load_dwordx4 v10, s[12:15], s62 offen lds
    s_add_u32 s62, s62, 13824
    s_add_u32 s63, s63, 1024
    s_mov_b32 m0, s63
    s_nop 0
    buffer_load_dwordx4 v11, s[12:15], s62 offen lds
    s_add_u32 s62, s62, 13824
    s_add_u32 s63, s63, 1024
    s_mov_b32 m0, s63
    s_nop 0
    buffer_load_dwordx4 v11, s[12:15], s62 offen lds
    s_waitcnt vmcnt(8)
    s_barrier
    v_add_u32 v13, 98304, v12
    ds_read_b64_tr_b16 a[16:17], v13 offset:0
    ds_read_b64_tr_b16 a[18:19], v13 offset:1024
    ds_read_b64_tr_b16 a[20:21], v13 offset:8192
    ds_read_b64_tr_b16 a[22:23], v13 offset:9216
    ds_read_b64_tr_b16 a[24:25], v13 offset:16384
    ds_read_b64_tr_b16 a[26:27], v13 offset:17408
    ds_read_b64_tr_b16 a[28:29], v13 offset:24576
    ds_read_b64_tr_b16 a[30:31], v13 offset:25600
    s_waitcnt lgkmcnt(0)
    s_barrier
    s_lshl_b32 s62, s52, 4
    s_add_u32 s62, s62, 512
    s_mul_i32 s62, s62, 3456
    s_mul_i32 s63, s55, 256
    s_add_u32 s62, s62, s63
    s_lshl_b32 s63, s52, 12
    s_add_u32 s63, s63, 98304
    s_mov_b32 m0, s63
    s_nop 0
    buffer_load_dwordx4 v10, s[12:15], s62 offen lds
    s_add_u32 s62, s62, 13824
    s_add_u32 s63, s63, 1024
    s_mov_b32 m0, s63
    s_nop 0
    buffer_load_dwordx4 v10, s[12:15], s62 offen lds
    s_add_u32 s62, s62, 13824
    s_add_u32 s63, s63, 1024
    s_mov_b32 m0, s63
    s_nop 0
    buffer_load_dwordx4 v11, s[12:15], s62 offen lds
    s_add_u32 s62, s62, 13824
    s_add_u32 s63, s63, 1024
    s_mov_b32 m0, s63
    s_nop 0
    buffer_load_dwordx4 v11, s[12:15], s62 offen lds
    s_waitcnt vmcnt(8)
    s_barrier
    v_add_u32 v13, 131072, v12
    ds_read_b64_tr_b16 a[32:33], v13 offset:0
    ds_read_b64_tr_b16 a[34:35], v13 offset:1024
    ds_read_b64_tr_b16 a[36:37], v13 offset:8192
    ds_read_b64_tr_b16 a[38:39], v13 offset:9216
    ds_read_b64_tr_b16 a[40:41], v13 offset:16384
    ds_read_b64_tr_b16 a[42:43], v13 offset:17408
    ds_read_b64_tr_b16 a[44:45], v13 offset:24576
    ds_read_b64_tr_b16 a[46:47], v13 offset:25600
    s_waitcnt lgkmcnt(0)
    s_barrier
    s_mov_b32 s12, s34
    s_and_b32 s13, s35, 0xffff
    s_mov_b32 s14, 2211840
    s_mov_b32 s15, 0x00020000
    s_lshl_b32 s62, s52, 4
    s_add_u32 s62, s62, 0
    s_mul_i32 s62, s62, 3456
    s_mul_i32 s63, s55, 256
    s_add_u32 s62, s62, s63
    s_lshl_b32 s63, s52, 12
    s_add_u32 s63, s63, 131072
    s_mov_b32 m0, s63
    s_nop 0
    buffer_load_dwordx4 v10, s[12:15], s62 offen lds
    s_add_u32 s62, s62, 13824
    s_add_u32 s63, s63, 1024
    s_mov_b32 m0, s63
    s_nop 0
    buffer_load_dwordx4 v10, s[12:15], s62 offen lds
    s_add_u32 s62, s62, 13824
    s_add_u32 s63, s63, 1024
    s_mov_b32 m0, s63
    s_nop 0
    buffer_load_dwordx4 v11, s[12:15], s62 offen lds
    s_add_u32 s62, s62, 13824
    s_add_u32 s63, s63, 1024
    s_mov_b32 m0, s63
    s_nop 0
    buffer_load_dwordx4 v11, s[12:15], s62 offen lds
    s_waitcnt vmcnt(8)
    s_barrier
    v_add_u32 v13, 65536, v12
    ds_read_b64_tr_b16 a[48:49], v13 offset:0
    ds_read_b64_tr_b16 a[50:51], v13 offset:1024
    ds_read_b64_tr_b16 a[52:53], v13 offset:8192
    ds_read_b64_tr_b16 a[54:55], v13 offset:9216
    ds_read_b64_tr_b16 a[56:57], v13 offset:16384
    ds_read_b64_tr_b16 a[58:59], v13 offset:17408
    ds_read_b64_tr_b16 a[60:61], v13 offset:24576
    ds_read_b64_tr_b16 a[62:63], v13 offset:25600
    s_waitcnt lgkmcnt(0)
    s_barrier
    s_lshl_b32 s62, s52, 4
    s_add_u32 s62, s62, 128
    s_mul_i32 s62, s62, 3456
    s_mul_i32 s63, s55, 256
    s_add_u32 s62, s62, s63
    s_lshl_b32 s63, s52, 12
    s_add_u32 s63, s63, 65536
    s_mov_b32 m0, s63
    s_nop 0
    buffer_load_dwordx4 v10, s[12:15], s62 offen lds
    s_add_u32 s62, s62, 13824
    s_add_u32 s63, s63, 1024
    s_mov_b32 m0, s63
    s_nop 0
    buffer_load_dwordx4 v10, s[12:15], s62 offen lds
    s_add_u32 s62, s62, 13824
    s_add_u32 s63, s63, 1024
    s_mov_b32 m0, s63
    s_nop 0
    buffer_load_dwordx4 v11, s[12:15], s62 offen lds
    s_add_u32 s62, s62, 13824
    s_add_u32 s63, s63, 1024
    s_mov_b32 m0, s63
    s_nop 0
    buffer_load_dwordx4 v11, s[12:15], s62 offen lds
    s_waitcnt vmcnt(8)
    s_barrier
    v_add_u32 v13, 98304, v12
    ds_read_b64_tr_b16 a[64:65], v13 offset:0
    ds_read_b64_tr_b16 a[66:67], v13 offset:1024
    ds_read_b64_tr_b16 a[68:69], v13 offset:8192
    ds_read_b64_tr_b16 a[70:71], v13 offset:9216
    ds_read_b64_tr_b16 a[72:73], v13 offset:16384
    ds_read_b64_tr_b16 a[74:75], v13 offset:17408
    ds_read_b64_tr_b16 a[76:77], v13 offset:24576
    ds_read_b64_tr_b16 a[78:79], v13 offset:25600
    s_waitcnt lgkmcnt(0)
    s_barrier
    s_lshl_b32 s62, s52, 4
    s_add_u32 s62, s62, 256
    s_mul_i32 s62, s62, 3456
    s_mul_i32 s63, s55, 256
    s_add_u32 s62, s62, s63
    s_lshl_b32 s63, s52, 12
    s_add_u32 s63, s63, 98304
    s_mov_b32 m0, s63
    s_nop 0
    buffer_load_dwordx4 v10, s[12:15], s62 offen lds
    s_add_u32 s62, s62, 13824
    s_add_u32 s63, s63, 1024
    s_mov_b32 m0, s63
    s_nop 0
    buffer_load_dwordx4 v10, s[12:15], s62 offen lds
    s_add_u32 s62, s62, 13824
    s_add_u32 s63, s63, 1024
    s_mov_b32 m0, s63
    s_nop 0
    buffer_load_dwordx4 v11, s[12:15], s62 offen lds
    s_add_u32 s62, s62, 13824
    s_add_u32 s63, s63, 1024
    s_mov_b32 m0, s63
    s_nop 0
    buffer_load_dwordx4 v11, s[12:15], s62 offen lds
    s_waitcnt vmcnt(8)
    s_barrier
    v_add_u32 v13, 131072, v12
    ds_read_b64_tr_b16 a[80:81], v13 offset:0
    ds_read_b64_tr_b16 a[82:83], v13 offset:1024
    ds_read_b64_tr_b16 a[84:85], v13 offset:8192
    ds_read_b64_tr_b16 a[86:87], v13 offset:9216
    ds_read_b64_tr_b16 a[88:89], v13 offset:16384
    ds_read_b64_tr_b16 a[90:91], v13 offset:17408
    ds_read_b64_tr_b16 a[92:93], v13 offset:24576
    ds_read_b64_tr_b16 a[94:95], v13 offset:25600
    s_waitcnt lgkmcnt(0)
    s_barrier
    s_lshl_b32 s62, s52, 4
    s_add_u32 s62, s62, 384
    s_mul_i32 s62, s62, 3456
    s_mul_i32 s63, s55, 256
    s_add_u32 s62, s62, s63
    s_lshl_b32 s63, s52, 12
    s_add_u32 s63, s63, 131072
    s_mov_b32 m0, s63
    s_nop 0
    buffer_load_dwordx4 v10, s[12:15], s62 offen lds
    s_add_u32 s62, s62, 13824
    s_add_u32 s63, s63, 1024
    s_mov_b32 m0, s63
    s_nop 0
    buffer_load_dwordx4 v10, s[12:15], s62 offen lds
    s_add_u32 s62, s62, 13824
    s_add_u32 s63, s63, 1024
    s_mov_b32 m0, s63
    s_nop 0
    buffer_load_dwordx4 v11, s[12:15], s62 offen lds
    s_add_u32 s62, s62, 13824
    s_add_u32 s63, s63, 1024
    s_mov_b32 m0, s63
    s_nop 0
    buffer_load_dwordx4 v11, s[12:15], s62 offen lds
    s_waitcnt vmcnt(8)
    s_barrier
    v_add_u32 v13, 65536, v12
    ds_read_b64_tr_b16 a[96:97], v13 offset:0
    ds_read_b64_tr_b16 a[98:99], v13 offset:1024
    ds_read_b64_tr_b16 a[100:101], v13 offset:8192
    ds_read_b64_tr_b16 a[102:103], v13 offset:9216
    ds_read_b64_tr_b16 a[104:105], v13 offset:16384
    ds_read_b64_tr_b16 a[106:107], v13 offset:17408
    ds_read_b64_tr_b16 a[108:109], v13 offset:24576
    ds_read_b64_tr_b16 a[110:111], v13 offset:25600
    s_waitcnt lgkmcnt(0)
    s_barrier
    s_lshl_b32 s62, s52, 4
    s_add_u32 s62, s62, 512
    s_mul_i32 s62, s62, 3456
    s_mul_i32 s63, s55, 256
    s_add_u32 s62, s62, s63
    s_lshl_b32 s63, s52, 12
    s_add_u32 s63, s63, 65536
    s_mov_b32 m0, s63
    s_nop 0
    buffer_load_dwordx4 v10, s[12:15], s62 offen lds
    s_add_u32 s62, s62, 13824
    s_add_u32 s63, s63, 1024
    s_mov_b32 m0, s63
    s_nop 0
    buffer_load_dwordx4 v10, s[12:15], s62 offen lds
    s_add_u32 s62, s62, 13824
    s_add_u32 s63, s63, 1024
    s_mov_b32 m0, s63
    s_nop 0
    buffer_load_dwordx4 v11, s[12:15], s62 offen lds
    s_add_u32 s62, s62, 13824
    s_add_u32 s63, s63, 1024
    s_mov_b32 m0, s63
    s_nop 0
    buffer_load_dwordx4 v11, s[12:15], s62 offen lds
    s_waitcnt vmcnt(8)
    s_barrier
    v_add_u32 v13, 98304, v12
    ds_read_b64_tr_b16 a[112:113], v13 offset:0
    ds_read_b64_tr_b16 a[114:115], v13 offset:1024
    ds_read_b64_tr_b16 a[116:117], v13 offset:8192
    ds_read_b64_tr_b16 a[118:119], v13 offset:9216
    ds_read_b64_tr_b16 a[120:121], v13 offset:16384
    ds_read_b64_tr_b16 a[122:123], v13 offset:17408
    ds_read_b64_tr_b16 a[124:125], v13 offset:24576
    ds_read_b64_tr_b16 a[126:127], v13 offset:25600
    s_waitcnt lgkmcnt(0)
    s_waitcnt vmcnt(4)
    s_barrier
    v_add_u32 v13, 131072, v12
    ds_read_b64_tr_b16 a[128:129], v13 offset:0
    ds_read_b64_tr_b16 a[130:131], v13 offset:1024
    ds_read_b64_tr_b16 a[132:133], v13 offset:8192
    ds_read_b64_tr_b16 a[134:135], v13 offset:9216
    ds_read_b64_tr_b16 a[136:137], v13 offset:16384
    ds_read_b64_tr_b16 a[138:139], v13 offset:17408
    ds_read_b64_tr_b16 a[140:141], v13 offset:24576
    ds_read_b64_tr_b16 a[142:143], v13 offset:25600
    s_waitcnt lgkmcnt(0)
    s_waitcnt vmcnt(0)
    s_barrier
    v_add_u32 v13, 65536, v12
    ds_read_b64_tr_b16 a[144:145], v13 offset:0
    ds_read_b64_tr_b16 a[146:147], v13 offset:1024
    ds_read_b64_tr_b16 a[148:149], v13 offset:8192
    ds_read_b64_tr_b16 a[150:151], v13 offset:9216
    ds_read_b64_tr_b16 a[152:153], v13 offset:16384
    ds_read_b64_tr_b16 a[154:155], v13 offset:17408
    ds_read_b64_tr_b16 a[156:157], v13 offset:24576
    ds_read_b64_tr_b16 a[158:159], v13 offset:25600
    s_waitcnt lgkmcnt(0)
    s_barrier
    s_mov_b32 s48, s16
    s_and_b32 s49, s17, 0xffff
    s_mov_b32 s50, 2621440
    s_mov_b32 s51, 0x00020000
    v_lshrrev_b32 v12, 3, v0
    v_and_b32 v6, 7, v0
    v_xor_b32 v6, v6, v12
    v_lshlrev_b32 v6, 4, v6
    v_mul_u32_u24 v12, 1280, v12
    v_add_u32 v6, v6, v12
    s_lshr_b32 s62, s52, 1
    s_mul_i32 s62, s62, 10240
    s_and_b32 s63, s52, 1
    s_mul_i32 s63, s63, 640
    s_add_u32 s71, s62, s63
    s_mul_i32 s62, s56, 40960
    s_add_u32 s71, s71, s62
    s_mul_i32 s72, s52, 5120
    s_add_u32 s72, s72, 0
    v_lshrrev_b32 v2, 4, v0
    v_and_b32 v12, 7, v0
    v_xor_b32 v2, v2, v12
    v_lshlrev_b32 v2, 4, v2
    v_lshl_add_u32 v2, v12, 7, v2
    v_bfe_u32 v12, v0, 3, 1
    v_mul_u32_u24 v12, 10240, v12
    v_add_u32 v2, v2, v12
    v_add_u32 v2, 0, v2
    v_xor_b32 v3, 64, v2
    s_add_u32 m0, s72, 0
    s_nop 0
    buffer_load_dwordx4 v6, s[48:51], s71 offen offset:0 lds
    s_add_u32 m0, s72, 896
    s_nop 0
    buffer_load_dwordx4 v6, s[48:51], s71 offen offset:128 lds
    s_add_u32 m0, s72, 1792
    s_nop 0
    buffer_load_dwordx4 v6, s[48:51], s71 offen offset:256 lds
    s_add_u32 m0, s72, 2688
    s_nop 0
    buffer_load_dwordx4 v6, s[48:51], s71 offen offset:384 lds
    s_add_u32 m0, s72, 3584
    s_nop 0
    buffer_load_dwordx4 v6, s[48:51], s71 offen offset:512 lds
    s_add_u32 s71, s71, 81920
    s_add_u32 s62, s72, 40960
    s_sub_u32 s63, s72, 40960
    s_cmp_lt_u32 s72, 40960
    s_cselect_b32 s72, s62, s63
    v_and_b32 v8, 31, v0
    v_lshlrev_b32 v8, 7, v8
    v_add_u32 v8, 2387968, v8
    s_mov_b32 s64, 1
    s_mov_b32 s89, s59
Lsp_188:
    buffer_load_dword v12, v8, s[4:7], 0 offen sc1
    s_waitcnt vmcnt(0)
    v_cmp_gt_u32 vcc, s64, v12
    s_cbranch_vccz Lspd_189
    s_sleep 4
    s_sub_u32 s89, s89, 1
    s_cbranch_scc0 Lsp_188
    s_mov_b32 s59, 0
Lspd_189:
    v_lshlrev_b32 v1, 4, v0
    v_mov_b32 v9, s90
    v_and_b32 v8, 15, v0
    v_lshlrev_b32 v8, 2, v8
    s_lshl_b32 s79, s56, 7
    s_add_u32 s79, s79, 2293760
    s_lshl_b32 s62, s55, 3
    s_add_u32 s62, s62, s52
    s_lshl_b32 s78, s62, 10
    s_mul_i32 s63, s56, 114688
    s_add_u32 s78, s78, s63
    s_add_u32 s78, s78, 251658240
    s_mov_b32 s60, 0
L_FF1_loop:
    s_waitcnt vmcnt(1)
    s_barrier
    s_max_u32 s64, s60, 1
    s_sub_u32 s64, s64, 1
    s_cmp_lg_u32 s52, 0
    s_cbranch_scc1 Lfs_190
    v_mov_b32 v13, s64
    s_mov_b64 exec, 1
    buffer_store_dword v13, v9, s[4:7], 0 offen sc1
    s_mov_b64 exec, -1
Lfs_190:
    ds_read_b128 v[16:19], v2 offset:0
    ds_read_b128 v[20:23], v2 offset:20480
    ds_read_b128 v[24:27], v3 offset:0
    ds_read_b128 v[28:31], v3 offset:20480
    ds_read_b128 v[32:35], v2 offset:1024
    ds_read_b128 v[36:39], v2 offset:21504
    ds_read_b128 v[40:43], v3 offset:1024
    ds_read_b128 v[44:47], v3 offset:21504
    s_waitcnt lgkmcnt(6)
    v_mfma_f32_16x16x32_bf16 v[48:51], a[0:3], v[16:19], 0
    v_mfma_f32_16x16x32_bf16 v[56:59], a[80:83], v[16:19], 0
    v_mfma_f32_16x16x32_bf16 v[52:55], a[0:3], v[20:23], 0
    v_mfma_f32_16x16x32_bf16 v[60:63], a[80:83], v[20:23], 0
    buffer_load_dword v4, v8, s[4:7], s79 offen sc1
    buffer_load_dword v5, v8, s[4:7], s79 offen offset:64 sc1
    s_add_u32 s79, s79, 256
    ds_read_b128 v[16:19], v2 offset:2048
    ds_read_b128 v[20:23], v2 offset:22528
    s_waitcnt lgkmcnt(6)
    v_mfma_f32_16x16x32_bf16 v[48:51], a[4:7], v[24:27], v[48:51]
    v_mfma_f32_16x16x32_bf16 v[56:59], a[84:87], v[24:27], v[56:59]
    v_mfma_f32_16x16x32_bf16 v[52:55], a[4:7], v[28:31], v[52:55]
    v_mfma_f32_16x16x32_bf16 v[60:63], a[84:87], v[28:31], v[60:63]
    ds_read_b128 v[24:27], v3 offset:2048
    ds_read_b128 v[28:31], v3 offset:22528
    s_waitcnt lgkmcnt(6)
    v_mfma_f32_16x16x32_bf16 v[48:51], a[8:11], v[32:35], v[48:51]
    v_mfma_f32_16x16x32_bf16 v[56:59], a[88:91], v[32:35], v[56:59]
    v_mfma_f32_16x16x32_bf16 v[52:55], a[8:11], v[36:39], v[52:55]
    v_mfma_f32_16x16x32_bf16 v[60:63], a[88:91], v[36:39], v[60:63]
    s_add_u32 m0, s72, 0
    s_nop 0
    buffer_load_dwordx4 v6, s[48:51], s71 offen offset:0 lds
    ds_read_b128 v[32:35], v2 offset:3072
    ds_read_b128 v[36:39], v2 offset:23552
    s_waitcnt lgkmcnt(6)
    v_mfma_f32_16x16x32_bf16 v[48:51], a[12:15], v[40:43], v[48:51]
    v_mfma_f32_16x16x32_bf16 v[56:59], a[92:95], v[40:43], v[56:59]
    v_mfma_f32_16x16x32_bf16 v[52:55], a[12:15], v[44:47], v[52:55]
    v_mfma_f32_16x16x32_bf16 v[60:63], a[92:95], v[44:47], v[60:63]
    ds_read_b128 v[40:43], v3 offset:3072
    ds_read_b128 v[44:47], v3 offset:23552
    s_waitcnt lgkmcnt(6)
    v_mfma_f32_16x16x32_bf16 v[48:51], a[16:19], v[16:19], v[48:51]
    v_mfma_f32_16x16x32_bf16 v[56:59], a[96:99], v[16:19], v[56:59]
    v_mfma_f32_16x16x32_bf16 v[52:55], a[16:19], v[20:23], v[52:55]
    v_mfma_f32_16x16x32_bf16 v[60:63], a[96:99], v[20:23], v[60:63]
    ds_read_b128 v[16:19], v2 offset:4096
    ds_read_b128 v[20:23], v2 offset:24576
    s_waitcnt lgkmcnt(6)
    v_mfma_f32_16x16x32_bf16 v[48:51], a[20:23], v[24:27], v[48:51]
    v_mfma_f32_16x16x32_bf16 v[56:59], a[100:103], v[24:27], v[56:59]
    v_mfma_f32_16x16x32_bf16 v[52:55], a[20:23], v[28:31], v[52:55]
    v_mfma_f32_16x16x32_bf16 v[60:63], a[100:103], v[28:31], v[60:63]
    s_add_u32 m0, s72, 896
    s_nop 0
    buffer_load_dwordx4 v6, s[48:51], s71 offen offset:128 lds
    ds_read_b128 v[24:27], v3 offset:4096
    ds_read_b128 v[28:31], v3 offset:24576
    s_waitcnt lgkmcnt(6)
    v_mfma_f32_16x16x32_bf16 v[48:51], a[24:27], v[32:35], v[48:51]
    v_mfma_f32_16x16x32_bf16 v[56:59], a[104:107], v[32:35], v[56:59]
    v_mfma_f32_16x16x32_bf16 v[52:55], a[24:27], v[36:39], v[52:55]
    v_mfma_f32_16x16x32_bf16 v[60:63], a[104:107], v[36:39], v[60:63]
    ds_read_b128 v[32:35], v2 offset:5120
    ds_read_b128 v[36:39], v2 offset:25600
    s_waitcnt lgkmcnt(6)
    v_mfma_f32_16x16x32_bf16 v[48:51], a[28:31], v[40:43], v[48:51]
    v_mfma_f32_16x16x32_bf16 v[56:59], a[108:111], v[40:43], v[56:59]
    v_mfma_f32_16x16x32_bf16 v[52:55], a[28:31], v[44:47], v[52:55]
    v_mfma_f32_16x16x32_bf16 v[60:63], a[108:111], v[44:47], v[60:63]
    ds_read_b128 v[40:43], v3 offset:5120
    ds_read_b128 v[44:47], v3 offset:25600
    s_waitcnt lgkmcnt(6)
    v_mfma_f32_16x16x32_bf16 v[48:51], a[32:35], v[16:19], v[48:51]
    v_mfma_f32_16x16x32_bf16 v[56:59], a[112:115], v[16:19], v[56:59]
    v_mfma_f32_16x16x32_bf16 v[52:55], a[32:35], v[20:23], v[52:55]
    v_mfma_f32_16x16x32_bf16 v[60:63], a[112:115], v[20:23], v[60:63]
    s_add_u32 m0, s72, 1792
    s_nop 0
    buffer_load_dwordx4 v6, s[48:51], s71 offen offset:256 lds
    ds_read_b128 v[16:19], v2 offset:6144
    ds_read_b128 v[20:23], v2 offset:26624
    s_waitcnt lgkmcnt(6)
    v_mfma_f32_16x16x32_bf16 v[48:51], a[36:39], v[24:27], v[48:51]
    v_mfma_f32_16x16x32_bf16 v[56:59], a[116:119], v[24:27], v[56:59]
    v_mfma_f32_16x16x32_bf16 v[52:55], a[36:39], v[28:31], v[52:55]
    v_mfma_f32_16x16x32_bf16 v[60:63], a[116:119], v[28:31], v[60:63]
    ds_read_b128 v[24:27], v3 offset:6144
    ds_read_b128 v[28:31], v3 offset:26624
    s_waitcnt lgkmcnt(6)
    v_mfma_f32_16x16x32_bf16 v[48:51], a[40:43], v[32:35], v[48:51]
    v_mfma_f32_16x16x32_bf16 v[56:59], a[120:123], v[32:35], v[56:59]
    v_mfma_f32_16x16x32_bf16 v[52:55], a[40:43], v[36:39], v[52:55]
    v_mfma_f32_16x16x32_bf16 v[60:63], a[120:123], v[36:39], v[60:63]
    ds_read_b128 v[32:35], v2 offset:7168
    ds_read_b128 v[36:39], v2 offset:27648
    s_waitcnt lgkmcnt(6)
    v_mfma_f32_16x16x32_bf16 v[48:51], a[44:47], v[40:43], v[48:51]
    v_mfma_f32_16x16x32_bf16 v[56:59], a[124:127], v[40:43], v[56:59]
    v_mfma_f32_16x16x32_bf16 v[52:55], a[44:47], v[44:47], v[52:55]
    v_mfma_f32_16x16x32_bf16 v[60:63], a[124:127], v[44:47], v[60:63]
    s_add_u32 m0, s72, 2688
    s_nop 0
    buffer_load_dwordx4 v6, s[48:51], s71 offen offset:384 lds
    ds_read_b128 v[40:43], v3 offset:7168
    ds_read_b128 v[44:47], v3 offset:27648
    s_waitcnt lgkmcnt(6)
    v_mfma_f32_16x16x32_bf16 v[48:51], a[48:51], v[16:19], v[48:51]
    v_mfma_f32_16x16x32_bf16 v[56:59], a[128:131], v[16:19], v[56:59]
    v_mfma_f32_16x16x32_bf16 v[52:55], a[48:51], v[20:23], v[52:55]
    v_mfma_f32_16x16x32_bf16 v[60:63], a[128:131], v[20:23], v[60:63]
    ds_read_b128 v[16:19], v2 offset:8192
    ds_read_b128 v[20:23], v2 offset:28672
    s_waitcnt lgkmcnt(6)
    v_mfma_f32_16x16x32_bf16 v[48:51], a[52:55], v[24:27], v[48:51]
    v_mfma_f32_16x16x32_bf16 v[56:59], a[132:135], v[24:27], v[56:59]
    v_mfma_f32_16x16x32_bf16 v[52:55], a[52:55], v[28:31], v[52:55]
    v_mfma_f32_16x16x32_bf16 v[60:63], a[132:135], v[28:31], v[60:63]
    ds_read_b128 v[24:27], v3 offset:8192
    ds_read_b128 v[28:31], v3 offset:28672
    s_waitcnt lgkmcnt(6)
    v_mfma_f32_16x16x32_bf16 v[48:51], a[56:59], v[32:35], v[48:51]
    v_mfma_f32_16x16x32_bf16 v[56:59], a[136:139], v[32:35], v[56:59]
    v_mfma_f32_16x16x32_bf16 v[52:55], a[56:59], v[36:39], v[52:55]
    v_mfma_f32_16x16x32_bf16 v[60:63], a[136:139], v[36:39], v[60:63]
    s_add_u32 m0, s72, 3584
    s_nop 0
    buffer_load_dwordx4 v6, s[48:51], s71 offen offset:512 lds
    s_add_u32 s71, s71, 81920
    s_add_u32 s62, s72, 40960
    s_sub_u32 s63, s72, 40960
    s_cmp_lt_u32 s72, 40960
    s_cselect_b32 s72, s62, s63
    ds_read_b128 v[32:35], v2 offset:9216
    ds_read_b128 v[36:39], v2 offset:29696
    s_waitcnt lgkmcnt(6)
    v_mfma_f32_16x16x32_bf16 v[48:51], a[60:63], v[40:43], v[48:51]
    v_mfma_f32_16x16x32_bf16 v[56:59], a[140:143], v[40:43], v[56:59]
    v_mfma_f32_16x16x32_bf16 v[52:55], a[60:63], v[44:47], v[52:55]
    v_mfma_f32_16x16x32_bf16 v[60:63], a[140:143], v[44:47], v[60:63]
    ds_read_b128 v[40:43], v3 offset:9216
    ds_read_b128 v[44:47], v3 offset:29696
    s_waitcnt lgkmcnt(6)
    v_mfma_f32_16x16x32_bf16 v[48:51], a[64:67], v[16:19], v[48:51]
    v_mfma_f32_16x16x32_bf16 v[56:59], a[144:147], v[16:19], v[56:59]
    v_mfma_f32_16x16x32_bf16 v[52:55], a[64:67], v[20:23], v[52:55]
    v_mfma_f32_16x16x32_bf16 v[60:63], a[144:147], v[20:23], v[60:63]
    s_waitcnt lgkmcnt(4)
    v_mfma_f32_16x16x32_bf16 v[48:51], a[68:71], v[24:27], v[48:51]
    v_mfma_f32_16x16x32_bf16 v[56:59], a[148:151], v[24:27], v[56:59]
    v_mfma_f32_16x16x32_bf16 v[52:55], a[68:71], v[28:31], v[52:55]
    v_mfma_f32_16x16x32_bf16 v[60:63], a[148:151], v[28:31], v[60:63]
    s_waitcnt lgkmcnt(2)
    v_mfma_f32_16x16x32_bf16 v[48:51], a[72:75], v[32:35], v[48:51]
    v_mfma_f32_16x16x32_bf16 v[56:59], a[152:155], v[32:35], v[56:59]
    v_mfma_f32_16x16x32_bf16 v[52:55], a[72:75], v[36:39], v[52:55]
    v_mfma_f32_16x16x32_bf16 v[60:63], a[152:155], v[36:39], v[60:63]
    s_waitcnt lgkmcnt(0)
    v_mfma_f32_16x16x32_bf16 v[48:51], a[76:79], v[40:43], v[48:51]
    v_mfma_f32_16x16x32_bf16 v[56:59], a[156:159], v[40:43], v[56:59]
    v_mfma_f32_16x16x32_bf16 v[52:55], a[76:79], v[44:47], v[52:55]
    v_mfma_f32_16x16x32_bf16 v[60:63], a[156:159], v[44:47], v[60:63]
    v_add_u32 v12, 40960, v2
    v_subrev_u32 v2, 40960, v2
    v_min_u32 v2, v2, v12
    v_xor_b32 v3, 64, v2
    s_waitcnt vmcnt(5)
    v_sub_f32 v4, 1.0, v4
    v_sub_f32 v5, 1.0, v5
    v_mul_f32 v48, v48, v4
    v_mul_f32 v49, v49, v4
    v_mul_f32 v50, v50, v4
    v_mul_f32 v51, v51, v4
    v_mul_f32 v52, v52, v5
    v_mul_f32 v53, v53, v5
    v_mul_f32 v54, v54, v5
    v_mul_f32 v55, v55, v5
    v_mul_f32 v48, v48, v56
    v_mul_f32 v49, v49, v57
    v_mul_f32 v50, v50, v58
    v_mul_f32 v51, v51, v59
    v_mul_f32 v52, v52, v60
    v_mul_f32 v53, v53, v61
    v_mul_f32 v54, v54, v62
    v_mul_f32 v55, v55, v63
    v_cvt_pk_bf16_f32 v64, v48, v49
    v_cvt_pk_bf16_f32 v65, v50, v51
    v_cvt_pk_bf16_f32 v66, v52, v53
    v_cvt_pk_bf16_f32 v67, v54, v55
    buffer_store_dwordx4 v[64:67], v1, s[4:7], s78 offen sc1
    s_add_u32 s78, s78, 229376
    s_add_u32 s60, s60, 1
    s_cmp_lt_u32 s60, 32
    s_cbranch_scc1 L_FF1_loop
    s_waitcnt vmcnt(0)
    s_barrier
    s_cmp_lg_u32 s52, 0
    s_cbranch_scc1 Lfs_191
    v_mov_b32 v13, s60
    s_mov_b64 exec, 1
    buffer_store_dword v13, v9, s[4:7], 0 offen sc1
    s_mov_b64 exec, -1
Lfs_191:
    s_and_b32 s55, s54, 7
    s_lshr_b32 s57, s54, 3
    s_cmp_ge_u32 s54, 16
    s_cselect_b32 s56, 62, 63
    s_cmp_lt_u32 s54, 24
    s_cbranch_scc1 L_FIN2
    s_branch L_end
L_FIN:
    s_lshl_b32 s57, s56, 3
    s_add_u32 s57, s57, s55
    s_lshl_b32 s62, s57, 7
    s_add_u32 s90, s62, 2387968
    s_waitcnt vmcnt(0)
    s_barrier
    s_or_b32 s62, s52, s30
    s_cbranch_scc1 Lci_192
    s_lshl_b32 s62, 1, s54
    s_lshl_b32 s63, s53, 5
    v_mov_b32 v20, s62
    v_mov_b32 v14, s63
    s_mov_b64 exec, 1
    buffer_atomic_or v20, v14, s[8:11], 0 offen sc0
    s_mov_b64 exec, -1
Lci_192:
    s_waitcnt vmcnt(0)
    v_min_u32 v15, 7, v0
    v_lshlrev_b32 v15, 5, v15
    s_cmp_lg_u32 s52, 0
    s_cbranch_scc1 Lwid_194
    s_mov_b32 s64, 0
    s_cmp_lg_u32 s30, 0
    s_cbranch_scc1 Lwok_195
    s_waitcnt vmcnt(0)
    v_readfirstlane_b32 s62, v20
    s_nop 0
    s_lshr_b32 s62, s62, s54
    s_and_b32 s64, s62, 1
Lwok_195:
    v_mov_b32 v14, 163832
    v_mov_b32 v20, s64
    ds_write_b32 v14, v20
    s_waitcnt lgkmcnt(0)
    s_cmp_lg_u32 s64, 0
    s_cbranch_scc1 Lwid_194
    s_mov_b32 s89, s59
Lwi_193:
    s_sleep 64
    buffer_load_dword v14, v15, s[8:11], 0 offen sc1
    s_waitcnt vmcnt(0)
    v_cmp_ne_u32 vcc, -1, v14
    s_cbranch_vccz Lwid_194
    s_sub_u32 s89, s89, 8
    s_cbranch_scc0 Lwi_193
    s_mov_b32 s59, 0
Lwid_194:
    s_barrier
    buffer_load_dword v14, v15, s[8:11], 0 offen offset:4 sc1
    v_mov_b32 v15, 163832
    ds_read_b32 v15, v15
    s_waitcnt vmcnt(0) lgkmcnt(0)
    v_readfirstlane_b32 s62, v15
    s_nop 0
    s_cmp_lg_u32 s62, 0
    s_cbranch_scc1 L_reclaim
    v_readlane_b32 s62, v14, 1
    v_readlane_b32 s63, v14, 2
    v_readlane_b32 s61, v14, 3
    s_cmp_gt_u32 s63, s62
    s_cselect_b32 s46, 0x2000, 0
    s_cmp_lg_u32 s52, 0
    s_cbranch_scc1 Lls_196
    v_mov_b32 v15, 2359296
    s_mov_b32 s64, 1
    s_mov_b32 s89, s59
Lsp_197:
    buffer_load_dword v14, v15, s[4:7], 0 offen sc1
    s_waitcnt vmcnt(0)
    v_cmp_gt_u32 vcc, s64, v14
    s_cbranch_vccz Lspd_198
    s_sleep 16
    s_sub_u32 s89, s89, 1
    s_cbranch_scc0 Lsp_197
    s_mov_b32 s59, 0
Lspd_198:
Lls_196:
    s_barrier
    s_mov_b32 s48, s16
    s_and_b32 s49, s17, 0xffff
    s_mov_b32 s50, 2621440
    s_mov_b32 s51, 0x00020000
    s_mov_b32 s12, s38
    s_and_b32 s13, s39, 0xffff
    s_mov_b32 s14, 1280
    s_mov_b32 s15, 0x00020000
    v_and_b32 v2, 7, v0
    v_lshlrev_b32 v2, 4, v2
    v_lshrrev_b32 v3, 3, v0
    v_mul_u32_u24 v4, 1280, v3
    v_add_u32 v4, v4, v2
    s_lshl_b32 s64, s57, 3
    s_add_u32 s64, s64, s52
    s_mul_i32 s62, s64, 10240
    buffer_load_dwordx4 v[16:19], v4, s[48:51], s62 offen offset:0
    buffer_load_dwordx4 v[56:59], v2, s[12:15], 0 offen offset:0
    buffer_load_dwordx4 v[20:23], v4, s[48:51], s62 offen offset:128
    buffer_load_dwordx4 v[60:63], v2, s[12:15], 0 offen offset:128
    buffer_load_dwordx4 v[24:27], v4, s[48:51], s62 offen offset:256
    buffer_load_dwordx4 v[64:67], v2, s[12:15], 0 offen offset:256
    buffer_load_dwordx4 v[28:31], v4, s[48:51], s62 offen offset:384
    buffer_load_dwordx4 v[68:71], v2, s[12:15], 0 offen offset:384
    buffer_load_dwordx4 v[32:35], v4, s[48:51], s62 offen offset:512
    buffer_load_dwordx4 v[72:75], v2, s[12:15], 0 offen offset:512
    buffer_load_dwordx4 v[36:39], v4, s[48:51], s62 offen offset:640
    buffer_load_dwordx4 v[76:79], v2, s[12:15], 0 offen offset:640
    buffer_load_dwordx4 v[40:43], v4, s[48:51], s62 offen offset:768
    buffer_load_dwordx4 v[80:83], v2, s[12:15], 0 offen offset:768
    buffer_load_dwordx4 v[44:47], v4, s[48:51], s62 offen offset:896
    buffer_load_dwordx4 v[84:87], v2, s[12:15], 0 offen offset:896
    buffer_load_dwordx4 v[48:51], v4, s[48:51], s62 offen offset:1024
    buffer_load_dwordx4 v[88:91], v2, s[12:15], 0 offen offset:1024
    buffer_load_dwordx4 v[52:55], v4, s[48:51], s62 offen offset:1152
    buffer_load_dwordx4 v[92:95], v2, s[12:15], 0 offen offset:1152
    v_mov_b32 v5, 0
    s_waitcnt vmcnt(0)
    v_dot2_f32_bf16 v5, v16, v56, v5
    v_dot2_f32_bf16 v5, v17, v57, v5
    v_dot2_f32_bf16 v5, v18, v58, v5
    v_dot2_f32_bf16 v5, v19, v59, v5
    v_dot2_f32_bf16 v5, v20, v60, v5
    v_dot2_f32_bf16 v5, v21, v61, v5
    v_dot2_f32_bf16 v5, v22, v62, v5
    v_dot2_f32_bf16 v5, v23, v63, v5
    v_dot2_f32_bf16 v5, v24, v64, v5
    v_dot2_f32_bf16 v5, v25, v65, v5
    v_dot2_f32_bf16 v5, v26, v66, v5
    v_dot2_f32_bf16 v5, v27, v67, v5
    v_dot2_f32_bf16 v5, v28, v68, v5
    v_dot2_f32_bf16 v5, v29, v69, v5
    v_dot2_f32_bf16 v5, v30, v70, v5
    v_dot2_f32_bf16 v5, v31, v71, v5
    v_dot2_f32_bf16 v5, v32, v72, v5
    v_dot2_f32_bf16 v5, v33, v73, v5
    v_dot2_f32_bf16 v5, v34, v74, v5
    v_dot2_f32_bf16 v5, v35, v75, v5
    v_dot2_f32_bf16 v5, v36, v76, v5
    v_dot2_f32_bf16 v5, v37, v77, v5
    v_dot2_f32_bf16 v5, v38, v78, v5
    v_dot2_f32_bf16 v5, v39, v79, v5
    v_dot2_f32_bf16 v5, v40, v80, v5
    v_dot2_f32_bf16 v5, v41, v81, v5
    v_dot2_f32_bf16 v5, v42, v82, v5
    v_dot2_f32_bf16 v5, v43, v83, v5
    v_dot2_f32_bf16 v5, v44, v84, v5
    v_dot2_f32_bf16 v5, v45, v85, v5
    v_dot2_f32_bf16 v5, v46, v86, v5
    v_dot2_f32_bf16 v5, v47, v87, v5
    v_dot2_f32_bf16 v5, v48, v88, v5
    v_dot2_f32_bf16 v5, v49, v89, v5
    v_dot2_f32_bf16 v5, v50, v90, v5
    v_dot2_f32_bf16 v5, v51, v91, v5
    v_dot2_f32_bf16 v5, v52, v92, v5
    v_dot2_f32_bf16 v5, v53, v93, v5
    v_dot2_f32_bf16 v5, v54, v94, v5
    v_dot2_f32_bf16 v5, v55, v95, v5
    s_nop 2
    v_add_f32_dpp v5, v5, v5 quad_perm:[1,0,3,2] row_mask:0xf bank_mask:0xf
    s_nop 1
    v_add_f32_dpp v5, v5, v5 quad_perm:[2,3,0,1] row_mask:0xf bank_mask:0xf
    s_nop 1
    v_add_f32_dpp v5, v5, v5 row_half_mirror row_mask:0xf bank_mask:0xf
    v_mul_f32 v5, 0xbfb8aa3b, v5
    v_exp_f32 v5, v5
    s_nop 0
    v_add_f32 v5, 1.0, v5
    v_rcp_f32 v5, v5
    v_lshlrev_b32 v3, 2, v3
    s_lshl_b32 s64, s64, 5
    s_add_u32 s64, s64, 2293760
    s_mov_b32 exec_lo, 0x01010101
    s_mov_b32 exec_hi, 0x01010101
    buffer_store_dword v5, v3, s[4:7], s64 offen sc1
    s_mov_b64 exec, -1
    s_waitcnt vmcnt(0)
    s_barrier
    v_mov_b32 v6, s90
    s_mov_b32 s64, 1
    s_cmp_lg_u32 s52, 1
    s_cbranch_scc1 Lfs_199
    v_mov_b32 v7, s64
    s_mov_b64 exec, 1
    buffer_store_dword v7, v6, s[4:7], 0 offen sc1
    s_mov_b64 exec, -1
Lfs_199:
L_FIN2:
    v_lshrrev_b32 v14, 4, v0
    v_bfe_u32 v10, v0, 1, 3
    v_xor_b32 v10, v10, v14
    v_cmp_lt_u32 vcc, 4, v10
    v_lshlrev_b32 v10, 5, v10
    v_mov_b32 v14, 0x40000000
    v_cndmask_b32 v10, v10, v14, vcc
    v_and_b32 v14, 1, v0
    v_lshl_add_u32 v10, v14, 4, v10
    v_lshrrev_b32 v14, 4, v0
    v_mul_u32_u24 v14, 1280, v14
    v_add_u32 v10, v10, v14
    v_lshrrev_b32 v14, 4, v0
    v_or_b32 v14, 4, v14
    v_bfe_u32 v11, v0, 1, 3
    v_xor_b32 v11, v11, v14
    v_cmp_lt_u32 vcc, 4, v11
    v_lshlrev_b32 v11, 5, v11
    v_mov_b32 v14, 0x40000000
    v_cndmask_b32 v11, v11, v14, vcc
    v_and_b32 v14, 1, v0
    v_lshl_add_u32 v11, v14, 4, v11
    v_lshrrev_b32 v14, 4, v0
    v_mul_u32_u24 v14, 1280, v14
    v_add_u32 v11, v11, v14
    v_bfe_u32 v12, v0, 2, 3
    v_lshlrev_b32 v12, 5, v12
    v_and_b32 v14, 3, v0
    v_lshl_add_u32 v12, v14, 3, v12
    v_lshrrev_b32 v14, 2, v0
    v_lshl_add_u32 v12, v14, 8, v12
    s_and_b32 s62, s52, 3
    s_lshl_b32 s62, s62, 13
    v_add_u32 v12, s62, v12
    s_mov_b32 s12, s36
    s_and_b32 s13, s37, 0xffff
    s_mov_b32 s14, 2211840
    s_mov_b32 s15, 0x00020000
    s_lshl_b32 s62, s52, 4
    s_add_u32 s62, s62, 0
    s_mul_i32 s62, s62, 1280
    s_mul_i32 s63, s55, 160
    s_add_u32 s62, s62, s63
    s_lshl_b32 s63, s52, 12
    s_add_u32 s63, s63, 65536
    s_mov_b32 m0, s63
    s_nop 0
    buffer_load_dwordx4 v10, s[12:15], s62 offen lds
    s_add_u32 s62, s62, 5120
    s_add_u32 s63, s63, 1024
    s_mov_b32 m0, s63
    s_nop 0
    buffer_load_dwordx4 v11, s[12:15], s62 offen lds
    s_add_u32 s62, s62, 5120
    s_add_u32 s63, s63, 1024
    s_mov_b32 m0, s63
    s_nop 0
    buffer_load_dwordx4 v10, s[12:15], s62 offen lds
    s_add_u32 s62, s62, 5120
    s_add_u32 s63, s63, 1024
    s_mov_b32 m0, s63
    s_nop 0
    buffer_load_dwordx4 v11, s[12:15], s62 offen lds
    s_lshl_b32 s62, s52, 4
    s_add_u32 s62, s62, 128
    s_mul_i32 s62, s62, 1280
    s_mul_i32 s63, s55, 160
    s_add_u32 s62, s62, s63
    s_lshl_b32 s63, s52, 12
    s_add_u32 s63, s63, 98304
    s_mov_b32 m0, s63
    s_nop 0
    buffer_load_dwordx4 v10, s[12:15], s62 offen lds
    s_add_u32 s62, s62, 5120
    s_add_u32 s63, s63, 1024
    s_mov_b32 m0, s63
    s_nop 0
    buffer_load_dwordx4 v11, s[12:15], s62 offen lds
    s_add_u32 s62, s62, 5120
    s_add_u32 s63, s63, 1024
    s_mov_b32 m0, s63
    s_nop 0
    buffer_load_dwordx4 v10, s[12:15], s62 offen lds
    s_add_u32 s62, s62, 5120
    s_add_u32 s63, s63, 1024
    s_mov_b32 m0, s63
    s_nop 0
    buffer_load_dwordx4 v11, s[12:15], s62 offen lds
    s_lshl_b32 s62, s52, 4
    s_add_u32 s62, s62, 256
    s_mul_i32 s62, s62, 1280
    s_mul_i32 s63, s55, 160
    s_add_u32 s62, s62, s63
    s_lshl_b32 s63, s52, 12
    s_add_u32 s63, s63, 131072
    s_mov_b32 m0, s63
    s_nop 0
    buffer_load_dwordx4 v10, s[12:15], s62 offen lds
    s_add_u32 s62, s62, 5120
    s_add_u32 s63, s63, 1024
    s_mov_b32 m0, s63
    s_nop 0
    buffer_load_dwordx4 v11, s[12:15], s62 offen lds
    s_add_u32 s62, s62, 5120
    s_add_u32 s63, s63, 1024
    s_mov_b32 m0, s63
    s_nop 0
    buffer_load_dwordx4 v10, s[12:15], s62 offen lds
    s_add_u32 s62, s62, 5120
    s_add_u32 s63, s63, 1024
    s_mov_b32 m0, s63
    s_nop 0
    buffer_load_dwordx4 v11, s[12:15], s62 offen lds
    s_waitcnt vmcnt(8)
    s_barrier
    v_add_u32 v13, 65536, v12
    s_cmp_ge_u32 s52, 4
    s_cbranch_scc1 Lwd_200
    v_xor_b32 v15, 0, v13
    ds_read_b64_tr_b16 a[0:1], v15 offset:0
    ds_read_b64_tr_b16 a[2:3], v15 offset:4096
    v_xor_b32 v15, 32, v13
    ds_read_b64_tr_b16 a[4:5], v15 offset:0
    ds_read_b64_tr_b16 a[6:7], v15 offset:4096
    v_xor_b32 v15, 64, v13
    ds_read_b64_tr_b16 a[8:9], v15 offset:0
    ds_read_b64_tr_b16 a[10:11], v15 offset:4096
    v_xor_b32 v15, 96, v13
    ds_read_b64_tr_b16 a[12:13], v15 offset:0
    ds_read_b64_tr_b16 a[14:15], v15 offset:4096
    v_xor_b32 v15, 128, v13
    ds_read_b64_tr_b16 a[16:17], v15 offset:0
    ds_read_b64_tr_b16 a[18:19], v15 offset:4096
Lwd_200:
    s_waitcnt lgkmcnt(0)
    s_barrier
    s_lshl_b32 s62, s52, 4
    s_add_u32 s62, s62, 384
    s_mul_i32 s62, s62, 1280
    s_mul_i32 s63, s55, 160
    s_add_u32 s62, s62, s63
    s_lshl_b32 s63, s52, 12
    s_add_u32 s63, s63, 65536
    s_mov_b32 m0, s63
    s_nop 0
    buffer_load_dwordx4 v10, s[12:15], s62 offen lds
    s_add_u32 s62, s62, 5120
    s_add_u32 s63, s63, 1024
    s_mov_b32 m0, s63
    s_nop 0
    buffer_load_dwordx4 v11, s[12:15], s62 offen lds
    s_add_u32 s62, s62, 5120
    s_add_u32 s63, s63, 1024
    s_mov_b32 m0, s63
    s_nop 0
    buffer_load_dwordx4 v10, s[12:15], s62 offen lds
    s_add_u32 s62, s62, 5120
    s_add_u32 s63, s63, 1024
    s_mov_b32 m0, s63
    s_nop 0
    buffer_load_dwordx4 v11, s[12:15], s62 offen lds
    s_waitcnt vmcnt(8)
    s_barrier
    v_add_u32 v13, 98304, v12
    s_cmp_ge_u32 s52, 4
    s_cbranch_scc0 Lwd_201
    v_xor_b32 v15, 0, v13
    ds_read_b64_tr_b16 a[0:1], v15 offset:0
    ds_read_b64_tr_b16 a[2:3], v15 offset:4096
    v_xor_b32 v15, 32, v13
    ds_read_b64_tr_b16 a[4:5], v15 offset:0
    ds_read_b64_tr_b16 a[6:7], v15 offset:4096
    v_xor_b32 v15, 64, v13
    ds_read_b64_tr_b16 a[8:9], v15 offset:0
    ds_read_b64_tr_b16 a[10:11], v15 offset:4096
    v_xor_b32 v15, 96, v13
    ds_read_b64_tr_b16 a[12:13], v15 offset:0
    ds_read_b64_tr_b16 a[14:15], v15 offset:4096
    v_xor_b32 v15, 128, v13
    ds_read_b64_tr_b16 a[16:17], v15 offset:0
    ds_read_b64_tr_b16 a[18:19], v15 offset:4096
Lwd_201:
    s_waitcnt lgkmcnt(0)
    s_barrier
    s_lshl_b32 s62, s52, 4
    s_add_u32 s62, s62, 512
    s_mul_i32 s62, s62, 1280
    s_mul_i32 s63, s55, 160
    s_add_u32 s62, s62, s63
    s_lshl_b32 s63, s52, 12
    s_add_u32 s63, s63, 98304
    s_mov_b32 m0, s63
    s_nop 0
    buffer_load_dwordx4 v10, s[12:15], s62 offen lds
    s_add_u32 s62, s62, 5120
    s_add_u32 s63, s63, 1024
    s_mov_b32 m0, s63
    s_nop 0
    buffer_load_dwordx4 v11, s[12:15], s62 offen lds
    s_add_u32 s62, s62, 5120
    s_add_u32 s63, s63, 1024
    s_mov_b32 m0, s63
    s_nop 0
    buffer_load_dwordx4 v10, s[12:15], s62 offen lds
    s_add_u32 s62, s62, 5120
    s_add_u32 s63, s63, 1024
    s_mov_b32 m0, s63
    s_nop 0
    buffer_load_dwordx4 v11, s[12:15], s62 offen lds
    s_waitcnt vmcnt(8)
    s_barrier
    v_add_u32 v13, 131072, v12
    s_cmp_ge_u32 s52, 4
    s_cbranch_scc1 Lwd_202
    v_xor_b32 v15, 0, v13
    ds_read_b64_tr_b16 a[20:21], v15 offset:0
    ds_read_b64_tr_b16 a[22:23], v15 offset:4096
    v_xor_b32 v15, 32, v13
    ds_read_b64_tr_b16 a[24:25], v15 offset:0
    ds_read_b64_tr_b16 a[26:27], v15 offset:4096
    v_xor_b32 v15, 64, v13
    ds_read_b64_tr_b16 a[28:29], v15 offset:0
    ds_read_b64_tr_b16 a[30:31], v15 offset:4096
    v_xor_b32 v15, 96, v13
    ds_read_b64_tr_b16 a[32:33], v15 offset:0
    ds_read_b64_tr_b16 a[34:35], v15 offset:4096
    v_xor_b32 v15, 128, v13
    ds_read_b64_tr_b16 a[36:37], v15 offset:0
    ds_read_b64_tr_b16 a[38:39], v15 offset:4096
Lwd_202:
    s_waitcnt lgkmcnt(0)
    s_barrier
    s_lshl_b32 s62, s52, 4
    s_add_u32 s62, s62, 640
    s_mul_i32 s62, s62, 1280
    s_mul_i32 s63, s55, 160
    s_add_u32 s62, s62, s63
    s_lshl_b32 s63, s52, 12
    s_add_u32 s63, s63, 131072
    s_mov_b32 m0, s63
    s_nop 0
    buffer_load_dwordx4 v10, s[12:15], s62 offen lds
    s_add_u32 s62, s62, 5120
    s_add_u32 s63, s63, 1024
    s_mov_b32 m0, s63
    s_nop 0
    buffer_load_dwordx4 v11, s[12:15], s62 offen lds
    s_add_u32 s62, s62, 5120
    s_add_u32 s63, s63, 1024
    s_mov_b32 m0, s63
    s_nop 0
    buffer_load_dwordx4 v10, s[12:15], s62 offen lds
    s_add_u32 s62, s62, 5120
    s_add_u32 s63, s63, 1024
    s_mov_b32 m0, s63
    s_nop 0
    buffer_load_dwordx4 v11, s[12:15], s62 offen lds
    s_waitcnt vmcnt(8)
    s_barrier
    v_add_u32 v13, 65536, v12
    s_cmp_ge_u32 s52, 4
    s_cbranch_scc0 Lwd_203
    v_xor_b32 v15, 0, v13
    ds_read_b64_tr_b16 a[20:21], v15 offset:0
    ds_read_b64_tr_b16 a[22:23], v15 offset:4096
    v_xor_b32 v15, 32, v13
    ds_read_b64_tr_b16 a[24:25], v15 offset:0
    ds_read_b64_tr_b16 a[26:27], v15 offset:4096
    v_xor_b32 v15, 64, v13
    ds_read_b64_tr_b16 a[28:29], v15 offset:0
    ds_read_b64_tr_b16 a[30:31], v15 offset:4096
    v_xor_b32 v15, 96, v13
    ds_read_b64_tr_b16 a[32:33], v15 offset:0
    ds_read_b64_tr_b16 a[34:35], v15 offset:4096
    v_xor_b32 v15, 128, v13
    ds_read_b64_tr_b16 a[36:37], v15 offset:0
    ds_read_b64_tr_b16 a[38:39], v15 offset:4096
Lwd_203:
    s_waitcnt lgkmcnt(0)
    s_barrier
    s_lshl_b32 s62, s52, 4
    s_add_u32 s62, s62, 768
    s_mul_i32 s62, s62, 1280
    s_mul_i32 s63, s55, 160
    s_add_u32 s62, s62, s63
    s_lshl_b32 s63, s52, 12
    s_add_u32 s63, s63, 65536
    s_mov_b32 m0, s63
    s_nop 0
    buffer_load_dwordx4 v10, s[12:15], s62 offen lds
    s_add_u32 s62, s62, 5120
    s_add_u32 s63, s63, 1024
    s_mov_b32 m0, s63
    s_nop 0
    buffer_load_dwordx4 v11, s[12:15], s62 offen lds
    s_add_u32 s62, s62, 5120
    s_add_u32 s63, s63, 1024
    s_mov_b32 m0, s63
    s_nop 0
    buffer_load_dwordx4 v10, s[12:15], s62 offen lds
    s_add_u32 s62, s62, 5120
    s_add_u32 s63, s63, 1024
    s_mov_b32 m0, s63
    s_nop 0
    buffer_load_dwordx4 v11, s[12:15], s62 offen lds
    s_waitcnt vmcnt(8)
    s_barrier
    v_add_u32 v13, 98304, v12
    s_cmp_ge_u32 s52, 4
    s_cbranch_scc1 Lwd_204
    v_xor_b32 v15, 0, v13
    ds_read_b64_tr_b16 a[40:41], v15 offset:0
    ds_read_b64_tr_b16 a[42:43], v15 offset:4096
    v_xor_b32 v15, 32, v13
    ds_read_b64_tr_b16 a[44:45], v15 offset:0
    ds_read_b64_tr_b16 a[46:47], v15 offset:4096
    v_xor_b32 v15, 64, v13
    ds_read_b64_tr_b16 a[48:49], v15 offset:0
    ds_read_b64_tr_b16 a[50:51], v15 offset:4096
    v_xor_b32 v15, 96, v13
    ds_read_b64_tr_b16 a[52:53], v15 offset:0
    ds_read_b64_tr_b16 a[54:55], v15 offset:4096
    v_xor_b32 v15, 128, v13
    ds_read_b64_tr_b16 a[56:57], v15 offset:0
    ds_read_b64_tr_b16 a[58:59], v15 offset:4096
Lwd_204:
    s_waitcnt lgkmcnt(0)
    s_barrier
    s_lshl_b32 s62, s52, 4
    s_add_u32 s62, s62, 896
    s_mul_i32 s62, s62, 1280
    s_mul_i32 s63, s55, 160
    s_add_u32 s62, s62, s63
    s_lshl_b32 s63, s52, 12
    s_add_u32 s63, s63, 98304
    s_mov_b32 m0, s63
    s_nop 0
    buffer_load_dwordx4 v10, s[12:15], s62 offen lds
    s_add_u32 s62, s62, 5120
    s_add_u32 s63, s63, 1024
    s_mov_b32 m0, s63
    s_nop 0
    buffer_load_dwordx4 v11, s[12:15], s62 offen lds
    s_add_u32 s62, s62, 5120
    s_add_u32 s63, s63, 1024
    s_mov_b32 m0, s63
    s_nop 0
    buffer_load_dwordx4 v10, s[12:15], s62 offen lds
    s_add_u32 s62, s62, 5120
    s_add_u32 s63, s63, 1024
    s_mov_b32 m0, s63
    s_nop 0
    buffer_load_dwordx4 v11, s[12:15], s62 offen lds
    s_waitcnt vmcnt(8)
    s_barrier
    v_add_u32 v13, 131072, v12
    s_cmp_ge_u32 s52, 4
    s_cbranch_scc0 Lwd_205
    v_xor_b32 v15, 0, v13
    ds_read_b64_tr_b16 a[40:41], v15 offset:0
    ds_read_b64_tr_b16 a[42:43], v15 offset:4096
    v_xor_b32 v15, 32, v13
    ds_read_b64_tr_b16 a[44:45], v15 offset:0
    ds_read_b64_tr_b16 a[46:47], v15 offset:4096
    v_xor_b32 v15, 64, v13
    ds_read_b64_tr_b16 a[48:49], v15 offset:0
    ds_read_b64_tr_b16 a[50:51], v15 offset:4096
    v_xor_b32 v15, 96, v13
    ds_read_b64_tr_b16 a[52:53], v15 offset:0
    ds_read_b64_tr_b16 a[54:55], v15 offset:4096
    v_xor_b32 v15, 128, v13
    ds_read_b64_tr_b16 a[56:57], v15 offset:0
    ds_read_b64_tr_b16 a[58:59], v15 offset:4096
Lwd_205:
    s_waitcnt lgkmcnt(0)
    s_barrier
    s_lshl_b32 s62, s52, 4
    s_add_u32 s62, s62, 1024
    s_mul_i32 s62, s62, 1280
    s_mul_i32 s63, s55, 160
    s_add_u32 s62, s62, s63
    s_lshl_b32 s63, s52, 12
    s_add_u32 s63, s63, 131072
    s_mov_b32 m0, s63
    s_nop 0
    buffer_load_dwordx4 v10, s[12:15], s62 offen lds
    s_add_u32 s62, s62, 5120
    s_add_u32 s63, s63, 1024
    s_mov_b32 m0, s63
    s_nop 0
    buffer_load_dwordx4 v11, s[12:15], s62 offen lds
    s_add_u32 s62, s62, 5120
    s_add_u32 s63, s63, 1024
    s_mov_b32 m0, s63
    s_nop 0
    buffer_load_dwordx4 v10, s[12:15], s62 offen lds
    s_add_u32 s62, s62, 5120
    s_add_u32 s63, s63, 1024
    s_mov_b32 m0, s63
    s_nop 0
    buffer_load_dwordx4 v11, s[12:15], s62 offen lds
    s_waitcnt vmcnt(8)
    s_barrier
    v_add_u32 v13, 65536, v12
    s_cmp_ge_u32 s52, 4
    s_cbranch_scc1 Lwd_206
    v_xor_b32 v15, 0, v13
    ds_read_b64_tr_b16 a[60:61], v15 offset:0
    ds_read_b64_tr_b16 a[62:63], v15 offset:4096
    v_xor_b32 v15, 32, v13
    ds_read_b64_tr_b16 a[64:65], v15 offset:0
    ds_read_b64_tr_b16 a[66:67], v15 offset:4096
    v_xor_b32 v15, 64, v13
    ds_read_b64_tr_b16 a[68:69], v15 offset:0
    ds_read_b64_tr_b16 a[70:71], v15 offset:4096
    v_xor_b32 v15, 96, v13
    ds_read_b64_tr_b16 a[72:73], v15 offset:0
    ds_read_b64_tr_b16 a[74:75], v15 offset:4096
    v_xor_b32 v15, 128, v13
    ds_read_b64_tr_b16 a[76:77], v15 offset:0
    ds_read_b64_tr_b16 a[78:79], v15 offset:4096
Lwd_206:
    s_waitcnt lgkmcnt(0)
    s_barrier
    s_lshl_b32 s62, s52, 4
    s_add_u32 s62, s62, 1152
    s_mul_i32 s62, s62, 1280
    s_mul_i32 s63, s55, 160
    s_add_u32 s62, s62, s63
    s_lshl_b32 s63, s52, 12
    s_add_u32 s63, s63, 65536
    s_mov_b32 m0, s63
    s_nop 0
    buffer_load_dwordx4 v10, s[12:15], s62 offen lds
    s_add_u32 s62, s62, 5120
    s_add_u32 s63, s63, 1024
    s_mov_b32 m0, s63
    s_nop 0
    buffer_load_dwordx4 v11, s[12:15], s62 offen lds
    s_add_u32 s62, s62, 5120
    s_add_u32 s63, s63, 1024
    s_mov_b32 m0, s63
    s_nop 0
    buffer_load_dwordx4 v10, s[12:15], s62 offen lds
    s_add_u32 s62, s62, 5120
    s_add_u32 s63, s63, 1024
    s_mov_b32 m0, s63
    s_nop 0
    buffer_load_dwordx4 v11, s[12:15], s62 offen lds
    s_waitcnt vmcnt(8)
    s_barrier
    v_add_u32 v13, 98304, v12
    s_cmp_ge_u32 s52, 4
    s_cbranch_scc0 Lwd_207
    v_xor_b32 v15, 0, v13
    ds_read_b64_tr_b16 a[60:61], v15 offset:0
    ds_read_b64_tr_b16 a[62:63], v15 offset:4096
    v_xor_b32 v15, 32, v13
    ds_read_b64_tr_b16 a[64:65], v15 offset:0
    ds_read_b64_tr_b16 a[66:67], v15 offset:4096
    v_xor_b32 v15, 64, v13
    ds_read_b64_tr_b16 a[68:69], v15 offset:0
    ds_read_b64_tr_b16 a[70:71], v15 offset:4096
    v_xor_b32 v15, 96, v13
    ds_read_b64_tr_b16 a[72:73], v15 offset:0
    ds_read_b64_tr_b16 a[74:75], v15 offset:4096
    v_xor_b32 v15, 128, v13
    ds_read_b64_tr_b16 a[76:77], v15 offset:0
    ds_read_b64_tr_b16 a[78:79], v15 offset:4096
Lwd_207:
    s_waitcnt lgkmcnt(0)
    s_barrier
    s_lshl_b32 s62, s52, 4
    s_add_u32 s62, s62, 1280
    s_mul_i32 s62, s62, 1280
    s_mul_i32 s63, s55, 160
    s_add_u32 s62, s62, s63
    s_lshl_b32 s63, s52, 12
    s_add_u32 s63, s63, 98304
    s_mov_b32 m0, s63
    s_nop 0
    buffer_load_dwordx4 v10, s[12:15], s62 offen lds
    s_add_u32 s62, s62, 5120
    s_add_u32 s63, s63, 1024
    s_mov_b32 m0, s63
    s_nop 0
    buffer_load_dwordx4 v11, s[12:15], s62 offen lds
    s_add_u32 s62, s62, 5120
    s_add_u32 s63, s63, 1024
    s_mov_b32 m0, s63
    s_nop 0
    buffer_load_dwordx4 v10, s[12:15], s62 offen lds
    s_add_u32 s62, s62, 5120
    s_add_u32 s63, s63, 1024
    s_mov_b32 m0, s63
    s_nop 0
    buffer_load_dwordx4 v11, s[12:15], s62 offen lds
    s_waitcnt vmcnt(8)
    s_barrier
    v_add_u32 v13, 131072, v12
    s_cmp_ge_u32 s52, 4
    s_cbranch_scc1 Lwd_208
    v_xor_b32 v15, 0, v13
    ds_read_b64_tr_b16 a[80:81], v15 offset:0
    ds_read_b64_tr_b16 a[82:83], v15 offset:4096
    v_xor_b32 v15, 32, v13
    ds_read_b64_tr_b16 a[84:85], v15 offset:0
    ds_read_b64_tr_b16 a[86:87], v15 offset:4096
    v_xor_b32 v15, 64, v13
    ds_read_b64_tr_b16 a[88:89], v15 offset:0
    ds_read_b64_tr_b16 a[90:91], v15 offset:4096
    v_xor_b32 v15, 96, v13
    ds_read_b64_tr_b16 a[92:93], v15 offset:0
    ds_read_b64_tr_b16 a[94:95], v15 offset:4096
    v_xor_b32 v15, 128, v13
    ds_read_b64_tr_b16 a[96:97], v15 offset:0
    ds_read_b64_tr_b16 a[98:99], v15 offset:4096
Lwd_208:
    s_waitcnt lgkmcnt(0)
    s_barrier
    s_lshl_b32 s62, s52, 4
    s_add_u32 s62, s62, 1408
    s_mul_i32 s62, s62, 1280
    s_mul_i32 s63, s55, 160
    s_add_u32 s62, s62, s63
    s_lshl_b32 s63, s52, 12
    s_add_u32 s63, s63, 131072
    s_mov_b32 m0, s63
    s_nop 0
    buffer_load_dwordx4 v10, s[12:15], s62 offen lds
    s_add_u32 s62, s62, 5120
    s_add_u32 s63, s63, 1024
    s_mov_b32 m0, s63
    s_nop 0
    buffer_load_dwordx4 v11, s[12:15], s62 offen lds
    s_add_u32 s62, s62, 5120
    s_add_u32 s63, s63, 1024
    s_mov_b32 m0, s63
    s_nop 0
    buffer_load_dwordx4 v10, s[12:15], s62 offen lds
    s_add_u32 s62, s62, 5120
    s_add_u32 s63, s63, 1024
    s_mov_b32 m0, s63
    s_nop 0
    buffer_load_dwordx4 v11, s[12:15], s62 offen lds
    s_waitcnt vmcnt(8)
    s_barrier
    v_add_u32 v13, 65536, v12
    s_cmp_ge_u32 s52, 4
    s_cbranch_scc0 Lwd_209
    v_xor_b32 v15, 0, v13
    ds_read_b64_tr_b16 a[80:81], v15 offset:0
    ds_read_b64_tr_b16 a[82:83], v15 offset:4096
    v_xor_b32 v15, 32, v13
    ds_read_b64_tr_b16 a[84:85], v15 offset:0
    ds_read_b64_tr_b16 a[86:87], v15 offset:4096
    v_xor_b32 v15, 64, v13
    ds_read_b64_tr_b16 a[88:89], v15 offset:0
    ds_read_b64_tr_b16 a[90:91], v15 offset:4096
    v_xor_b32 v15, 96, v13
    ds_read_b64_tr_b16 a[92:93], v15 offset:0
    ds_read_b64_tr_b16 a[94:95], v15 offset:4096
    v_xor_b32 v15, 128, v13
    ds_read_b64_tr_b16 a[96:97], v15 offset:0
    ds_read_b64_tr_b16 a[98:99], v15 offset:4096
Lwd_209:
    s_waitcnt lgkmcnt(0)
    s_barrier
    s_lshl_b32 s62, s52, 4
    s_add_u32 s62, s62, 1536
    s_mul_i32 s62, s62, 1280
    s_mul_i32 s63, s55, 160
    s_add_u32 s62, s62, s63
    s_lshl_b32 s63, s52, 12
    s_add_u32 s63, s63, 65536
    s_mov_b32 m0, s63
    s_nop 0
    buffer_load_dwordx4 v10, s[12:15], s62 offen lds
    s_add_u32 s62, s62, 5120
    s_add_u32 s63, s63, 1024
    s_mov_b32 m0, s63
    s_nop 0
    buffer_load_dwordx4 v11, s[12:15], s62 offen lds
    s_add_u32 s62, s62, 5120
    s_add_u32 s63, s63, 1024
    s_mov_b32 m0, s63
    s_nop 0
    buffer_load_dwordx4 v10, s[12:15], s62 offen lds
    s_add_u32 s62, s62, 5120
    s_add_u32 s63, s63, 1024
    s_mov_b32 m0, s63
    s_nop 0
    buffer_load_dwordx4 v11, s[12:15], s62 offen lds
    s_waitcnt vmcnt(8)
    s_barrier
    v_add_u32 v13, 98304, v12
    s_cmp_ge_u32 s52, 4
    s_cbranch_scc1 Lwd_210
    v_xor_b32 v15, 0, v13
    ds_read_b64_tr_b16 a[100:101], v15 offset:0
    ds_read_b64_tr_b16 a[102:103], v15 offset:4096
    v_xor_b32 v15, 32, v13
    ds_read_b64_tr_b16 a[104:105], v15 offset:0
    ds_read_b64_tr_b16 a[106:107], v15 offset:4096
    v_xor_b32 v15, 64, v13
    ds_read_b64_tr_b16 a[108:109], v15 offset:0
    ds_read_b64_tr_b16 a[110:111], v15 offset:4096
    v_xor_b32 v15, 96, v13
    ds_read_b64_tr_b16 a[112:113], v15 offset:0
    ds_read_b64_tr_b16 a[114:115], v15 offset:4096
    v_xor_b32 v15, 128, v13
    ds_read_b64_tr_b16 a[116:117], v15 offset:0
    ds_read_b64_tr_b16 a[118:119], v15 offset:4096
Lwd_210:
    s_waitcnt lgkmcnt(0)
    s_barrier
    s_lshl_b32 s62, s52, 4
    s_add_u32 s62, s62, 1664
    s_mul_i32 s62, s62, 1280
    s_mul_i32 s63, s55, 160
    s_add_u32 s62, s62, s63
    s_lshl_b32 s63, s52, 12
    s_add_u32 s63, s63, 98304
    s_mov_b32 m0, s63
    s_nop 0
    buffer_load_dwordx4 v10, s[12:15], s62 offen lds
    s_add_u32 s62, s62, 5120
    s_add_u32 s63, s63, 1024
    s_mov_b32 m0, s63
    s_nop 0
    buffer_load_dwordx4 v11, s[12:15], s62 offen lds
    s_add_u32 s62, s62, 5120
    s_add_u32 s63, s63, 1024
    s_mov_b32 m0, s63
    s_nop 0
    buffer_load_dwordx4 v10, s[12:15], s62 offen lds
    s_add_u32 s62, s62, 5120
    s_add_u32 s63, s63, 1024
    s_mov_b32 m0, s63
    s_nop 0
    buffer_load_dwordx4 v11, s[12:15], s62 offen lds
    s_waitcnt vmcnt(8)
    s_barrier
    v_add_u32 v13, 131072, v12
    s_cmp_ge_u32 s52, 4
    s_cbranch_scc0 Lwd_211
    v_xor_b32 v15, 0, v13
    ds_read_b64_tr_b16 a[100:101], v15 offset:0
    ds_read_b64_tr_b16 a[102:103], v15 offset:4096
    v_xor_b32 v15, 32, v13
    ds_read_b64_tr_b16 a[104:105], v15 offset:0
    ds_read_b64_tr_b16 a[106:107], v15 offset:4096
    v_xor_b32 v15, 64, v13
    ds_read_b64_tr_b16 a[108:109], v15 offset:0
    ds_read_b64_tr_b16 a[110:111], v15 offset:4096
    v_xor_b32 v15, 96, v13
    ds_read_b64_tr_b16 a[112:113], v15 offset:0
    ds_read_b64_tr_b16 a[114:115], v15 offset:4096
    v_xor_b32 v15, 128, v13
    ds_read_b64_tr_b16 a[116:117], v15 offset:0
    ds_read_b64_tr_b16 a[118:119], v15 offset:4096
Lwd_211:
    s_waitcnt lgkmcnt(0)
    s_waitcnt vmcnt(4)
    s_barrier
    v_add_u32 v13, 65536, v12
    s_cmp_ge_u32 s52, 4
    s_cbranch_scc1 Lwd_212
    v_xor_b32 v15, 0, v13
    ds_read_b64_tr_b16 a[120:121], v15 offset:0
    ds_read_b64_tr_b16 a[122:123], v15 offset:4096
    v_xor_b32 v15, 32, v13
    ds_read_b64_tr_b16 a[124:125], v15 offset:0
    ds_read_b64_tr_b16 a[126:127], v15 offset:4096
    v_xor_b32 v15, 64, v13
    ds_read_b64_tr_b16 a[128:129], v15 offset:0
    ds_read_b64_tr_b16 a[130:131], v15 offset:4096
    v_xor_b32 v15, 96, v13
    ds_read_b64_tr_b16 a[132:133], v15 offset:0
    ds_read_b64_tr_b16 a[134:135], v15 offset:4096
    v_xor_b32 v15, 128, v13
    ds_read_b64_tr_b16 a[136:137], v15 offset:0
    ds_read_b64_tr_b16 a[138:139], v15 offset:4096
Lwd_212:
    s_waitcnt lgkmcnt(0)
    s_waitcnt vmcnt(0)
    s_barrier
    v_add_u32 v13, 98304, v12
    s_cmp_ge_u32 s52, 4
    s_cbranch_scc0 Lwd_213
    v_xor_b32 v15, 0, v13
    ds_read_b64_tr_b16 a[120:121], v15 offset:0
    ds_read_b64_tr_b16 a[122:123], v15 offset:4096
    v_xor_b32 v15, 32, v13
    ds_read_b64_tr_b16 a[124:125], v15 offset:0
    ds_read_b64_tr_b16 a[126:127], v15 offset:4096
    v_xor_b32 v15, 64, v13
    ds_read_b64_tr_b16 a[128:129], v15 offset:0
    ds_read_b64_tr_b16 a[130:131], v15 offset:4096
    v_xor_b32 v15, 96, v13
    ds_read_b64_tr_b16 a[132:133], v15 offset:0
    ds_read_b64_tr_b16 a[134:135], v15 offset:4096
    v_xor_b32 v15, 128, v13
    ds_read_b64_tr_b16 a[136:137], v15 offset:0
    ds_read_b64_tr_b16 a[138:139], v15 offset:4096
Lwd_213:
    s_waitcnt lgkmcnt(0)
    s_barrier
    s_mov_b32 s12, s40
    s_and_b32 s13, s41, 0xffff
    s_mov_b32 s14, 2621440
    s_mov_b32 s15, 0x00020000
    v_lshlrev_b32 v1, 4, v0
    s_and_b32 s63, s56, 1
    s_lshl_b32 s63, s63, 7
    s_add_u32 s63, s63, 2383872
    v_min_u32 v2, 13, v0
    v_lshlrev_b32 v2, 8, v2
    v_add_u32 v2, s63, v2
    s_and_b32 s63, s56, 0
    s_lshl_b32 s63, s63, 7
    s_lshl_b32 s62, s52, 10
    s_add_u32 s63, s63, s62
    s_add_u32 s63, s63, 2375680
    v_and_b32 v3, 3, v0
    v_lshlrev_b32 v3, 8, v3
    v_add_u32 v3, s63, v3
    s_and_b32 s63, s56, 1
    s_lshl_b32 s63, s63, 7
    s_lshl_b32 s62, s52, 10
    s_add_u32 s63, s63, s62
    s_add_u32 s63, s63, 2367488
    v_bfe_u32 v4, v0, 1, 2
    v_lshlrev_b32 v4, 8, v4
    v_and_b32 v9, 1, v0
    v_lshl_add_u32 v4, v9, 2, v4
    v_add_u32 v4, s63, v4
    s_lshl_b32 s62, s52, 10
    s_mul_i32 s63, s55, 81920
    s_add_u32 s62, s62, s63
    v_add_u32 v5, s62, v1
    s_mul_i32 s62, s52, 10240
    v_add_u32 v10, s62, v1
    s_lshl_b32 s62, s52, 6
    v_add_u32 v9, s62, v0
    v_mul_u32_u24 v7, 6554, v9
    v_lshrrev_b32 v7, 16, v7
    v_mul_u32_u24 v8, 10, v7
    v_sub_u32 v9, v9, v8
    v_mul_u32_u24 v8, 1280, v7
    v_lshl_add_u32 v8, v9, 4, v8
    s_mul_i32 s62, s55, 160
    v_add_u32 v8, s62, v8
    v_lshrrev_b32 v6, 4, v7
    v_and_b32 v7, 15, v7
    v_lshlrev_b32 v7, 4, v7
    v_lshl_add_u32 v7, v6, 10, v7
    v_lshrrev_b32 v6, 1, v9
    v_lshl_add_u32 v7, v6, 11, v7
    v_and_b32 v6, 1, v9
    v_lshl_add_u32 v7, v6, 9, v7
    s_lshl_b32 s65, s52, 2
    s_lshr_b32 s62, s65, 4
    s_mul_i32 s64, s62, 2138112
    s_bfe_u32 s62, s65, 0x10003
    s_mul_i32 s62, s62, 24576
    s_xor_b32 s64, s64, s62
    s_and_b32 s62, s65, 7
    s_lshl_b32 s62, s62, 10
    s_add_u32 s64, s64, s62
    s_mul_i32 s65, s55, 5
    s_add_u32 s65, s65, 0
    s_mov_b32 s68, s64
    s_and_b32 s62, s65, 31
    s_lshl_b32 s62, s62, 16
    s_add_u32 s68, s68, s62
    s_lshl_b32 s62, s65, 22
    s_add_u32 s68, s68, s62
    s_add_u32 s68, s68, 83886080
    s_lshl_b32 s63, s56, 15
    s_xor_b32 s68, s68, s63
    s_mul_i32 s65, s55, 5
    s_add_u32 s65, s65, 1
    s_mov_b32 s69, s64
    s_and_b32 s62, s65, 31
    s_lshl_b32 s62, s62, 16
    s_add_u32 s69, s69, s62
    s_lshl_b32 s62, s65, 22
    s_add_u32 s69, s69, s62
    s_add_u32 s69, s69, 83886080
    s_lshl_b32 s63, s56, 15
    s_xor_b32 s69, s69, s63
    s_mul_i32 s65, s55, 5
    s_add_u32 s65, s65, 2
    s_mov_b32 s70, s64
    s_and_b32 s62, s65, 31
    s_lshl_b32 s62, s62, 16
    s_add_u32 s70, s70, s62
    s_lshl_b32 s62, s65, 22
    s_add_u32 s70, s70, s62
    s_add_u32 s70, s70, 83886080
    s_lshl_b32 s63, s56, 15
    s_xor_b32 s70, s70, s63
    s_mul_i32 s65, s55, 5
    s_add_u32 s65, s65, 3
    s_mov_b32 s71, s64
    s_and_b32 s62, s65, 31
    s_lshl_b32 s62, s62, 16
    s_add_u32 s71, s71, s62
    s_lshl_b32 s62, s65, 22
    s_add_u32 s71, s71, s62
    s_add_u32 s71, s71, 83886080
    s_lshl_b32 s63, s56, 15
    s_xor_b32 s71, s71, s63
    s_mul_i32 s65, s55, 5
    s_add_u32 s65, s65, 4
    s_mov_b32 s72, s64
    s_and_b32 s62, s65, 31
    s_lshl_b32 s62, s62, 16
    s_add_u32 s72, s72, s62
    s_lshl_b32 s62, s65, 22
    s_add_u32 s72, s72, s62
    s_add_u32 s72, s72, 83886080
    s_lshl_b32 s63, s56, 15
    s_xor_b32 s72, s72, s63
    s_mov_b32 s60, s56
L_FIN_loop:
    s_mul_i32 s62, s60, 43
    s_lshr_b32 s62, s62, 7
    s_and_b32 s73, s62, 1
    s_lshl_b32 s73, s73, 13
    s_xor_b32 s73, s73, s46
    s_lshl_b32 s62, s62, 17
    s_add_u32 s73, s73, s62
    s_mul_i32 s62, s60, 655360
    s_add_u32 s73, s73, s62
    s_add_u32 s73, s73, 37748736
    s_add_u32 s74, s73, 16384
    s_add_u32 s75, s73, 32768
    s_add_u32 s76, s73, 49152
    s_add_u32 s77, s73, 65536
    s_lshr_b32 s64, s60, 1
    s_add_u32 s64, s64, 1
    s_mov_b32 s89, s59
Lsp_214:
    buffer_load_dword v9, v2, s[4:7], 0 offen sc1
    s_waitcnt vmcnt(0)
    v_cmp_gt_u32 vcc, s64, v9
    s_cbranch_vccz Lspd_215
    s_sleep 8
    s_sub_u32 s89, s89, 1
    s_cbranch_scc0 Lsp_214
    s_mov_b32 s59, 0
Lspd_215:
    s_mul_i32 s64, s60, 114688
    s_lshl_b32 s62, s52, 11
    s_add_u32 s64, s64, s62
    s_add_u32 s64, s64, 251658240
    buffer_load_dwordx4 v[32:35], v1, s[4:7], s64 offen sc1
    buffer_load_dwordx4 v[36:39], v1, s[4:7], s64 offen offset:1024 sc1
    s_add_u32 s64, s64, 16384
    buffer_load_dwordx4 v[40:43], v1, s[4:7], s64 offen sc1
    buffer_load_dwordx4 v[44:47], v1, s[4:7], s64 offen offset:1024 sc1
    s_add_u32 s64, s64, 16384
    buffer_load_dwordx4 v[48:51], v1, s[4:7], s64 offen sc1
    buffer_load_dwordx4 v[52:55], v1, s[4:7], s64 offen offset:1024 sc1
    s_add_u32 s64, s64, 16384
    buffer_load_dwordx4 v[56:59], v1, s[4:7], s64 offen sc1
    buffer_load_dwordx4 v[60:63], v1, s[4:7], s64 offen offset:1024 sc1
    s_add_u32 s64, s64, 16384
    buffer_load_dwordx4 v[64:67], v1, s[4:7], s64 offen sc1
    buffer_load_dwordx4 v[68:71], v1, s[4:7], s64 offen offset:1024 sc1
    s_add_u32 s64, s64, 16384
    buffer_load_dwordx4 v[72:75], v1, s[4:7], s64 offen sc1
    buffer_load_dwordx4 v[76:79], v1, s[4:7], s64 offen offset:1024 sc1
    s_cmp_ge_u32 s52, 6
    s_cselect_b32 s62, 0, 16384
    s_add_u32 s64, s64, s62
    buffer_load_dwordx4 v[80:83], v1, s[4:7], s64 offen sc1
    buffer_load_dwordx4 v[84:87], v1, s[4:7], s64 offen offset:1024 sc1
    s_waitcnt vmcnt(12)
    v_swap_b32 v34, v36
    v_swap_b32 v35, v37
    s_nop 1
    v_mfma_f32_16x16x32_bf16 v[12:15], a[0:3], v[32:35], 0
    v_mfma_f32_16x16x32_bf16 a[140:143], a[0:3], v[36:39], 0
    v_mfma_f32_16x16x32_bf16 v[16:19], a[4:7], v[32:35], 0
    v_mfma_f32_16x16x32_bf16 a[144:147], a[4:7], v[36:39], 0
    v_mfma_f32_16x16x32_bf16 v[20:23], a[8:11], v[32:35], 0
    v_mfma_f32_16x16x32_bf16 a[148:151], a[8:11], v[36:39], 0
    v_mfma_f32_16x16x32_bf16 v[24:27], a[12:15], v[32:35], 0
    v_mfma_f32_16x16x32_bf16 a[152:155], a[12:15], v[36:39], 0
    v_mfma_f32_16x16x32_bf16 v[28:31], a[16:19], v[32:35], 0
    v_mfma_f32_16x16x32_bf16 a[156:159], a[16:19], v[36:39], 0
    s_waitcnt vmcnt(10)
    v_swap_b32 v42, v44
    v_swap_b32 v43, v45
    s_nop 1
    v_mfma_f32_16x16x32_bf16 v[12:15], a[20:23], v[40:43], v[12:15]
    v_mfma_f32_16x16x32_bf16 a[140:143], a[20:23], v[44:47], a[140:143]
    v_mfma_f32_16x16x32_bf16 v[16:19], a[24:27], v[40:43], v[16:19]
    v_mfma_f32_16x16x32_bf16 a[144:147], a[24:27], v[44:47], a[144:147]
    v_mfma_f32_16x16x32_bf16 v[20:23], a[28:31], v[40:43], v[20:23]
    v_mfma_f32_16x16x32_bf16 a[148:151], a[28:31], v[44:47], a[148:151]
    v_mfma_f32_16x16x32_bf16 v[24:27], a[32:35], v[40:43], v[24:27]
    v_mfma_f32_16x16x32_bf16 a[152:155], a[32:35], v[44:47], a[152:155]
    v_mfma_f32_16x16x32_bf16 v[28:31], a[36:39], v[40:43], v[28:31]
    v_mfma_f32_16x16x32_bf16 a[156:159], a[36:39], v[44:47], a[156:159]
    s_waitcnt vmcnt(8)
    v_swap_b32 v50, v52
    v_swap_b32 v51, v53
    s_nop 1
    v_mfma_f32_16x16x32_bf16 v[12:15], a[40:43], v[48:51], v[12:15]
    v_mfma_f32_16x16x32_bf16 a[140:143], a[40:43], v[52:55], a[140:143]
    v_mfma_f32_16x16x32_bf16 v[16:19], a[44:47], v[48:51], v[16:19]
    v_mfma_f32_16x16x32_bf16 a[144:147], a[44:47], v[52:55], a[144:147]
    v_mfma_f32_16x16x32_bf16 v[20:23], a[48:51], v[48:51], v[20:23]
    v_mfma_f32_16x16x32_bf16 a[148:151], a[48:51], v[52:55], a[148:151]
    v_mfma_f32_16x16x32_bf16 v[24:27], a[52:55], v[48:51], v[24:27]
    v_mfma_f32_16x16x32_bf16 a[152:155], a[52:55], v[52:55], a[152:155]
    v_mfma_f32_16x16x32_bf16 v[28:31], a[56:59], v[48:51], v[28:31]
    v_mfma_f32_16x16x32_bf16 a[156:159], a[56:59], v[52:55], a[156:159]
    s_waitcnt vmcnt(6)
    v_swap_b32 v58, v60
    v_swap_b32 v59, v61
    s_nop 1
    v_mfma_f32_16x16x32_bf16 v[12:15], a[60:63], v[56:59], v[12:15]
    v_mfma_f32_16x16x32_bf16 a[140:143], a[60:63], v[60:63], a[140:143]
    v_mfma_f32_16x16x32_bf16 v[16:19], a[64:67], v[56:59], v[16:19]
    v_mfma_f32_16x16x32_bf16 a[144:147], a[64:67], v[60:63], a[144:147]
    v_mfma_f32_16x16x32_bf16 v[20:23], a[68:71], v[56:59], v[20:23]
    v_mfma_f32_16x16x32_bf16 a[148:151], a[68:71], v[60:63], a[148:151]
    v_mfma_f32_16x16x32_bf16 v[24:27], a[72:75], v[56:59], v[24:27]
    v_mfma_f32_16x16x32_bf16 a[152:155], a[72:75], v[60:63], a[152:155]
    v_mfma_f32_16x16x32_bf16 v[28:31], a[76:79], v[56:59], v[28:31]
    v_mfma_f32_16x16x32_bf16 a[156:159], a[76:79], v[60:63], a[156:159]
    s_waitcnt vmcnt(4)
    v_swap_b32 v66, v68
    v_swap_b32 v67, v69
    s_nop 1
    v_mfma_f32_16x16x32_bf16 v[12:15], a[80:83], v[64:67], v[12:15]
    v_mfma_f32_16x16x32_bf16 a[140:143], a[80:83], v[68:71], a[140:143]
    v_mfma_f32_16x16x32_bf16 v[16:19], a[84:87], v[64:67], v[16:19]
    v_mfma_f32_16x16x32_bf16 a[144:147], a[84:87], v[68:71], a[144:147]
    v_mfma_f32_16x16x32_bf16 v[20:23], a[88:91], v[64:67], v[20:23]
    v_mfma_f32_16x16x32_bf16 a[148:151], a[88:91], v[68:71], a[148:151]
    v_mfma_f32_16x16x32_bf16 v[24:27], a[92:95], v[64:67], v[24:27]
    v_mfma_f32_16x16x32_bf16 a[152:155], a[92:95], v[68:71], a[152:155]
    v_mfma_f32_16x16x32_bf16 v[28:31], a[96:99], v[64:67], v[28:31]
    v_mfma_f32_16x16x32_bf16 a[156:159], a[96:99], v[68:71], a[156:159]
    s_waitcnt vmcnt(2)
    v_swap_b32 v74, v76
    v_swap_b32 v75, v77
    s_nop 1
    v_mfma_f32_16x16x32_bf16 v[12:15], a[100:103], v[72:75], v[12:15]
    v_mfma_f32_16x16x32_bf16 a[140:143], a[100:103], v[76:79], a[140:143]
    v_mfma_f32_16x16x32_bf16 v[16:19], a[104:107], v[72:75], v[16:19]
    v_mfma_f32_16x16x32_bf16 a[144:147], a[104:107], v[76:79], a[144:147]
    v_mfma_f32_16x16x32_bf16 v[20:23], a[108:111], v[72:75], v[20:23]
    v_mfma_f32_16x16x32_bf16 a[148:151], a[108:111], v[76:79], a[148:151]
    v_mfma_f32_16x16x32_bf16 v[24:27], a[112:115], v[72:75], v[24:27]
    v_mfma_f32_16x16x32_bf16 a[152:155], a[112:115], v[76:79], a[152:155]
    v_mfma_f32_16x16x32_bf16 v[28:31], a[116:119], v[72:75], v[28:31]
    v_mfma_f32_16x16x32_bf16 a[156:159], a[116:119], v[76:79], a[156:159]
    s_waitcnt vmcnt(0)
    v_swap_b32 v82, v84
    v_swap_b32 v83, v85
    s_nop 1
    v_mfma_f32_16x16x32_bf16 v[12:15], a[120:123], v[80:83], v[12:15]
    v_mfma_f32_16x16x32_bf16 a[140:143], a[120:123], v[84:87], a[140:143]
    v_mfma_f32_16x16x32_bf16 v[16:19], a[124:127], v[80:83], v[16:19]
    v_mfma_f32_16x16x32_bf16 a[144:147], a[124:127], v[84:87], a[144:147]
    v_mfma_f32_16x16x32_bf16 v[20:23], a[128:131], v[80:83], v[20:23]
    v_mfma_f32_16x16x32_bf16 a[148:151], a[128:131], v[84:87], a[148:151]
    v_mfma_f32_16x16x32_bf16 v[24:27], a[132:135], v[80:83], v[24:27]
    v_mfma_f32_16x16x32_bf16 a[152:155], a[132:135], v[84:87], a[152:155]
    v_mfma_f32_16x16x32_bf16 v[28:31], a[136:139], v[80:83], v[28:31]
    v_mfma_f32_16x16x32_bf16 a[156:159], a[136:139], v[84:87], a[156:159]
    s_lshr_b32 s64, s60, 0
    s_add_u32 s64, s64, 1
    s_mov_b32 s89, s59
Lsp_216:
    buffer_load_dword v9, v3, s[4:7], 0 offen sc1
    s_waitcnt vmcnt(0)
    v_cmp_gt_u32 vcc, s64, v9
    s_cbranch_vccz Lspd_217
    s_sleep 8
    s_sub_u32 s89, s89, 1
    s_cbranch_scc0 Lsp_216
    s_mov_b32 s59, 0
Lspd_217:
    s_cmp_gt_u32 s60, 57
    s_cbranch_scc1 L_FIN_last
    buffer_load_dwordx4 v[32:35], v1, s[4:7], s68 offen offset:0 sc1
    buffer_load_dwordx4 v[36:39], v1, s[4:7], s69 offen offset:0 sc1
    buffer_load_dwordx4 v[40:43], v1, s[4:7], s70 offen offset:0 sc1
    buffer_load_dwordx4 v[44:47], v1, s[4:7], s71 offen offset:0 sc1
    buffer_load_dwordx4 v[48:51], v1, s[4:7], s72 offen offset:0 sc1
    buffer_load_dwordx4 v[60:63], v1, s[4:7], s68 offen offset:1024 sc1
    buffer_load_dwordx4 v[64:67], v1, s[4:7], s69 offen offset:1024 sc1
    buffer_load_dwordx4 v[68:71], v1, s[4:7], s70 offen offset:1024 sc1
    buffer_load_dwordx4 v[72:75], v1, s[4:7], s71 offen offset:1024 sc1
    buffer_load_dwordx4 v[76:79], v1, s[4:7], s72 offen offset:1024 sc1
    s_lshr_b32 s64, s60, 1
    s_add_u32 s64, s64, 1
    s_mov_b32 s89, s59
Lsp_218:
    buffer_load_dword v9, v4, s[4:7], 0 offen sc1
    s_waitcnt vmcnt(0)
    v_cmp_gt_u32 vcc, s64, v9
    s_cbranch_vccz Lspd_219
    s_sleep 2
    s_sub_u32 s89, s89, 1
    s_cbranch_scc0 Lsp_218
    s_mov_b32 s59, 0
Lspd_219:
    s_lshl_b32 s65, s60, 16
    s_lshl_b32 s62, s52, 13
    s_add_u32 s65, s65, s62
    s_add_u32 s65, s65, 31457280
    s_lshl_b32 s66, s60, 14
    s_lshl_b32 s62, s52, 11
    s_add_u32 s66, s66, s62
    s_add_u32 s66, s66, 6291456
    buffer_load_dwordx4 v[52:55], v1, s[4:7], s65 offen offset:0 sc1
    buffer_load_dwordx4 v[56:59], v1, s[4:7], s65 offen offset:1024 sc1
    buffer_load_dwordx4 v[80:83], v1, s[4:7], s65 offen offset:2048 sc1
    buffer_load_dwordx4 v[84:87], v1, s[4:7], s65 offen offset:3072 sc1
    s_add_u32 s65, s65, 4096
    s_waitcnt vmcnt(2)
    v_mfma_f32_16x16x32_bf16 v[12:15], v[32:35], v[52:55], v[12:15]
    v_mfma_f32_16x16x32_bf16 a[140:143], v[32:35], v[56:59], a[140:143]
    v_mfma_f32_16x16x32_bf16 v[16:19], v[36:39], v[52:55], v[16:19]
    v_mfma_f32_16x16x32_bf16 a[144:147], v[36:39], v[56:59], a[144:147]
    v_mfma_f32_16x16x32_bf16 v[20:23], v[40:43], v[52:55], v[20:23]
    v_mfma_f32_16x16x32_bf16 a[148:151], v[40:43], v[56:59], a[148:151]
    v_mfma_f32_16x16x32_bf16 v[24:27], v[44:47], v[52:55], v[24:27]
    v_mfma_f32_16x16x32_bf16 a[152:155], v[44:47], v[56:59], a[152:155]
    v_mfma_f32_16x16x32_bf16 v[28:31], v[48:51], v[52:55], v[28:31]
    v_mfma_f32_16x16x32_bf16 a[156:159], v[48:51], v[56:59], a[156:159]
    buffer_load_dwordx4 v[32:35], v1, s[4:7], s68 offen offset:2048 sc1
    buffer_load_dwordx4 v[36:39], v1, s[4:7], s69 offen offset:2048 sc1
    buffer_load_dwordx4 v[40:43], v1, s[4:7], s70 offen offset:2048 sc1
    buffer_load_dwordx4 v[44:47], v1, s[4:7], s71 offen offset:2048 sc1
    buffer_load_dwordx4 v[48:51], v1, s[4:7], s72 offen offset:2048 sc1
    buffer_load_dwordx4 v[52:55], v1, s[4:7], s65 offen offset:0 sc1
    buffer_load_dwordx4 v[56:59], v1, s[4:7], s65 offen offset:1024 sc1
    s_waitcnt vmcnt(7)
    v_mfma_f32_16x16x32_bf16 v[12:15], v[60:63], v[80:83], v[12:15]
    v_mfma_f32_16x16x32_bf16 a[140:143], v[60:63], v[84:87], a[140:143]
    v_mfma_f32_16x16x32_bf16 v[16:19], v[64:67], v[80:83], v[16:19]
    v_mfma_f32_16x16x32_bf16 a[144:147], v[64:67], v[84:87], a[144:147]
    v_mfma_f32_16x16x32_bf16 v[20:23], v[68:71], v[80:83], v[20:23]
    v_mfma_f32_16x16x32_bf16 a[148:151], v[68:71], v[84:87], a[148:151]
    v_mfma_f32_16x16x32_bf16 v[24:27], v[72:75], v[80:83], v[24:27]
    v_mfma_f32_16x16x32_bf16 a[152:155], v[72:75], v[84:87], a[152:155]
    v_mfma_f32_16x16x32_bf16 v[28:31], v[76:79], v[80:83], v[28:31]
    v_mfma_f32_16x16x32_bf16 a[156:159], v[76:79], v[84:87], a[156:159]
    buffer_load_dwordx4 v[60:63], v1, s[4:7], s68 offen offset:3072 sc1
    buffer_load_dwordx4 v[64:67], v1, s[4:7], s69 offen offset:3072 sc1
    buffer_load_dwordx4 v[68:71], v1, s[4:7], s70 offen offset:3072 sc1
    buffer_load_dwordx4 v[72:75], v1, s[4:7], s71 offen offset:3072 sc1
    buffer_load_dwordx4 v[76:79], v1, s[4:7], s72 offen offset:3072 sc1
    buffer_load_dwordx4 v[80:83], v1, s[4:7], s65 offen offset:2048 sc1
    buffer_load_dwordx4 v[84:87], v1, s[4:7], s65 offen offset:3072 sc1
    s_add_u32 s65, s65, 4096
    s_waitcnt vmcnt(7)
    v_mfma_f32_16x16x32_bf16 v[12:15], v[32:35], v[52:55], v[12:15]
    v_mfma_f32_16x16x32_bf16 a[140:143], v[32:35], v[56:59], a[140:143]
    v_mfma_f32_16x16x32_bf16 v[16:19], v[36:39], v[52:55], v[16:19]
    v_mfma_f32_16x16x32_bf16 a[144:147], v[36:39], v[56:59], a[144:147]
    v_mfma_f32_16x16x32_bf16 v[20:23], v[40:43], v[52:55], v[20:23]
    v_mfma_f32_16x16x32_bf16 a[148:151], v[40:43], v[56:59], a[148:151]
    v_mfma_f32_16x16x32_bf16 v[24:27], v[44:47], v[52:55], v[24:27]
    v_mfma_f32_16x16x32_bf16 a[152:155], v[44:47], v[56:59], a[152:155]
    v_mfma_f32_16x16x32_bf16 v[28:31], v[48:51], v[52:55], v[28:31]
    v_mfma_f32_16x16x32_bf16 a[156:159], v[48:51], v[56:59], a[156:159]
    buffer_load_dwordx4 v[52:55], v1, s[4:7], s66 offen offset:0 sc1
    buffer_load_dwordx4 v[56:59], v1, s[4:7], s66 offen offset:1024 sc1
    buffer_load_dwordx4 v[32:35], v5, s[4:7], s73 offen sc1
    buffer_load_dwordx4 v[36:39], v5, s[4:7], s74 offen sc1
    buffer_load_dwordx4 v[40:43], v5, s[4:7], s75 offen sc1
    buffer_load_dwordx4 v[44:47], v5, s[4:7], s76 offen sc1
    buffer_load_dwordx4 v[48:51], v5, s[4:7], s77 offen sc1
    s_waitcnt vmcnt(7)
    v_mfma_f32_16x16x32_bf16 v[12:15], v[60:63], v[80:83], v[12:15]
    v_mfma_f32_16x16x32_bf16 a[140:143], v[60:63], v[84:87], a[140:143]
    v_mfma_f32_16x16x32_bf16 v[16:19], v[64:67], v[80:83], v[16:19]
    v_mfma_f32_16x16x32_bf16 a[144:147], v[64:67], v[84:87], a[144:147]
    v_mfma_f32_16x16x32_bf16 v[20:23], v[68:71], v[80:83], v[20:23]
    v_mfma_f32_16x16x32_bf16 a[148:151], v[68:71], v[84:87], a[148:151]
    v_mfma_f32_16x16x32_bf16 v[24:27], v[72:75], v[80:83], v[24:27]
    v_mfma_f32_16x16x32_bf16 a[152:155], v[72:75], v[84:87], a[152:155]
    v_mfma_f32_16x16x32_bf16 v[28:31], v[76:79], v[80:83], v[28:31]
    v_mfma_f32_16x16x32_bf16 a[156:159], v[76:79], v[84:87], a[156:159]
    s_mov_b32 s89, s59
    s_waitcnt vmcnt(0)
    s_branch Lchk_221
Lpoll_220:
    buffer_load_dwordx4 v[32:35], v5, s[4:7], s73 offen sc1
    buffer_load_dwordx4 v[36:39], v5, s[4:7], s74 offen sc1
    buffer_load_dwordx4 v[40:43], v5, s[4:7], s75 offen sc1
    buffer_load_dwordx4 v[44:47], v5, s[4:7], s76 offen sc1
    buffer_load_dwordx4 v[48:51], v5, s[4:7], s77 offen sc1
    s_waitcnt vmcnt(0)
Lchk_221:
    v_max_u32 v9, v32, v33
    v_max3_u32 v9, v9, v34, v35
    v_max3_u32 v9, v9, v36, v37
    v_max3_u32 v9, v9, v38, v39
    v_max3_u32 v9, v9, v40, v41
    v_max3_u32 v9, v9, v42, v43
    v_max3_u32 v9, v9, v44, v45
    v_max3_u32 v9, v9, v46, v47
    v_max3_u32 v9, v9, v48, v49
    v_max3_u32 v9, v9, v50, v51
    v_cmp_eq_u32 vcc, -1, v9
    s_cbranch_vccz Lpdone_222
    s_sub_u32 s89, s89, 1
    s_cbranch_scc0 Lpoll_220
    s_mov_b32 s59, 0
Lpdone_222:
    v_mfma_f32_16x16x32_bf16 v[12:15], v[32:35], v[52:55], v[12:15]
    v_mfma_f32_16x16x32_bf16 a[140:143], v[32:35], v[56:59], a[140:143]
    v_mfma_f32_16x16x32_bf16 v[16:19], v[36:39], v[52:55], v[16:19]
    v_mfma_f32_16x16x32_bf16 a[144:147], v[36:39], v[56:59], a[144:147]
    v_mfma_f32_16x16x32_bf16 v[20:23], v[40:43], v[52:55], v[20:23]
    v_mfma_f32_16x16x32_bf16 a[148:151], v[40:43], v[56:59], a[148:151]
    v_mfma_f32_16x16x32_bf16 v[24:27], v[44:47], v[52:55], v[24:27]
    v_mfma_f32_16x16x32_bf16 a[152:155], v[44:47], v[56:59], a[152:155]
    v_mfma_f32_16x16x32_bf16 v[28:31], v[48:51], v[52:55], v[28:31]
    v_mfma_f32_16x16x32_bf16 a[156:159], v[48:51], v[56:59], a[156:159]
    s_add_u32 s62, s60, 4
    s_xor_b32 s62, s62, s60
    s_lshl_b32 s62, s62, 15
    s_xor_b32 s68, s68, s62
    s_xor_b32 s69, s69, s62
    s_xor_b32 s70, s70, s62
    s_xor_b32 s71, s71, s62
    s_xor_b32 s72, s72, s62
L_FIN_red:
    s_barrier
    ds_write_b128 v10, v[12:15] offset:0
    ds_write_b128 v10, a[140:143] offset:1024
    ds_write_b128 v10, v[16:19] offset:2048
    ds_write_b128 v10, a[144:147] offset:3072
    ds_write_b128 v10, v[20:23] offset:4096
    ds_write_b128 v10, a[148:151] offset:5120
    ds_write_b128 v10, v[24:27] offset:6144
    ds_write_b128 v10, a[152:155] offset:7168
    ds_write_b128 v10, v[28:31] offset:8192
    ds_write_b128 v10, a[156:159] offset:9216
    s_waitcnt lgkmcnt(0)
    s_barrier
    s_cmp_ge_u32 s52, 5
    s_cbranch_scc1 L_FIN_nored
L_FIN_red2:
    v_add_u32 v9, 40960, v7
    ds_read_b128 v[32:35], v7 offset:0
    ds_read_b128 v[36:39], v7 offset:256
    ds_read_b128 v[40:43], v7 offset:10240
    ds_read_b128 v[44:47], v7 offset:10496
    ds_read_b128 v[48:51], v7 offset:20480
    ds_read_b128 v[52:55], v7 offset:20736
    ds_read_b128 v[56:59], v7 offset:30720
    ds_read_b128 v[60:63], v7 offset:30976
    ds_read_b128 v[64:67], v9 offset:0
    ds_read_b128 v[68:71], v9 offset:256
    ds_read_b128 v[72:75], v9 offset:10240
    ds_read_b128 v[76:79], v9 offset:10496
    ds_read_b128 v[80:83], v9 offset:20480
    ds_read_b128 v[84:87], v9 offset:20736
    ds_read_b128 v[88:91], v9 offset:30720
    ds_read_b128 v[92:95], v9 offset:30976
    s_waitcnt lgkmcnt(12)
    v_pk_add_f32 v[32:33], v[32:33], v[40:41]
    v_pk_add_f32 v[34:35], v[34:35], v[42:43]
    v_pk_add_f32 v[36:37], v[36:37], v[44:45]
    v_pk_add_f32 v[38:39], v[38:39], v[46:47]
    s_waitcnt lgkmcnt(10)
    v_pk_add_f32 v[32:33], v[32:33], v[48:49]
    v_pk_add_f32 v[34:35], v[34:35], v[50:51]
    v_pk_add_f32 v[36:37], v[36:37], v[52:53]
    v_pk_add_f32 v[38:39], v[38:39], v[54:55]
    s_waitcnt lgkmcnt(8)
    v_pk_add_f32 v[32:33], v[32:33], v[56:57]
    v_pk_add_f32 v[34:35], v[34:35], v[58:59]
    v_pk_add_f32 v[36:37], v[36:37], v[60:61]
    v_pk_add_f32 v[38:39], v[38:39], v[62:63]
    s_waitcnt lgkmcnt(6)
    v_pk_add_f32 v[32:33], v[32:33], v[64:65]
    v_pk_add_f32 v[34:35], v[34:35], v[66:67]
    v_pk_add_f32 v[36:37], v[36:37], v[68:69]
    v_pk_add_f32 v[38:39], v[38:39], v[70:71]
    s_waitcnt lgkmcnt(4)
    v_pk_add_f32 v[32:33], v[32:33], v[72:73]
    v_pk_add_f32 v[34:35], v[34:35], v[74:75]
    v_pk_add_f32 v[36:37], v[36:37], v[76:77]
    v_pk_add_f32 v[38:39], v[38:39], v[78:79]
    s_waitcnt lgkmcnt(2)
    v_pk_add_f32 v[32:33], v[32:33], v[80:81]
    v_pk_add_f32 v[34:35], v[34:35], v[82:83]
    v_pk_add_f32 v[36:37], v[36:37], v[84:85]
    v_pk_add_f32 v[38:39], v[38:39], v[86:87]
    s_waitcnt lgkmcnt(0)
    v_pk_add_f32 v[32:33], v[32:33], v[88:89]
    v_pk_add_f32 v[34:35], v[34:35], v[90:91]
    v_pk_add_f32 v[36:37], v[36:37], v[92:93]
    v_pk_add_f32 v[38:39], v[38:39], v[94:95]
    v_cvt_pk_bf16_f32 v32, v32, v33
    v_cvt_pk_bf16_f32 v33, v34, v35
    v_cvt_pk_bf16_f32 v34, v36, v37
    v_cvt_pk_bf16_f32 v35, v38, v39
    s_mul_i32 s62, s60, 40960
    buffer_store_dwordx4 v[32:35], v8, s[12:15], s62 offen
L_FIN_nored:
    s_add_u32 s60, s60, 4
    s_cmp_le_u32 s60, 61
    s_cbranch_scc1 L_FIN_loop
    s_branch L_end
L_FIN_last:
    buffer_load_dwordx4 a[0:3], v1, s[4:7], s68 offen offset:0 sc1
    buffer_load_dwordx4 a[4:7], v1, s[4:7], s69 offen offset:0 sc1
    buffer_load_dwordx4 a[8:11], v1, s[4:7], s70 offen offset:0 sc1
    buffer_load_dwordx4 a[12:15], v1, s[4:7], s71 offen offset:0 sc1
    buffer_load_dwordx4 a[16:19], v1, s[4:7], s72 offen offset:0 sc1
    buffer_load_dwordx4 a[20:23], v1, s[4:7], s68 offen offset:1024 sc1
    buffer_load_dwordx4 a[24:27], v1, s[4:7], s69 offen offset:1024 sc1
    buffer_load_dwordx4 a[28:31], v1, s[4:7], s70 offen offset:1024 sc1
    buffer_load_dwordx4 a[32:35], v1, s[4:7], s71 offen offset:1024 sc1
    buffer_load_dwordx4 a[36:39], v1, s[4:7], s72 offen offset:1024 sc1
    buffer_load_dwordx4 a[40:43], v1, s[4:7], s68 offen offset:2048 sc1
    buffer_load_dwordx4 a[44:47], v1, s[4:7], s69 offen offset:2048 sc1
    buffer_load_dwordx4 a[48:51], v1, s[4:7], s70 offen offset:2048 sc1
    buffer_load_dwordx4 a[52:55], v1, s[4:7], s71 offen offset:2048 sc1
    buffer_load_dwordx4 a[56:59], v1, s[4:7], s72 offen offset:2048 sc1
    buffer_load_dwordx4 a[60:63], v1, s[4:7], s68 offen offset:3072 sc1
    buffer_load_dwordx4 a[64:67], v1, s[4:7], s69 offen offset:3072 sc1
    buffer_load_dwordx4 a[68:71], v1, s[4:7], s70 offen offset:3072 sc1
    buffer_load_dwordx4 a[72:75], v1, s[4:7], s71 offen offset:3072 sc1
    buffer_load_dwordx4 a[76:79], v1, s[4:7], s72 offen offset:3072 sc1
    s_lshl_b32 s65, s60, 16
    s_lshl_b32 s62, s52, 13
    s_add_u32 s65, s65, s62
    s_add_u32 s65, s65, 31457280
    s_lshl_b32 s66, s60, 14
    s_lshl_b32 s62, s52, 11
    s_add_u32 s66, s66, s62
    s_add_u32 s66, s66, 6291456
    s_lshr_b32 s64, s60, 1
    s_add_u32 s64, s64, 1
    s_cmp_eq_u32 s60, 63
    s_cbranch_scc1 L_FIN_63
    s_mov_b32 s89, s59
Lsp_223:
    buffer_load_dword v9, v4, s[4:7], 0 offen sc1
    s_waitcnt vmcnt(0)
    v_cmp_gt_u32 vcc, s64, v9
    s_cbranch_vccz Lspd_224
    s_sleep 3
    s_sub_u32 s89, s89, 1
    s_cbranch_scc0 Lsp_223
    s_mov_b32 s59, 0
Lspd_224:
    s_add_u32 s64, s65, 4096
    buffer_load_dwordx4 v[32:35], v1, s[4:7], s65 offen offset:0 sc1
    buffer_load_dwordx4 v[36:39], v1, s[4:7], s65 offen offset:1024 sc1
    buffer_load_dwordx4 v[40:43], v1, s[4:7], s65 offen offset:2048 sc1
    buffer_load_dwordx4 v[44:47], v1, s[4:7], s65 offen offset:3072 sc1
    buffer_load_dwordx4 v[48:51], v1, s[4:7], s64 offen offset:0 sc1
    buffer_load_dwordx4 v[52:55], v1, s[4:7], s64 offen offset:1024 sc1
    buffer_load_dwordx4 v[56:59], v1, s[4:7], s64 offen offset:2048 sc1
    buffer_load_dwordx4 v[60:63], v1, s[4:7], s64 offen offset:3072 sc1
    buffer_load_dwordx4 v[64:67], v1, s[4:7], s66 offen offset:0 sc1
    buffer_load_dwordx4 v[68:71], v1, s[4:7], s66 offen offset:1024 sc1
    buffer_load_dwordx4 v[72:75], v5, s[4:7], s73 offen sc1
    buffer_load_dwordx4 v[76:79], v5, s[4:7], s74 offen sc1
    buffer_load_dwordx4 v[80:83], v5, s[4:7], s75 offen sc1
    buffer_load_dwordx4 v[84:87], v5, s[4:7], s76 offen sc1
    buffer_load_dwordx4 v[88:91], v5, s[4:7], s77 offen sc1
    s_waitcnt vmcnt(13)
    v_mfma_f32_16x16x32_bf16 v[12:15], a[0:3], v[32:35], v[12:15]
    v_mfma_f32_16x16x32_bf16 a[140:143], a[0:3], v[36:39], a[140:143]
    v_mfma_f32_16x16x32_bf16 v[16:19], a[4:7], v[32:35], v[16:19]
    v_mfma_f32_16x16x32_bf16 a[144:147], a[4:7], v[36:39], a[144:147]
    v_mfma_f32_16x16x32_bf16 v[20:23], a[8:11], v[32:35], v[20:23]
    v_mfma_f32_16x16x32_bf16 a[148:151], a[8:11], v[36:39], a[148:151]
    v_mfma_f32_16x16x32_bf16 v[24:27], a[12:15], v[32:35], v[24:27]
    v_mfma_f32_16x16x32_bf16 a[152:155], a[12:15], v[36:39], a[152:155]
    v_mfma_f32_16x16x32_bf16 v[28:31], a[16:19], v[32:35], v[28:31]
    v_mfma_f32_16x16x32_bf16 a[156:159], a[16:19], v[36:39], a[156:159]
    s_waitcnt vmcnt(11)
    v_mfma_f32_16x16x32_bf16 v[12:15], a[20:23], v[40:43], v[12:15]
    v_mfma_f32_16x16x32_bf16 a[140:143], a[20:23], v[44:47], a[140:143]
    v_mfma_f32_16x16x32_bf16 v[16:19], a[24:27], v[40:43], v[16:19]
    v_mfma_f32_16x16x32_bf16 a[144:147], a[24:27], v[44:47], a[144:147]
    v_mfma_f32_16x16x32_bf16 v[20:23], a[28:31], v[40:43], v[20:23]
    v_mfma_f32_16x16x32_bf16 a[148:151], a[28:31], v[44:47], a[148:151]
    v_mfma_f32_16x16x32_bf16 v[24:27], a[32:35], v[40:43], v[24:27]
    v_mfma_f32_16x16x32_bf16 a[152:155], a[32:35], v[44:47], a[152:155]
    v_mfma_f32_16x16x32_bf16 v[28:31], a[36:39], v[40:43], v[28:31]
    v_mfma_f32_16x16x32_bf16 a[156:159], a[36:39], v[44:47], a[156:159]
    s_waitcnt vmcnt(9)
    v_mfma_f32_16x16x32_bf16 v[12:15], a[40:43], v[48:51], v[12:15]
    v_mfma_f32_16x16x32_bf16 a[140:143], a[40:43], v[52:55], a[140:143]
    v_mfma_f32_16x16x32_bf16 v[16:19], a[44:47], v[48:51], v[16:19]
    v_mfma_f32_16x16x32_bf16 a[144:147], a[44:47], v[52:55], a[144:147]
    v_mfma_f32_16x16x32_bf16 v[20:23], a[48:51], v[48:51], v[20:23]
    v_mfma_f32_16x16x32_bf16 a[148:151], a[48:51], v[52:55], a[148:151]
    v_mfma_f32_16x16x32_bf16 v[24:27], a[52:55], v[48:51], v[24:27]
    v_mfma_f32_16x16x32_bf16 a[152:155], a[52:55], v[52:55], a[152:155]
    v_mfma_f32_16x16x32_bf16 v[28:31], a[56:59], v[48:51], v[28:31]
    v_mfma_f32_16x16x32_bf16 a[156:159], a[56:59], v[52:55], a[156:159]
    s_waitcnt vmcnt(7)
    v_mfma_f32_16x16x32_bf16 v[12:15], a[60:63], v[56:59], v[12:15]
    v_mfma_f32_16x16x32_bf16 a[140:143], a[60:63], v[60:63], a[140:143]
    v_mfma_f32_16x16x32_bf16 v[16:19], a[64:67], v[56:59], v[16:19]
    v_mfma_f32_16x16x32_bf16 a[144:147], a[64:67], v[60:63], a[144:147]
    v_mfma_f32_16x16x32_bf16 v[20:23], a[68:71], v[56:59], v[20:23]
    v_mfma_f32_16x16x32_bf16 a[148:151], a[68:71], v[60:63], a[148:151]
    v_mfma_f32_16x16x32_bf16 v[24:27], a[72:75], v[56:59], v[24:27]
    v_mfma_f32_16x16x32_bf16 a[152:155], a[72:75], v[60:63], a[152:155]
    v_mfma_f32_16x16x32_bf16 v[28:31], a[76:79], v[56:59], v[28:31]
    v_mfma_f32_16x16x32_bf16 a[156:159], a[76:79], v[60:63], a[156:159]
    s_mov_b32 s89, s59
    s_waitcnt vmcnt(0)
    s_branch Lchk_226
Lpoll_225:
    buffer_load_dwordx4 v[72:75], v5, s[4:7], s73 offen sc1
    buffer_load_dwordx4 v[76:79], v5, s[4:7], s74 offen sc1
    buffer_load_dwordx4 v[80:83], v5, s[4:7], s75 offen sc1
    buffer_load_dwordx4 v[84:87], v5, s[4:7], s76 offen sc1
    buffer_load_dwordx4 v[88:91], v5, s[4:7], s77 offen sc1
    s_waitcnt vmcnt(0)
Lchk_226:
    v_max_u32 v9, v72, v73
    v_max3_u32 v9, v9, v74, v75
    v_max3_u32 v9, v9, v76, v77
    v_max3_u32 v9, v9, v78, v79
    v_max3_u32 v9, v9, v80, v81
    v_max3_u32 v9, v9, v82, v83
    v_max3_u32 v9, v9, v84, v85
    v_max3_u32 v9, v9, v86, v87
    v_max3_u32 v9, v9, v88, v89
    v_max3_u32 v9, v9, v90, v91
    v_cmp_eq_u32 vcc, -1, v9
    s_cbranch_vccz Lpdone_227
    s_sub_u32 s89, s89, 1
    s_cbranch_scc0 Lpoll_225
    s_mov_b32 s59, 0
Lpdone_227:
    v_mfma_f32_16x16x32_bf16 v[12:15], v[72:75], v[64:67], v[12:15]
    v_mfma_f32_16x16x32_bf16 a[140:143], v[72:75], v[68:71], a[140:143]
    v_mfma_f32_16x16x32_bf16 v[16:19], v[76:79], v[64:67], v[16:19]
    v_mfma_f32_16x16x32_bf16 a[144:147], v[76:79], v[68:71], a[144:147]
    v_mfma_f32_16x16x32_bf16 v[20:23], v[80:83], v[64:67], v[20:23]
    v_mfma_f32_16x16x32_bf16 a[148:151], v[80:83], v[68:71], a[148:151]
    v_mfma_f32_16x16x32_bf16 v[24:27], v[84:87], v[64:67], v[24:27]
    v_mfma_f32_16x16x32_bf16 a[152:155], v[84:87], v[68:71], a[152:155]
    v_mfma_f32_16x16x32_bf16 v[28:31], v[88:91], v[64:67], v[28:31]
    v_mfma_f32_16x16x32_bf16 a[156:159], v[88:91], v[68:71], a[156:159]
    s_nop 7
    s_branch L_FIN_red
L_FIN_63:
    s_cmp_eq_u32 s57, 0
    s_cbranch_scc1 Ltt_228
    v_accvgpr_read_b32 v12, a140
    v_accvgpr_read_b32 v13, a141
    v_accvgpr_read_b32 v14, a142
    v_accvgpr_read_b32 v15, a143
    v_accvgpr_read_b32 v16, a144
    v_accvgpr_read_b32 v17, a145
    v_accvgpr_read_b32 v18, a146
    v_accvgpr_read_b32 v19, a147
    v_accvgpr_read_b32 v20, a148
    v_accvgpr_read_b32 v21, a149
    v_accvgpr_read_b32 v22, a150
    v_accvgpr_read_b32 v23, a151
    v_accvgpr_read_b32 v24, a152
    v_accvgpr_read_b32 v25, a153
    v_accvgpr_read_b32 v26, a154
    v_accvgpr_read_b32 v27, a155
    v_accvgpr_read_b32 v28, a156
    v_accvgpr_read_b32 v29, a157
    v_accvgpr_read_b32 v30, a158
    v_accvgpr_read_b32 v31, a159
Ltt_228:
    s_lshl_b32 s62, s57, 10
    s_add_u32 s65, s65, s62
    s_add_u32 s66, s66, s62
    v_add_u32 v3, -16384, v3
    s_mov_b32 s89, s59
Lsp_229:
    buffer_load_dword v9, v3, s[4:7], 0 offen sc1
    s_waitcnt vmcnt(0)
    v_cmp_gt_u32 vcc, s64, v9
    s_cbranch_vccz Lspd_230
    s_sleep 8
    s_sub_u32 s89, s89, 1
    s_cbranch_scc0 Lsp_229
    s_mov_b32 s59, 0
Lspd_230:
    s_mov_b32 s89, s59
Lpoll_231:
    buffer_load_dwordx4 v[72:75], v5, s[4:7], s73 offen sc1
    buffer_load_dwordx4 v[76:79], v5, s[4:7], s74 offen sc1
    buffer_load_dwordx4 v[80:83], v5, s[4:7], s75 offen sc1
    buffer_load_dwordx4 v[84:87], v5, s[4:7], s76 offen sc1
    buffer_load_dwordx4 v[88:91], v5, s[4:7], s77 offen sc1
    s_waitcnt vmcnt(0)
Lchk_232:
    v_max_u32 v9, v72, v73
    v_max3_u32 v9, v9, v74, v75
    v_max3_u32 v9, v9, v76, v77
    v_max3_u32 v9, v9, v78, v79
    v_max3_u32 v9, v9, v80, v81
    v_max3_u32 v9, v9, v82, v83
    v_max3_u32 v9, v9, v84, v85
    v_max3_u32 v9, v9, v86, v87
    v_max3_u32 v9, v9, v88, v89
    v_max3_u32 v9, v9, v90, v91
    v_cmp_eq_u32 vcc, -1, v9
    s_cbranch_vccz Lpdone_233
    s_sleep 4
    s_sub_u32 s89, s89, 1
    s_cbranch_scc0 Lpoll_231
    s_mov_b32 s59, 0
Lpdone_233:
    s_add_u32 s64, s65, 4096
    s_mov_b32 s89, s59
Lpoll_234:
    buffer_load_dwordx4 v[64:67], v1, s[4:7], s66 offen sc1
    s_waitcnt vmcnt(0)
Lchk_235:
    v_max_u32 v9, v64, v65
    v_max3_u32 v9, v9, v66, v67
    v_cmp_eq_u32 vcc, -1, v9
    s_cbranch_vccz Lpdone_236
    s_sub_u32 s89, s89, 1
    s_cbranch_scc0 Lpoll_234
    s_mov_b32 s59, 0
Lpdone_236:
    s_barrier
    buffer_load_dwordx4 v[32:35], v1, s[4:7], s65 offen offset:0 sc1
    buffer_load_dwordx4 v[36:39], v1, s[4:7], s65 offen offset:2048 sc1
    buffer_load_dwordx4 v[40:43], v1, s[4:7], s64 offen offset:0 sc1
    buffer_load_dwordx4 v[44:47], v1, s[4:7], s64 offen offset:2048 sc1
    v_mfma_f32_16x16x32_bf16 v[12:15], v[72:75], v[64:67], v[12:15]
    v_mfma_f32_16x16x32_bf16 v[16:19], v[76:79], v[64:67], v[16:19]
    v_mfma_f32_16x16x32_bf16 v[20:23], v[80:83], v[64:67], v[20:23]
    v_mfma_f32_16x16x32_bf16 v[24:27], v[84:87], v[64:67], v[24:27]
    v_mfma_f32_16x16x32_bf16 v[28:31], v[88:91], v[64:67], v[28:31]
    s_waitcnt vmcnt(3)
Lck_237:
    v_max_u32 v9, v32, v33
    v_max3_u32 v9, v9, v34, v35
    v_cmp_eq_u32 vcc, -1, v9
    s_cbranch_vccnz Lrt_238
Lckd_239:
    v_mfma_f32_16x16x32_bf16 v[12:15], a[0:3], v[32:35], v[12:15]
    v_mfma_f32_16x16x32_bf16 v[16:19], a[4:7], v[32:35], v[16:19]
    v_mfma_f32_16x16x32_bf16 v[20:23], a[8:11], v[32:35], v[20:23]
    v_mfma_f32_16x16x32_bf16 v[24:27], a[12:15], v[32:35], v[24:27]
    v_mfma_f32_16x16x32_bf16 v[28:31], a[16:19], v[32:35], v[28:31]
    s_waitcnt vmcnt(2)
Lck_240:
    v_max_u32 v9, v36, v37
    v_max3_u32 v9, v9, v38, v39
    v_cmp_eq_u32 vcc, -1, v9
    s_cbranch_vccnz Lrt_241
Lckd_242:
    v_mfma_f32_16x16x32_bf16 v[12:15], a[20:23], v[36:39], v[12:15]
    v_mfma_f32_16x16x32_bf16 v[16:19], a[24:27], v[36:39], v[16:19]
    v_mfma_f32_16x16x32_bf16 v[20:23], a[28:31], v[36:39], v[20:23]
    v_mfma_f32_16x16x32_bf16 v[24:27], a[32:35], v[36:39], v[24:27]
    v_mfma_f32_16x16x32_bf16 v[28:31], a[36:39], v[36:39], v[28:31]
    s_waitcnt vmcnt(1)
Lck_243:
    v_max_u32 v9, v40, v41
    v_max3_u32 v9, v9, v42, v43
    v_cmp_eq_u32 vcc, -1, v9
    s_cbranch_vccnz Lrt_244
Lckd_245:
    v_mfma_f32_16x16x32_bf16 v[12:15], a[40:43], v[40:43], v[12:15]
    v_mfma_f32_16x16x32_bf16 v[16:19], a[44:47], v[40:43], v[16:19]
    v_mfma_f32_16x16x32_bf16 v[20:23], a[48:51], v[40:43], v[20:23]
    v_mfma_f32_16x16x32_bf16 v[24:27], a[52:55], v[40:43], v[24:27]
    v_mfma_f32_16x16x32_bf16 v[28:31], a[56:59], v[40:43], v[28:31]
    s_waitcnt vmcnt(0)
Lck_246:
    v_max_u32 v9, v44, v45
    v_max3_u32 v9, v9, v46, v47
    v_cmp_eq_u32 vcc, -1, v9
    s_cbranch_vccnz Lrt_247
Lckd_248:
    v_mfma_f32_16x16x32_bf16 v[12:15], a[60:63], v[44:47], v[12:15]
    v_mfma_f32_16x16x32_bf16 v[16:19], a[64:67], v[44:47], v[16:19]
    v_mfma_f32_16x16x32_bf16 v[20:23], a[68:71], v[44:47], v[20:23]
    v_mfma_f32_16x16x32_bf16 v[24:27], a[72:75], v[44:47], v[24:27]
    v_mfma_f32_16x16x32_bf16 v[28:31], a[76:79], v[44:47], v[28:31]
    s_nop 3
    ds_write_b128 v10, v[12:15] offset:0
    ds_write_b128 v10, v[16:19] offset:2048
    ds_write_b128 v10, v[20:23] offset:4096
    ds_write_b128 v10, v[24:27] offset:6144
    ds_write_b128 v10, v[28:31] offset:8192
    s_mul_i32 s62, s57, 20480
    v_add_u32 v8, s62, v8
    s_waitcnt lgkmcnt(0)
    s_barrier
    s_cmp_ge_u32 s52, 3
    s_cbranch_scc1 L_FIN_nored
    s_cmp_lt_u32 s52, 2
    s_cbranch_scc1 L_FIN_red2
    s_mov_b32 exec_hi, 0
    s_branch L_FIN_red2
Lrt_238:
    s_sub_u32 s59, s59, 1
    s_cbranch_scc0 Lrg_249
    s_mov_b32 s59, 0
    s_branch Lckd_239
Lrg_249:
    s_nop 7
    buffer_load_dwordx4 v[32:35], v1, s[4:7], s65 offen offset:0 sc1
    s_waitcnt vmcnt(0)
    s_branch Lck_237
Lrt_241:
    s_sub_u32 s59, s59, 1
    s_cbranch_scc0 Lrg_250
    s_mov_b32 s59, 0
    s_branch Lckd_242
Lrg_250:
    s_nop 7
    buffer_load_dwordx4 v[36:39], v1, s[4:7], s65 offen offset:2048 sc1
    s_waitcnt vmcnt(0)
    s_branch Lck_240
Lrt_244:
    s_sub_u32 s59, s59, 1
    s_cbranch_scc0 Lrg_251
    s_mov_b32 s59, 0
    s_branch Lckd_245
Lrg_251:
    s_nop 7
    buffer_load_dwordx4 v[40:43], v1, s[4:7], s64 offen offset:0 sc1
    s_waitcnt vmcnt(0)
    s_branch Lck_243
Lrt_247:
    s_sub_u32 s59, s59, 1
    s_cbranch_scc0 Lrg_252
    s_mov_b32 s59, 0
    s_branch Lckd_248
Lrg_252:
    s_nop 7
    buffer_load_dwordx4 v[44:47], v1, s[4:7], s64 offen offset:2048 sc1
    s_waitcnt vmcnt(0)
    s_branch Lck_246
L_end:
    s_endpgm
.section .rodata,"a"
.p2align 6
.amdhsa_kernel gated_mix__memory_aug_recurrent_mem_tr__glu_gated_bilinear__prompt_kernel
  .amdhsa_next_free_vgpr 256
  .amdhsa_next_free_sgpr 102
  .amdhsa_accum_offset 96
  .amdhsa_group_segment_fixed_size 0
  .amdhsa_kernarg_size 120
  .amdhsa_user_sgpr_count 2
  .amdhsa_user_sgpr_kernarg_segment_ptr 1
  .amdhsa_system_sgpr_workgroup_id_x 1
.end_amdhsa_kernel
```
